```python
import torch

def _softmax(x, axis=-1):
    return torch.softmax(x, dim=axis)
def _gelu(x):
    return torch.nn.functional.gelu(x, approximate="tanh")
def _silu(x):
    return torch.nn.functional.silu(x)
def _sigmoid(x):
    return torch.sigmoid(x)
def _layernorm(x, axis=-1, eps=1e-5):
    m = x.mean(dim=axis, keepdim=True)
    v = x.var(dim=axis, keepdim=True, unbiased=False)
    return (x - m) / torch.sqrt(v + eps)
def _scatter_add(tgt, idx, src, axis=0):
    return tgt.clone().index_add_(axis, idx, src)
def _segment_sum(src, seg, n):
    out = torch.zeros((n,) + src.shape[1:], dtype=src.dtype)
    return out.index_add_(0, seg, src)
def _pad(x, pw):
    flat = tuple(v for pair in reversed(pw) for v in pair)
    return torch.nn.functional.pad(x, flat)

kernel_name = 'concat_heads__mha_block_cached__mha_block_cached__near_ridge'

def setup_inputs():

    _w = (lambda a: (lambda t: t.to(torch.bfloat16) if t.is_floating_point() else t)(torch.as_tensor(a)))
    def _A_setup():
        B, Sq, D = 8, 96, 640
        H, Sk, Dh = 32, 512, 128
        return {
            "x": _w((lambda *s: torch.randn(*s, dtype=torch.bfloat16) * 0.8)(B, Sq, D)),
            "k_cache": _w((lambda *s: torch.randn(*s, dtype=torch.bfloat16) * 0.8)(B, H, Sk, Dh)),
            "v_cache": _w((lambda *s: torch.randn(*s, dtype=torch.bfloat16) * 0.05)(B, H, Sk, Dh)),
            "wq": _w((lambda *s: torch.randn(*s, dtype=torch.bfloat16) * 0.8)(D, H * Dh) * (D ** -0.5)),
            "wo": _w((lambda *s: torch.randn(*s, dtype=torch.bfloat16) * 0.05)(H * Dh, D) * ((H * Dh) ** -0.5)),
        }
    _A_in = _A_setup()

    def _B_setup():
        B, Sq, D = 8, 96, 640
        H, Sk, Dh = 32, 512, 128
        return {
            "x": _w((lambda *s: torch.randn(*s, dtype=torch.bfloat16) * 0.8)(B, Sq, D)),
            "k_cache": _w((lambda *s: torch.randn(*s, dtype=torch.bfloat16) * 0.8)(B, H, Sk, Dh)),
            "v_cache": _w((lambda *s: torch.randn(*s, dtype=torch.bfloat16) * 0.05)(B, H, Sk, Dh)),
            "wq": _w((lambda *s: torch.randn(*s, dtype=torch.bfloat16) * 0.8)(D, H * Dh) * (D ** -0.5)),
            "wo": _w((lambda *s: torch.randn(*s, dtype=torch.bfloat16) * 0.05)(H * Dh, D) * ((H * Dh) ** -0.5)),
        }
    _B_in = _B_setup()

    return {
        "A_x": _A_in["x"],
        "A_k_cache": _A_in["k_cache"],
        "A_v_cache": _A_in["v_cache"],
        "A_wq": _A_in["wq"],
        "A_wo": _A_in["wo"],
        "B_x": _B_in["x"],
        "B_k_cache": _B_in["k_cache"],
        "B_v_cache": _B_in["v_cache"],
        "B_wq": _B_in["wq"],
        "B_wo": _B_in["wo"],
    }

def reference(A_x, A_k_cache, A_v_cache, A_wq, A_wo, B_x, B_k_cache, B_v_cache, B_wq, B_wo):
    def _A_ref(x, k_cache, v_cache, wq, wo):
        B, Sq, D = x.shape
        H, Dh = 32, 128
        q = (lambda x, *d: x.permute(*d))((x @ wq).reshape(B, Sq, H, Dh), 0, 2, 1, 3)
        scores = torch.einsum("bhqd,bhkd->bhqk", q, k_cache) * (Dh ** -0.5)
        p = _softmax(scores, axis=-1)
        o = torch.einsum("bhqk,bhkd->bhqd", p, v_cache)
        return (lambda x, *d: x.permute(*d))(o, 0, 2, 1, 3).reshape(B, Sq, H * Dh) @ wo

    def _B_ref(x, k_cache, v_cache, wq, wo):
        B, Sq, D = x.shape
        H, Dh = 32, 128
        q = (lambda x, *d: x.permute(*d))((x @ wq).reshape(B, Sq, H, Dh), 0, 2, 1, 3)
        scores = torch.einsum("bhqd,bhkd->bhqk", q, k_cache) * (Dh ** -0.5)
        p = _softmax(scores, axis=-1)
        o = torch.einsum("bhqk,bhkd->bhqd", p, v_cache)
        return (lambda x, *d: x.permute(*d))(o, 0, 2, 1, 3).reshape(B, Sq, H * Dh) @ wo

    a = _A_ref(A_x, A_k_cache, A_v_cache, A_wq, A_wo)
    b = _B_ref(B_x, B_k_cache, B_v_cache, B_wq, B_wo)
    return torch.concatenate([a, b], axis=-1)
```

```asm
; @launch grid=(256,1,1) block=(256,1,1) lds=163840
.amdgcn_target "amdgcn-amd-amdhsa--gfx950"
.text
.text
.globl concat_heads__mha_block_cached__mha_block_cached__near_ridge_kernel
.p2align 8
.type concat_heads__mha_block_cached__mha_block_cached__near_ridge_kernel,@function
concat_heads__mha_block_cached__mha_block_cached__near_ridge_kernel:
s_cmp_ge_u32 s2, 256
s_cbranch_scc1 L_k1_end
s_and_b32 s14, s2, 7
s_lshr_b32 s46, s14, 2
s_mul_i32 s3, s46, 40
s_load_dwordx8 s[4:11], s[0:1], s3
s_load_dwordx2 s[12:13], s[0:1], 96
s_load_dwordx2 s[76:77], s[0:1], 88
s_load_dwordx2 s[96:97], s[0:1], s3 offset:32
s_memrealtime s[98:99]
v_lshrrev_b32 v2, 6, v0
v_and_b32 v1, 63, v0
s_lshr_b32 s15, s2, 3
v_readfirstlane_b32 s36, v2
v_and_b32 v2, 15, v1
v_lshrrev_b32 v3, 4, v1
s_and_b32 s47, s14, 3
s_lshl_b32 s47, s47, 3
s_and_b32 s48, s15, 7
s_add_u32 s47, s47, s48
s_lshr_b32 s48, s15, 3
s_lshl_b32 s39, s36, 12
s_lshr_b32 s49, s15, 4
s_lshl_b32 s49, s49, 3
s_and_b32 s43, s15, 7
s_add_u32 s49, s49, s43
s_lshl_b32 s49, s49, 2
s_add_u32 s49, s49, s36
v_mul_u32_u24 v41, 43, v1
v_lshrrev_b32 v41, 9, v41
v_mul_u32_u24 v42, 12, v41
v_sub_u32 v42, v1, v42
v_mul_u32_u24 v42, 1280, v42
v_lshlrev_b32 v41, 7, v41
v_add_u32 v40, v41, v42
v_lshlrev_b32 v41, 19, v3
v_lshlrev_b32 v42, 7, v2
v_add_u32 v42, v41, v42
v_lshlrev_b32 v46, 8, v3
v_add_u32 v46, s39, v46
v_add_u32 v47, 0, v3
v_xor_b32 v47, v2, v47
v_lshlrev_b32 v47, 4, v47
v_add_u32 v4, v46, v47
v_add_u32 v47, 4, v3
v_xor_b32 v47, v2, v47
v_lshlrev_b32 v47, 4, v47
v_add_u32 v5, v46, v47
v_add_u32 v47, 8, v3
v_xor_b32 v47, v2, v47
v_lshlrev_b32 v47, 4, v47
v_add_u32 v6, v46, v47
v_add_u32 v47, 12, v3
v_xor_b32 v47, v2, v47
v_lshlrev_b32 v47, 4, v47
v_add_u32 v7, v46, v47
s_mul_i32 s42, s36, 6144
v_lshrrev_b32 v48, 3, v1
s_mul_i32 s43, s36, 48
v_add_u32 v48, s43, v48
v_mul_u32_u24 v48, 1280, v48
v_and_b32 v49, 7, v1
v_xor_b32 v50, v49, v3
v_xor_b32 v51, 4, v50
v_lshlrev_b32 v50, 4, v50
v_lshlrev_b32 v51, 4, v51
v_add_u32 v164, v48, v50
v_add_u32 v165, 9216, v48
v_add_u32 v165, v165, v51
v_add_u32 v166, 18432, v48
v_add_u32 v166, v166, v50
v_add_u32 v167, 27648, v48
v_add_u32 v167, v167, v51
v_add_u32 v168, 40960, v48
v_add_u32 v168, v168, v50
v_add_u32 v169, 50176, v48
v_add_u32 v169, v169, v51
s_lshl_b32 s43, s36, 4
v_add_u32 v48, s43, v3
v_lshlrev_b32 v48, 13, v48
v_lshlrev_b32 v49, 1, v3
v_xor_b32 v50, v2, v49
v_xor_b32 v51, 8, v50
v_lshlrev_b32 v50, 4, v50
v_lshlrev_b32 v51, 4, v51
v_add_u32 v160, v48, v50
v_add_u32 v161, 31744, v48
v_add_u32 v161, v161, v50
v_add_u32 v162, 63488, v48
v_add_u32 v162, v162, v51
v_add_u32 v163, 95232, v48
v_add_u32 v163, v163, v51
s_mul_i32 s50, s49, 15360
s_lshl_b32 s51, s49, 13
s_and_b32 s3, s14, 3
s_lshl_b32 s3, s3, 11
s_lshl_b32 s43, s48, 6
s_add_u32 s43, s43, s47
s_lshl_b32 s43, s43, 17
s_waitcnt lgkmcnt(0)
s_mov_b32 s88, s4
s_and_b32 s89, s5, 0xffff
s_mov_b32 s90, 983040
s_mov_b32 s91, 0x20000
s_add_u32 s92, s10, s3
s_addc_u32 s93, s11, 0
s_and_b32 s93, s93, 0xffff
s_sub_u32 s94, 5242880, s3
s_mov_b32 s95, 0x20000
s_add_u32 s20, s6, s43
s_addc_u32 s21, s7, 0
s_and_b32 s21, s21, 0xffff
s_sub_u32 s22, 33554432, s43
s_mov_b32 s23, 0x20000
s_mul_i32 s43, s48, 245760
s_add_u32 s16, s4, s43
s_addc_u32 s17, s5, 0
s_and_b32 s17, s17, 0xffff
s_mov_b32 s18, 245760
s_mov_b32 s19, 0x20000
s_lshl_b32 s43, s47, 8
s_add_u32 s28, s10, s43
s_addc_u32 s29, s11, 0
s_and_b32 s29, s29, 0xffff
s_sub_u32 s30, 5242880, s43
s_mov_b32 s31, 0x20000
s_and_b32 s43, s48, 1
s_cmp_eq_u32 s43, 1
s_cbranch_scc1 L_headB
s_mov_b32 exec_lo, 0xffffffff
s_mov_b32 exec_hi, 0xfffffff
s_add_u32 s43, s50, 0
buffer_load_dword v60, v40, s[88:91], s43 offen
s_mov_b32 exec_lo, 0xffffffff
s_mov_b32 exec_hi, 0xffffffff
s_add_u32 s43, s51, 0
buffer_load_dword v61, v42, s[92:95], s43 offen
s_mov_b32 exec_lo, 0xffffffff
s_mov_b32 exec_hi, 0xffffffff
s_add_u32 s43, s51, 2097152
buffer_load_dword v61, v42, s[92:95], s43 offen
s_mov_b32 exec_lo, 0xffffffff
s_mov_b32 exec_hi, 0xfffffff
s_add_u32 s43, s50, 640
buffer_load_dword v60, v40, s[88:91], s43 offen
s_mov_b32 exec_lo, 0xffffffff
s_mov_b32 exec_hi, 0x0
s_add_u32 s43, s51, 4194304
buffer_load_dword v61, v42, s[92:95], s43 offen
s_mov_b64 exec, -1
s_mov_b32 s44, 0
s_add_u32 m0, s42, 73728
s_nop 0
buffer_load_dwordx4 v164, s[16:19], s44 offen offset:0 lds
buffer_load_dwordx4 v165, s[16:19], s44 offen offset:1024 lds
buffer_load_dwordx4 v166, s[16:19], s44 offen offset:2048 lds
buffer_load_dwordx4 v167, s[16:19], s44 offen offset:3072 lds
s_add_u32 m0, s42, 77824
s_nop 0
buffer_load_dwordx4 v168, s[16:19], s44 offen offset:0 lds
buffer_load_dwordx4 v169, s[16:19], s44 offen offset:1024 lds
s_add_u32 m0, s39, 98304
s_nop 0
buffer_load_dwordx4 v160, s[28:31], s44 offen offset:0 lds
buffer_load_dwordx4 v161, s[28:31], s44 offen offset:1024 lds
buffer_load_dwordx4 v162, s[28:31], s44 offen offset:2048 lds
buffer_load_dwordx4 v163, s[28:31], s44 offen offset:3072 lds
s_mov_b32 s44, 128
s_add_u32 m0, s42, 32768
s_nop 0
buffer_load_dwordx4 v164, s[16:19], s44 offen offset:0 lds
buffer_load_dwordx4 v165, s[16:19], s44 offen offset:1024 lds
buffer_load_dwordx4 v166, s[16:19], s44 offen offset:2048 lds
buffer_load_dwordx4 v167, s[16:19], s44 offen offset:3072 lds
s_add_u32 m0, s42, 36864
s_nop 0
buffer_load_dwordx4 v168, s[16:19], s44 offen offset:0 lds
buffer_load_dwordx4 v169, s[16:19], s44 offen offset:1024 lds
s_mov_b32 s44, 524288
s_add_u32 m0, s39, 57344
s_nop 0
buffer_load_dwordx4 v160, s[28:31], s44 offen offset:0 lds
buffer_load_dwordx4 v161, s[28:31], s44 offen offset:1024 lds
buffer_load_dwordx4 v162, s[28:31], s44 offen offset:2048 lds
buffer_load_dwordx4 v163, s[28:31], s44 offen offset:3072 lds
s_and_b32 s37, s36, 1
s_lshr_b32 s38, s36, 1
s_mov_b32 s40, 0x3e0293ee
s_mov_b32 s41, 0x3e0293ee
s_lshl_b32 s43, s48, 6
s_add_u32 s43, s43, s47
s_lshl_b32 s43, s43, 17
s_add_u32 s24, s8, s43
s_addc_u32 s25, s9, 0
s_and_b32 s25, s25, 0xffff
s_sub_u32 s26, 33554432, s43
s_mov_b32 s27, 0x20000
s_mul_i32 s43, s46, 6291456
s_add_u32 s32, s12, s43
s_addc_u32 s33, s13, 0
s_and_b32 s33, s33, 0xffff
s_mov_b32 s34, 6291456
s_mov_b32 s35, 0x20000
v_lshlrev_b32 v46, 8, v3
v_add_u32 v46, s39, v46
v_add_u32 v41, 0, v3
v_lshlrev_b32 v41, 1, v41
v_xor_b32 v41, v2, v41
v_lshlrev_b32 v41, 4, v41
v_add_u32 v8, v46, v41
v_add_u32 v41, 4, v3
v_lshlrev_b32 v41, 1, v41
v_xor_b32 v41, v2, v41
v_lshlrev_b32 v41, 4, v41
v_add_u32 v9, v46, v41
s_lshl_b32 s43, s38, 5
v_add_u32 v40, s43, v2
v_lshlrev_b32 v40, 8, v40
v_xor_b32 v41, v3, v2
v_lshlrev_b32 v41, 4, v41
v_add_u32 v10, v40, v41
v_lshrrev_b32 v42, 2, v2
v_and_b32 v43, 3, v2
v_lshlrev_b32 v44, 2, v3
v_add_u32 v44, v44, v42
v_add_u32 v40, s43, v44
v_lshlrev_b32 v40, 8, v40
v_and_b32 v45, 7, v44
s_lshl_b32 s51, s38, 2
v_xor_b32 v45, s51, v45
v_lshlrev_b32 v45, 5, v45
v_lshlrev_b32 v46, 3, v43
v_add3_u32 v11, v40, v45, v46
v_lshlrev_b32 v12, 4, v1
s_mul_i32 s43, s37, 6144
v_lshrrev_b32 v40, 3, v2
v_lshlrev_b32 v40, 10, v40
v_and_b32 v41, 7, v2
v_lshlrev_b32 v41, 7, v41
v_lshrrev_b32 v47, 1, v2
v_and_b32 v47, 7, v47
v_xor_b32 v47, v3, v47
v_lshlrev_b32 v47, 4, v47
v_add3_u32 v170, v40, v41, v47
v_add_u32 v170, s43, v170
v_lshlrev_b32 v40, 3, v3
v_add_u32 v40, v40, v42
v_lshlrev_b32 v40, 8, v40
v_and_b32 v41, 1, v3
v_lshlrev_b32 v41, 2, v41
v_add_u32 v41, v41, v42
v_xor_b32 v41, s51, v41
v_lshlrev_b32 v41, 5, v41
v_add3_u32 v171, v40, v41, v46
v_add_u32 v171, 24576, v171
s_mov_b32 s80, s76
s_and_b32 s81, s77, 0xffff
s_mov_b32 s82, 256
s_mov_b32 s83, 0x20000
s_add_u32 s84, s12, 25165824
s_addc_u32 s85, s13, 0
s_and_b32 s85, s85, 0xffff
s_mov_b32 s86, 65536
s_mov_b32 s87, 0x20000
s_or_b32 s79, s98, 1
v_add_u32 v57, s36, v1
v_add_u32 v57, s2, v57
v_cmp_eq_u32 vcc, 0, v57
v_mov_b32 v56, 0x1000
v_mov_b32 v58, 0
v_cndmask_b32 v57, v56, v58, vcc
v_mov_b32 v58, s79
buffer_store_dword v58, v57, s[80:83], 0 offen sc1
v_mov_b32 v40, 0x3f803f80
v_accvgpr_write_b32 a176, v40
v_accvgpr_write_b32 a177, v40
v_accvgpr_write_b32 a178, v40
v_accvgpr_write_b32 a179, v40
v_add_u32 v13, 73728, v170
v_xor_b32 v14, 64, v13
v_add_u32 v22, 73728, v171
v_xor_b32 v23, 32, v22
v_xor_b32 v24, 64, v22
v_xor_b32 v25, 96, v22
v_add_u32 v15, 32768, v170
v_xor_b32 v16, 64, v15
v_add_u32 v26, 32768, v171
v_xor_b32 v27, 32, v26
v_xor_b32 v28, 64, v26
v_xor_b32 v29, 96, v26
v_add_u32 v17, 114688, v170
v_xor_b32 v18, 64, v17
v_add_u32 v30, 114688, v171
v_xor_b32 v31, 32, v30
v_xor_b32 v32, 64, v30
v_xor_b32 v33, 96, v30
s_waitcnt vmcnt(10)
s_barrier
s_mov_b32 s44, 256
s_add_u32 m0, s42, 114688
s_nop 0
buffer_load_dwordx4 v164, s[16:19], s44 offen offset:0 lds
buffer_load_dwordx4 v165, s[16:19], s44 offen offset:1024 lds
buffer_load_dwordx4 v166, s[16:19], s44 offen offset:2048 lds
buffer_load_dwordx4 v167, s[16:19], s44 offen offset:3072 lds
s_add_u32 m0, s42, 118784
s_nop 0
buffer_load_dwordx4 v168, s[16:19], s44 offen offset:0 lds
buffer_load_dwordx4 v169, s[16:19], s44 offen offset:1024 lds
s_mov_b32 s44, 1048576
s_add_u32 m0, s39, 139264
s_nop 0
buffer_load_dwordx4 v160, s[28:31], s44 offen offset:0 lds
buffer_load_dwordx4 v161, s[28:31], s44 offen offset:1024 lds
buffer_load_dwordx4 v162, s[28:31], s44 offen offset:2048 lds
buffer_load_dwordx4 v163, s[28:31], s44 offen offset:3072 lds
ds_read_b64_tr_b16 a[96:97], v22 offset:0
ds_read_b64_tr_b16 a[98:99], v22 offset:1024
ds_read_b64_tr_b16 a[100:101], v23 offset:0
ds_read_b64_tr_b16 a[102:103], v23 offset:1024
ds_read_b64_tr_b16 a[104:105], v24 offset:0
ds_read_b64_tr_b16 a[106:107], v24 offset:1024
ds_read_b64_tr_b16 a[108:109], v25 offset:0
ds_read_b64_tr_b16 a[110:111], v25 offset:1024
ds_read_b128 a[112:115], v13 offset:0
ds_read_b128 a[116:119], v13 offset:2048
ds_read_b128 a[120:123], v13 offset:4096
ds_read_b128 a[124:127], v13 offset:12288
ds_read_b128 a[128:131], v13 offset:14336
ds_read_b128 a[132:135], v13 offset:16384
s_waitcnt lgkmcnt(0)
v_mfma_f32_16x16x32_bf16 v[64:67], a[96:99], a[112:115], 0
ds_read_b64_tr_b16 a[136:137], v22 offset:8192
v_mfma_f32_16x16x32_bf16 v[68:71], a[96:99], a[116:119], 0
ds_read_b64_tr_b16 a[138:139], v22 offset:9216
v_mfma_f32_16x16x32_bf16 v[72:75], a[96:99], a[120:123], 0
ds_read_b64_tr_b16 a[140:141], v23 offset:8192
v_mfma_f32_16x16x32_bf16 v[76:79], a[96:99], a[124:127], 0
ds_read_b64_tr_b16 a[142:143], v23 offset:9216
v_mfma_f32_16x16x32_bf16 v[80:83], a[96:99], a[128:131], 0
ds_read_b64_tr_b16 a[144:145], v24 offset:8192
v_mfma_f32_16x16x32_bf16 v[84:87], a[96:99], a[132:135], 0
ds_read_b64_tr_b16 a[146:147], v24 offset:9216
v_mfma_f32_16x16x32_bf16 v[88:91], a[100:103], a[112:115], 0
ds_read_b64_tr_b16 a[148:149], v25 offset:8192
ds_read_b64_tr_b16 a[150:151], v25 offset:9216
v_mfma_f32_16x16x32_bf16 v[92:95], a[100:103], a[116:119], 0
ds_read_b128 a[152:155], v14 offset:0
v_mfma_f32_16x16x32_bf16 v[96:99], a[100:103], a[120:123], 0
ds_read_b128 a[156:159], v14 offset:2048
v_mfma_f32_16x16x32_bf16 v[100:103], a[100:103], a[124:127], 0
ds_read_b128 a[160:163], v14 offset:4096
v_mfma_f32_16x16x32_bf16 v[104:107], a[100:103], a[128:131], 0
ds_read_b128 a[164:167], v14 offset:12288
v_mfma_f32_16x16x32_bf16 v[108:111], a[100:103], a[132:135], 0
ds_read_b128 a[168:171], v14 offset:14336
v_mfma_f32_16x16x32_bf16 v[112:115], a[104:107], a[112:115], 0
ds_read_b128 a[172:175], v14 offset:16384
v_mfma_f32_16x16x32_bf16 v[116:119], a[104:107], a[116:119], 0
v_mfma_f32_16x16x32_bf16 v[120:123], a[104:107], a[120:123], 0
v_mfma_f32_16x16x32_bf16 v[124:127], a[104:107], a[124:127], 0
v_mfma_f32_16x16x32_bf16 v[128:131], a[104:107], a[128:131], 0
v_mfma_f32_16x16x32_bf16 v[132:135], a[104:107], a[132:135], 0
v_mfma_f32_16x16x32_bf16 v[136:139], a[108:111], a[112:115], 0
v_mfma_f32_16x16x32_bf16 v[140:143], a[108:111], a[116:119], 0
v_mfma_f32_16x16x32_bf16 v[144:147], a[108:111], a[120:123], 0
v_mfma_f32_16x16x32_bf16 v[148:151], a[108:111], a[124:127], 0
v_mfma_f32_16x16x32_bf16 v[152:155], a[108:111], a[128:131], 0
v_mfma_f32_16x16x32_bf16 v[156:159], a[108:111], a[132:135], 0
s_waitcnt lgkmcnt(0)
s_waitcnt vmcnt(10)
s_barrier
s_mov_b32 s44, 384
s_add_u32 m0, s42, 73728
s_nop 0
buffer_load_dwordx4 v164, s[16:19], s44 offen offset:0 lds
v_mfma_f32_16x16x32_bf16 v[64:67], a[136:139], a[152:155], v[64:67]
ds_read_b64_tr_b16 a[96:97], v26 offset:0
v_mfma_f32_16x16x32_bf16 v[68:71], a[136:139], a[156:159], v[68:71]
ds_read_b64_tr_b16 a[98:99], v26 offset:1024
v_mfma_f32_16x16x32_bf16 v[72:75], a[136:139], a[160:163], v[72:75]
buffer_load_dwordx4 v165, s[16:19], s44 offen offset:1024 lds
ds_read_b64_tr_b16 a[100:101], v27 offset:0
v_mfma_f32_16x16x32_bf16 v[76:79], a[136:139], a[164:167], v[76:79]
ds_read_b64_tr_b16 a[102:103], v27 offset:1024
v_mfma_f32_16x16x32_bf16 v[80:83], a[136:139], a[168:171], v[80:83]
ds_read_b64_tr_b16 a[104:105], v28 offset:0
v_mfma_f32_16x16x32_bf16 v[84:87], a[136:139], a[172:175], v[84:87]
ds_read_b64_tr_b16 a[106:107], v28 offset:1024
buffer_load_dwordx4 v166, s[16:19], s44 offen offset:2048 lds
v_mfma_f32_16x16x32_bf16 v[88:91], a[140:143], a[152:155], v[88:91]
ds_read_b64_tr_b16 a[108:109], v29 offset:0
ds_read_b64_tr_b16 a[110:111], v29 offset:1024
v_mfma_f32_16x16x32_bf16 v[92:95], a[140:143], a[156:159], v[92:95]
ds_read_b128 a[112:115], v15 offset:0
v_mfma_f32_16x16x32_bf16 v[96:99], a[140:143], a[160:163], v[96:99]
ds_read_b128 a[116:119], v15 offset:2048
buffer_load_dwordx4 v167, s[16:19], s44 offen offset:3072 lds
v_mfma_f32_16x16x32_bf16 v[100:103], a[140:143], a[164:167], v[100:103]
ds_read_b128 a[120:123], v15 offset:4096
v_mfma_f32_16x16x32_bf16 v[104:107], a[140:143], a[168:171], v[104:107]
ds_read_b128 a[124:127], v15 offset:12288
v_mfma_f32_16x16x32_bf16 v[108:111], a[140:143], a[172:175], v[108:111]
ds_read_b128 a[128:131], v15 offset:14336
v_mfma_f32_16x16x32_bf16 v[112:115], a[144:147], a[152:155], v[112:115]
s_add_u32 m0, s42, 77824
s_nop 0
buffer_load_dwordx4 v168, s[16:19], s44 offen offset:0 lds
ds_read_b128 a[132:135], v15 offset:16384
v_mfma_f32_16x16x32_bf16 v[116:119], a[144:147], a[156:159], v[116:119]
v_mfma_f32_16x16x32_bf16 v[120:123], a[144:147], a[160:163], v[120:123]
v_mfma_f32_16x16x32_bf16 v[124:127], a[144:147], a[164:167], v[124:127]
buffer_load_dwordx4 v169, s[16:19], s44 offen offset:1024 lds
v_mfma_f32_16x16x32_bf16 v[128:131], a[144:147], a[168:171], v[128:131]
v_mfma_f32_16x16x32_bf16 v[132:135], a[144:147], a[172:175], v[132:135]
v_mfma_f32_16x16x32_bf16 v[136:139], a[148:151], a[152:155], v[136:139]
v_mfma_f32_16x16x32_bf16 v[140:143], a[148:151], a[156:159], v[140:143]
s_mov_b32 s44, 1572864
s_add_u32 m0, s39, 98304
s_nop 0
buffer_load_dwordx4 v160, s[28:31], s44 offen offset:0 lds
v_mfma_f32_16x16x32_bf16 v[144:147], a[148:151], a[160:163], v[144:147]
v_mfma_f32_16x16x32_bf16 v[148:151], a[148:151], a[164:167], v[148:151]
v_mfma_f32_16x16x32_bf16 v[152:155], a[148:151], a[168:171], v[152:155]
v_mfma_f32_16x16x32_bf16 v[156:159], a[148:151], a[172:175], v[156:159]
buffer_load_dwordx4 v161, s[28:31], s44 offen offset:1024 lds
s_waitcnt lgkmcnt(0)
v_mfma_f32_16x16x32_bf16 v[64:67], a[96:99], a[112:115], v[64:67]
ds_read_b64_tr_b16 a[136:137], v26 offset:8192
buffer_load_dwordx4 v162, s[28:31], s44 offen offset:2048 lds
v_mfma_f32_16x16x32_bf16 v[68:71], a[96:99], a[116:119], v[68:71]
ds_read_b64_tr_b16 a[138:139], v26 offset:9216
v_mfma_f32_16x16x32_bf16 v[72:75], a[96:99], a[120:123], v[72:75]
ds_read_b64_tr_b16 a[140:141], v27 offset:8192
v_mfma_f32_16x16x32_bf16 v[76:79], a[96:99], a[124:127], v[76:79]
ds_read_b64_tr_b16 a[142:143], v27 offset:9216
v_mfma_f32_16x16x32_bf16 v[80:83], a[96:99], a[128:131], v[80:83]
buffer_load_dwordx4 v163, s[28:31], s44 offen offset:3072 lds
ds_read_b64_tr_b16 a[144:145], v28 offset:8192
v_mfma_f32_16x16x32_bf16 v[84:87], a[96:99], a[132:135], v[84:87]
ds_read_b64_tr_b16 a[146:147], v28 offset:9216
v_mfma_f32_16x16x32_bf16 v[88:91], a[100:103], a[112:115], v[88:91]
ds_read_b64_tr_b16 a[148:149], v29 offset:8192
ds_read_b64_tr_b16 a[150:151], v29 offset:9216
v_mfma_f32_16x16x32_bf16 v[92:95], a[100:103], a[116:119], v[92:95]
ds_read_b128 a[152:155], v16 offset:0
v_mfma_f32_16x16x32_bf16 v[96:99], a[100:103], a[120:123], v[96:99]
ds_read_b128 a[156:159], v16 offset:2048
v_mfma_f32_16x16x32_bf16 v[100:103], a[100:103], a[124:127], v[100:103]
ds_read_b128 a[160:163], v16 offset:4096
v_mfma_f32_16x16x32_bf16 v[104:107], a[100:103], a[128:131], v[104:107]
ds_read_b128 a[164:167], v16 offset:12288
v_mfma_f32_16x16x32_bf16 v[108:111], a[100:103], a[132:135], v[108:111]
ds_read_b128 a[168:171], v16 offset:14336
v_mfma_f32_16x16x32_bf16 v[112:115], a[104:107], a[112:115], v[112:115]
ds_read_b128 a[172:175], v16 offset:16384
v_mfma_f32_16x16x32_bf16 v[116:119], a[104:107], a[116:119], v[116:119]
v_mfma_f32_16x16x32_bf16 v[120:123], a[104:107], a[120:123], v[120:123]
v_mfma_f32_16x16x32_bf16 v[124:127], a[104:107], a[124:127], v[124:127]
v_mfma_f32_16x16x32_bf16 v[128:131], a[104:107], a[128:131], v[128:131]
v_mfma_f32_16x16x32_bf16 v[132:135], a[104:107], a[132:135], v[132:135]
v_mfma_f32_16x16x32_bf16 v[136:139], a[108:111], a[112:115], v[136:139]
v_mfma_f32_16x16x32_bf16 v[140:143], a[108:111], a[116:119], v[140:143]
v_mfma_f32_16x16x32_bf16 v[144:147], a[108:111], a[120:123], v[144:147]
v_mfma_f32_16x16x32_bf16 v[148:151], a[108:111], a[124:127], v[148:151]
v_mfma_f32_16x16x32_bf16 v[152:155], a[108:111], a[128:131], v[152:155]
v_mfma_f32_16x16x32_bf16 v[156:159], a[108:111], a[132:135], v[156:159]
s_waitcnt lgkmcnt(0)
s_waitcnt vmcnt(10)
s_barrier
s_mov_b32 s44, 512
s_add_u32 m0, s42, 32768
s_nop 0
buffer_load_dwordx4 v164, s[16:19], s44 offen offset:0 lds
v_mfma_f32_16x16x32_bf16 v[64:67], a[136:139], a[152:155], v[64:67]
ds_read_b64_tr_b16 a[96:97], v30 offset:0
v_mfma_f32_16x16x32_bf16 v[68:71], a[136:139], a[156:159], v[68:71]
ds_read_b64_tr_b16 a[98:99], v30 offset:1024
v_mfma_f32_16x16x32_bf16 v[72:75], a[136:139], a[160:163], v[72:75]
buffer_load_dwordx4 v165, s[16:19], s44 offen offset:1024 lds
ds_read_b64_tr_b16 a[100:101], v31 offset:0
v_mfma_f32_16x16x32_bf16 v[76:79], a[136:139], a[164:167], v[76:79]
ds_read_b64_tr_b16 a[102:103], v31 offset:1024
v_mfma_f32_16x16x32_bf16 v[80:83], a[136:139], a[168:171], v[80:83]
ds_read_b64_tr_b16 a[104:105], v32 offset:0
v_mfma_f32_16x16x32_bf16 v[84:87], a[136:139], a[172:175], v[84:87]
ds_read_b64_tr_b16 a[106:107], v32 offset:1024
buffer_load_dwordx4 v166, s[16:19], s44 offen offset:2048 lds
v_mfma_f32_16x16x32_bf16 v[88:91], a[140:143], a[152:155], v[88:91]
ds_read_b64_tr_b16 a[108:109], v33 offset:0
ds_read_b64_tr_b16 a[110:111], v33 offset:1024
v_mfma_f32_16x16x32_bf16 v[92:95], a[140:143], a[156:159], v[92:95]
ds_read_b128 a[112:115], v17 offset:0
v_mfma_f32_16x16x32_bf16 v[96:99], a[140:143], a[160:163], v[96:99]
ds_read_b128 a[116:119], v17 offset:2048
buffer_load_dwordx4 v167, s[16:19], s44 offen offset:3072 lds
v_mfma_f32_16x16x32_bf16 v[100:103], a[140:143], a[164:167], v[100:103]
ds_read_b128 a[120:123], v17 offset:4096
v_mfma_f32_16x16x32_bf16 v[104:107], a[140:143], a[168:171], v[104:107]
ds_read_b128 a[124:127], v17 offset:12288
v_mfma_f32_16x16x32_bf16 v[108:111], a[140:143], a[172:175], v[108:111]
ds_read_b128 a[128:131], v17 offset:14336
v_mfma_f32_16x16x32_bf16 v[112:115], a[144:147], a[152:155], v[112:115]
s_add_u32 m0, s42, 36864
s_nop 0
buffer_load_dwordx4 v168, s[16:19], s44 offen offset:0 lds
ds_read_b128 a[132:135], v17 offset:16384
v_mfma_f32_16x16x32_bf16 v[116:119], a[144:147], a[156:159], v[116:119]
v_mfma_f32_16x16x32_bf16 v[120:123], a[144:147], a[160:163], v[120:123]
v_mfma_f32_16x16x32_bf16 v[124:127], a[144:147], a[164:167], v[124:127]
buffer_load_dwordx4 v169, s[16:19], s44 offen offset:1024 lds
v_mfma_f32_16x16x32_bf16 v[128:131], a[144:147], a[168:171], v[128:131]
v_mfma_f32_16x16x32_bf16 v[132:135], a[144:147], a[172:175], v[132:135]
v_mfma_f32_16x16x32_bf16 v[136:139], a[148:151], a[152:155], v[136:139]
v_mfma_f32_16x16x32_bf16 v[140:143], a[148:151], a[156:159], v[140:143]
s_mov_b32 s44, 2097152
s_add_u32 m0, s39, 57344
s_nop 0
buffer_load_dwordx4 v160, s[28:31], s44 offen offset:0 lds
v_mfma_f32_16x16x32_bf16 v[144:147], a[148:151], a[160:163], v[144:147]
v_mfma_f32_16x16x32_bf16 v[148:151], a[148:151], a[164:167], v[148:151]
v_mfma_f32_16x16x32_bf16 v[152:155], a[148:151], a[168:171], v[152:155]
v_mfma_f32_16x16x32_bf16 v[156:159], a[148:151], a[172:175], v[156:159]
buffer_load_dwordx4 v161, s[28:31], s44 offen offset:1024 lds
s_waitcnt lgkmcnt(0)
v_mfma_f32_16x16x32_bf16 v[64:67], a[96:99], a[112:115], v[64:67]
ds_read_b64_tr_b16 a[136:137], v30 offset:8192
buffer_load_dwordx4 v162, s[28:31], s44 offen offset:2048 lds
v_mfma_f32_16x16x32_bf16 v[68:71], a[96:99], a[116:119], v[68:71]
ds_read_b64_tr_b16 a[138:139], v30 offset:9216
v_mfma_f32_16x16x32_bf16 v[72:75], a[96:99], a[120:123], v[72:75]
ds_read_b64_tr_b16 a[140:141], v31 offset:8192
v_mfma_f32_16x16x32_bf16 v[76:79], a[96:99], a[124:127], v[76:79]
ds_read_b64_tr_b16 a[142:143], v31 offset:9216
v_mfma_f32_16x16x32_bf16 v[80:83], a[96:99], a[128:131], v[80:83]
buffer_load_dwordx4 v163, s[28:31], s44 offen offset:3072 lds
ds_read_b64_tr_b16 a[144:145], v32 offset:8192
v_mfma_f32_16x16x32_bf16 v[84:87], a[96:99], a[132:135], v[84:87]
ds_read_b64_tr_b16 a[146:147], v32 offset:9216
v_mfma_f32_16x16x32_bf16 v[88:91], a[100:103], a[112:115], v[88:91]
ds_read_b64_tr_b16 a[148:149], v33 offset:8192
ds_read_b64_tr_b16 a[150:151], v33 offset:9216
v_mfma_f32_16x16x32_bf16 v[92:95], a[100:103], a[116:119], v[92:95]
ds_read_b128 a[152:155], v18 offset:0
v_mfma_f32_16x16x32_bf16 v[96:99], a[100:103], a[120:123], v[96:99]
ds_read_b128 a[156:159], v18 offset:2048
v_mfma_f32_16x16x32_bf16 v[100:103], a[100:103], a[124:127], v[100:103]
ds_read_b128 a[160:163], v18 offset:4096
v_mfma_f32_16x16x32_bf16 v[104:107], a[100:103], a[128:131], v[104:107]
ds_read_b128 a[164:167], v18 offset:12288
v_mfma_f32_16x16x32_bf16 v[108:111], a[100:103], a[132:135], v[108:111]
ds_read_b128 a[168:171], v18 offset:14336
v_mfma_f32_16x16x32_bf16 v[112:115], a[104:107], a[112:115], v[112:115]
ds_read_b128 a[172:175], v18 offset:16384
v_mfma_f32_16x16x32_bf16 v[116:119], a[104:107], a[116:119], v[116:119]
v_mfma_f32_16x16x32_bf16 v[120:123], a[104:107], a[120:123], v[120:123]
v_mfma_f32_16x16x32_bf16 v[124:127], a[104:107], a[124:127], v[124:127]
v_mfma_f32_16x16x32_bf16 v[128:131], a[104:107], a[128:131], v[128:131]
v_mfma_f32_16x16x32_bf16 v[132:135], a[104:107], a[132:135], v[132:135]
v_mfma_f32_16x16x32_bf16 v[136:139], a[108:111], a[112:115], v[136:139]
v_mfma_f32_16x16x32_bf16 v[140:143], a[108:111], a[116:119], v[140:143]
v_mfma_f32_16x16x32_bf16 v[144:147], a[108:111], a[120:123], v[144:147]
v_mfma_f32_16x16x32_bf16 v[148:151], a[108:111], a[124:127], v[148:151]
v_mfma_f32_16x16x32_bf16 v[152:155], a[108:111], a[128:131], v[152:155]
v_mfma_f32_16x16x32_bf16 v[156:159], a[108:111], a[132:135], v[156:159]
s_waitcnt lgkmcnt(0)
s_waitcnt vmcnt(10)
s_barrier
s_mov_b32 s44, 640
s_add_u32 m0, s42, 114688
s_nop 0
buffer_load_dwordx4 v164, s[16:19], s44 offen offset:0 lds
v_mfma_f32_16x16x32_bf16 v[64:67], a[136:139], a[152:155], v[64:67]
ds_read_b64_tr_b16 a[96:97], v22 offset:0
v_mfma_f32_16x16x32_bf16 v[68:71], a[136:139], a[156:159], v[68:71]
ds_read_b64_tr_b16 a[98:99], v22 offset:1024
v_mfma_f32_16x16x32_bf16 v[72:75], a[136:139], a[160:163], v[72:75]
buffer_load_dwordx4 v165, s[16:19], s44 offen offset:1024 lds
ds_read_b64_tr_b16 a[100:101], v23 offset:0
v_mfma_f32_16x16x32_bf16 v[76:79], a[136:139], a[164:167], v[76:79]
ds_read_b64_tr_b16 a[102:103], v23 offset:1024
v_mfma_f32_16x16x32_bf16 v[80:83], a[136:139], a[168:171], v[80:83]
ds_read_b64_tr_b16 a[104:105], v24 offset:0
v_mfma_f32_16x16x32_bf16 v[84:87], a[136:139], a[172:175], v[84:87]
ds_read_b64_tr_b16 a[106:107], v24 offset:1024
buffer_load_dwordx4 v166, s[16:19], s44 offen offset:2048 lds
v_mfma_f32_16x16x32_bf16 v[88:91], a[140:143], a[152:155], v[88:91]
ds_read_b64_tr_b16 a[108:109], v25 offset:0
ds_read_b64_tr_b16 a[110:111], v25 offset:1024
v_mfma_f32_16x16x32_bf16 v[92:95], a[140:143], a[156:159], v[92:95]
ds_read_b128 a[112:115], v13 offset:0
v_mfma_f32_16x16x32_bf16 v[96:99], a[140:143], a[160:163], v[96:99]
ds_read_b128 a[116:119], v13 offset:2048
buffer_load_dwordx4 v167, s[16:19], s44 offen offset:3072 lds
v_mfma_f32_16x16x32_bf16 v[100:103], a[140:143], a[164:167], v[100:103]
ds_read_b128 a[120:123], v13 offset:4096
v_mfma_f32_16x16x32_bf16 v[104:107], a[140:143], a[168:171], v[104:107]
ds_read_b128 a[124:127], v13 offset:12288
v_mfma_f32_16x16x32_bf16 v[108:111], a[140:143], a[172:175], v[108:111]
ds_read_b128 a[128:131], v13 offset:14336
v_mfma_f32_16x16x32_bf16 v[112:115], a[144:147], a[152:155], v[112:115]
s_add_u32 m0, s42, 118784
s_nop 0
buffer_load_dwordx4 v168, s[16:19], s44 offen offset:0 lds
ds_read_b128 a[132:135], v13 offset:16384
v_mfma_f32_16x16x32_bf16 v[116:119], a[144:147], a[156:159], v[116:119]
v_mfma_f32_16x16x32_bf16 v[120:123], a[144:147], a[160:163], v[120:123]
v_mfma_f32_16x16x32_bf16 v[124:127], a[144:147], a[164:167], v[124:127]
buffer_load_dwordx4 v169, s[16:19], s44 offen offset:1024 lds
v_mfma_f32_16x16x32_bf16 v[128:131], a[144:147], a[168:171], v[128:131]
v_mfma_f32_16x16x32_bf16 v[132:135], a[144:147], a[172:175], v[132:135]
v_mfma_f32_16x16x32_bf16 v[136:139], a[148:151], a[152:155], v[136:139]
v_mfma_f32_16x16x32_bf16 v[140:143], a[148:151], a[156:159], v[140:143]
s_mov_b32 s44, 2621440
s_add_u32 m0, s39, 139264
s_nop 0
buffer_load_dwordx4 v160, s[28:31], s44 offen offset:0 lds
v_mfma_f32_16x16x32_bf16 v[144:147], a[148:151], a[160:163], v[144:147]
v_mfma_f32_16x16x32_bf16 v[148:151], a[148:151], a[164:167], v[148:151]
v_mfma_f32_16x16x32_bf16 v[152:155], a[148:151], a[168:171], v[152:155]
v_mfma_f32_16x16x32_bf16 v[156:159], a[148:151], a[172:175], v[156:159]
buffer_load_dwordx4 v161, s[28:31], s44 offen offset:1024 lds
s_waitcnt lgkmcnt(0)
v_mfma_f32_16x16x32_bf16 v[64:67], a[96:99], a[112:115], v[64:67]
ds_read_b64_tr_b16 a[136:137], v22 offset:8192
buffer_load_dwordx4 v162, s[28:31], s44 offen offset:2048 lds
v_mfma_f32_16x16x32_bf16 v[68:71], a[96:99], a[116:119], v[68:71]
ds_read_b64_tr_b16 a[138:139], v22 offset:9216
v_mfma_f32_16x16x32_bf16 v[72:75], a[96:99], a[120:123], v[72:75]
ds_read_b64_tr_b16 a[140:141], v23 offset:8192
v_mfma_f32_16x16x32_bf16 v[76:79], a[96:99], a[124:127], v[76:79]
ds_read_b64_tr_b16 a[142:143], v23 offset:9216
v_mfma_f32_16x16x32_bf16 v[80:83], a[96:99], a[128:131], v[80:83]
buffer_load_dwordx4 v163, s[28:31], s44 offen offset:3072 lds
ds_read_b64_tr_b16 a[144:145], v24 offset:8192
v_mfma_f32_16x16x32_bf16 v[84:87], a[96:99], a[132:135], v[84:87]
ds_read_b64_tr_b16 a[146:147], v24 offset:9216
v_mfma_f32_16x16x32_bf16 v[88:91], a[100:103], a[112:115], v[88:91]
ds_read_b64_tr_b16 a[148:149], v25 offset:8192
ds_read_b64_tr_b16 a[150:151], v25 offset:9216
v_mfma_f32_16x16x32_bf16 v[92:95], a[100:103], a[116:119], v[92:95]
ds_read_b128 a[152:155], v14 offset:0
v_mfma_f32_16x16x32_bf16 v[96:99], a[100:103], a[120:123], v[96:99]
ds_read_b128 a[156:159], v14 offset:2048
v_mfma_f32_16x16x32_bf16 v[100:103], a[100:103], a[124:127], v[100:103]
ds_read_b128 a[160:163], v14 offset:4096
v_mfma_f32_16x16x32_bf16 v[104:107], a[100:103], a[128:131], v[104:107]
ds_read_b128 a[164:167], v14 offset:12288
v_mfma_f32_16x16x32_bf16 v[108:111], a[100:103], a[132:135], v[108:111]
ds_read_b128 a[168:171], v14 offset:14336
v_mfma_f32_16x16x32_bf16 v[112:115], a[104:107], a[112:115], v[112:115]
ds_read_b128 a[172:175], v14 offset:16384
v_mfma_f32_16x16x32_bf16 v[116:119], a[104:107], a[116:119], v[116:119]
v_mfma_f32_16x16x32_bf16 v[120:123], a[104:107], a[120:123], v[120:123]
v_mfma_f32_16x16x32_bf16 v[124:127], a[104:107], a[124:127], v[124:127]
v_mfma_f32_16x16x32_bf16 v[128:131], a[104:107], a[128:131], v[128:131]
v_mfma_f32_16x16x32_bf16 v[132:135], a[104:107], a[132:135], v[132:135]
v_mfma_f32_16x16x32_bf16 v[136:139], a[108:111], a[112:115], v[136:139]
v_mfma_f32_16x16x32_bf16 v[140:143], a[108:111], a[116:119], v[140:143]
v_mfma_f32_16x16x32_bf16 v[144:147], a[108:111], a[120:123], v[144:147]
v_mfma_f32_16x16x32_bf16 v[148:151], a[108:111], a[124:127], v[148:151]
v_mfma_f32_16x16x32_bf16 v[152:155], a[108:111], a[128:131], v[152:155]
v_mfma_f32_16x16x32_bf16 v[156:159], a[108:111], a[132:135], v[156:159]
s_waitcnt lgkmcnt(0)
s_waitcnt vmcnt(10)
s_barrier
s_mov_b32 s44, 768
s_add_u32 m0, s42, 73728
s_nop 0
buffer_load_dwordx4 v164, s[16:19], s44 offen offset:0 lds
v_mfma_f32_16x16x32_bf16 v[64:67], a[136:139], a[152:155], v[64:67]
ds_read_b64_tr_b16 a[96:97], v26 offset:0
v_mfma_f32_16x16x32_bf16 v[68:71], a[136:139], a[156:159], v[68:71]
ds_read_b64_tr_b16 a[98:99], v26 offset:1024
v_mfma_f32_16x16x32_bf16 v[72:75], a[136:139], a[160:163], v[72:75]
buffer_load_dwordx4 v165, s[16:19], s44 offen offset:1024 lds
ds_read_b64_tr_b16 a[100:101], v27 offset:0
v_mfma_f32_16x16x32_bf16 v[76:79], a[136:139], a[164:167], v[76:79]
ds_read_b64_tr_b16 a[102:103], v27 offset:1024
v_mfma_f32_16x16x32_bf16 v[80:83], a[136:139], a[168:171], v[80:83]
ds_read_b64_tr_b16 a[104:105], v28 offset:0
v_mfma_f32_16x16x32_bf16 v[84:87], a[136:139], a[172:175], v[84:87]
ds_read_b64_tr_b16 a[106:107], v28 offset:1024
buffer_load_dwordx4 v166, s[16:19], s44 offen offset:2048 lds
v_mfma_f32_16x16x32_bf16 v[88:91], a[140:143], a[152:155], v[88:91]
ds_read_b64_tr_b16 a[108:109], v29 offset:0
ds_read_b64_tr_b16 a[110:111], v29 offset:1024
v_mfma_f32_16x16x32_bf16 v[92:95], a[140:143], a[156:159], v[92:95]
ds_read_b128 a[112:115], v15 offset:0
v_mfma_f32_16x16x32_bf16 v[96:99], a[140:143], a[160:163], v[96:99]
ds_read_b128 a[116:119], v15 offset:2048
buffer_load_dwordx4 v167, s[16:19], s44 offen offset:3072 lds
v_mfma_f32_16x16x32_bf16 v[100:103], a[140:143], a[164:167], v[100:103]
ds_read_b128 a[120:123], v15 offset:4096
v_mfma_f32_16x16x32_bf16 v[104:107], a[140:143], a[168:171], v[104:107]
ds_read_b128 a[124:127], v15 offset:12288
v_mfma_f32_16x16x32_bf16 v[108:111], a[140:143], a[172:175], v[108:111]
ds_read_b128 a[128:131], v15 offset:14336
v_mfma_f32_16x16x32_bf16 v[112:115], a[144:147], a[152:155], v[112:115]
s_add_u32 m0, s42, 77824
s_nop 0
buffer_load_dwordx4 v168, s[16:19], s44 offen offset:0 lds
ds_read_b128 a[132:135], v15 offset:16384
v_mfma_f32_16x16x32_bf16 v[116:119], a[144:147], a[156:159], v[116:119]
v_mfma_f32_16x16x32_bf16 v[120:123], a[144:147], a[160:163], v[120:123]
v_mfma_f32_16x16x32_bf16 v[124:127], a[144:147], a[164:167], v[124:127]
buffer_load_dwordx4 v169, s[16:19], s44 offen offset:1024 lds
v_mfma_f32_16x16x32_bf16 v[128:131], a[144:147], a[168:171], v[128:131]
v_mfma_f32_16x16x32_bf16 v[132:135], a[144:147], a[172:175], v[132:135]
v_mfma_f32_16x16x32_bf16 v[136:139], a[148:151], a[152:155], v[136:139]
v_mfma_f32_16x16x32_bf16 v[140:143], a[148:151], a[156:159], v[140:143]
s_mov_b32 s44, 3145728
s_add_u32 m0, s39, 98304
s_nop 0
buffer_load_dwordx4 v160, s[28:31], s44 offen offset:0 lds
v_mfma_f32_16x16x32_bf16 v[144:147], a[148:151], a[160:163], v[144:147]
v_mfma_f32_16x16x32_bf16 v[148:151], a[148:151], a[164:167], v[148:151]
v_mfma_f32_16x16x32_bf16 v[152:155], a[148:151], a[168:171], v[152:155]
v_mfma_f32_16x16x32_bf16 v[156:159], a[148:151], a[172:175], v[156:159]
buffer_load_dwordx4 v161, s[28:31], s44 offen offset:1024 lds
s_waitcnt lgkmcnt(0)
v_mfma_f32_16x16x32_bf16 v[64:67], a[96:99], a[112:115], v[64:67]
ds_read_b64_tr_b16 a[136:137], v26 offset:8192
buffer_load_dwordx4 v162, s[28:31], s44 offen offset:2048 lds
v_mfma_f32_16x16x32_bf16 v[68:71], a[96:99], a[116:119], v[68:71]
ds_read_b64_tr_b16 a[138:139], v26 offset:9216
v_mfma_f32_16x16x32_bf16 v[72:75], a[96:99], a[120:123], v[72:75]
ds_read_b64_tr_b16 a[140:141], v27 offset:8192
v_mfma_f32_16x16x32_bf16 v[76:79], a[96:99], a[124:127], v[76:79]
ds_read_b64_tr_b16 a[142:143], v27 offset:9216
v_mfma_f32_16x16x32_bf16 v[80:83], a[96:99], a[128:131], v[80:83]
buffer_load_dwordx4 v163, s[28:31], s44 offen offset:3072 lds
ds_read_b64_tr_b16 a[144:145], v28 offset:8192
v_mfma_f32_16x16x32_bf16 v[84:87], a[96:99], a[132:135], v[84:87]
ds_read_b64_tr_b16 a[146:147], v28 offset:9216
v_mfma_f32_16x16x32_bf16 v[88:91], a[100:103], a[112:115], v[88:91]
ds_read_b64_tr_b16 a[148:149], v29 offset:8192
ds_read_b64_tr_b16 a[150:151], v29 offset:9216
v_mfma_f32_16x16x32_bf16 v[92:95], a[100:103], a[116:119], v[92:95]
ds_read_b128 a[152:155], v16 offset:0
v_mfma_f32_16x16x32_bf16 v[96:99], a[100:103], a[120:123], v[96:99]
ds_read_b128 a[156:159], v16 offset:2048
v_mfma_f32_16x16x32_bf16 v[100:103], a[100:103], a[124:127], v[100:103]
ds_read_b128 a[160:163], v16 offset:4096
v_mfma_f32_16x16x32_bf16 v[104:107], a[100:103], a[128:131], v[104:107]
ds_read_b128 a[164:167], v16 offset:12288
v_mfma_f32_16x16x32_bf16 v[108:111], a[100:103], a[132:135], v[108:111]
ds_read_b128 a[168:171], v16 offset:14336
v_mfma_f32_16x16x32_bf16 v[112:115], a[104:107], a[112:115], v[112:115]
ds_read_b128 a[172:175], v16 offset:16384
v_mfma_f32_16x16x32_bf16 v[116:119], a[104:107], a[116:119], v[116:119]
v_mfma_f32_16x16x32_bf16 v[120:123], a[104:107], a[120:123], v[120:123]
v_mfma_f32_16x16x32_bf16 v[124:127], a[104:107], a[124:127], v[124:127]
v_mfma_f32_16x16x32_bf16 v[128:131], a[104:107], a[128:131], v[128:131]
v_mfma_f32_16x16x32_bf16 v[132:135], a[104:107], a[132:135], v[132:135]
v_mfma_f32_16x16x32_bf16 v[136:139], a[108:111], a[112:115], v[136:139]
v_mfma_f32_16x16x32_bf16 v[140:143], a[108:111], a[116:119], v[140:143]
v_mfma_f32_16x16x32_bf16 v[144:147], a[108:111], a[120:123], v[144:147]
v_mfma_f32_16x16x32_bf16 v[148:151], a[108:111], a[124:127], v[148:151]
v_mfma_f32_16x16x32_bf16 v[152:155], a[108:111], a[128:131], v[152:155]
v_mfma_f32_16x16x32_bf16 v[156:159], a[108:111], a[132:135], v[156:159]
s_waitcnt lgkmcnt(0)
s_waitcnt vmcnt(10)
s_barrier
s_mov_b32 s44, 896
s_add_u32 m0, s42, 32768
s_nop 0
buffer_load_dwordx4 v164, s[16:19], s44 offen offset:0 lds
v_mfma_f32_16x16x32_bf16 v[64:67], a[136:139], a[152:155], v[64:67]
ds_read_b64_tr_b16 a[96:97], v30 offset:0
v_mfma_f32_16x16x32_bf16 v[68:71], a[136:139], a[156:159], v[68:71]
ds_read_b64_tr_b16 a[98:99], v30 offset:1024
v_mfma_f32_16x16x32_bf16 v[72:75], a[136:139], a[160:163], v[72:75]
buffer_load_dwordx4 v165, s[16:19], s44 offen offset:1024 lds
ds_read_b64_tr_b16 a[100:101], v31 offset:0
v_mfma_f32_16x16x32_bf16 v[76:79], a[136:139], a[164:167], v[76:79]
ds_read_b64_tr_b16 a[102:103], v31 offset:1024
v_mfma_f32_16x16x32_bf16 v[80:83], a[136:139], a[168:171], v[80:83]
ds_read_b64_tr_b16 a[104:105], v32 offset:0
v_mfma_f32_16x16x32_bf16 v[84:87], a[136:139], a[172:175], v[84:87]
ds_read_b64_tr_b16 a[106:107], v32 offset:1024
buffer_load_dwordx4 v166, s[16:19], s44 offen offset:2048 lds
v_mfma_f32_16x16x32_bf16 v[88:91], a[140:143], a[152:155], v[88:91]
ds_read_b64_tr_b16 a[108:109], v33 offset:0
ds_read_b64_tr_b16 a[110:111], v33 offset:1024
v_mfma_f32_16x16x32_bf16 v[92:95], a[140:143], a[156:159], v[92:95]
ds_read_b128 a[112:115], v17 offset:0
v_mfma_f32_16x16x32_bf16 v[96:99], a[140:143], a[160:163], v[96:99]
ds_read_b128 a[116:119], v17 offset:2048
buffer_load_dwordx4 v167, s[16:19], s44 offen offset:3072 lds
v_mfma_f32_16x16x32_bf16 v[100:103], a[140:143], a[164:167], v[100:103]
ds_read_b128 a[120:123], v17 offset:4096
v_mfma_f32_16x16x32_bf16 v[104:107], a[140:143], a[168:171], v[104:107]
ds_read_b128 a[124:127], v17 offset:12288
v_mfma_f32_16x16x32_bf16 v[108:111], a[140:143], a[172:175], v[108:111]
ds_read_b128 a[128:131], v17 offset:14336
v_mfma_f32_16x16x32_bf16 v[112:115], a[144:147], a[152:155], v[112:115]
s_add_u32 m0, s42, 36864
s_nop 0
buffer_load_dwordx4 v168, s[16:19], s44 offen offset:0 lds
ds_read_b128 a[132:135], v17 offset:16384
v_mfma_f32_16x16x32_bf16 v[116:119], a[144:147], a[156:159], v[116:119]
v_mfma_f32_16x16x32_bf16 v[120:123], a[144:147], a[160:163], v[120:123]
v_mfma_f32_16x16x32_bf16 v[124:127], a[144:147], a[164:167], v[124:127]
buffer_load_dwordx4 v169, s[16:19], s44 offen offset:1024 lds
v_mfma_f32_16x16x32_bf16 v[128:131], a[144:147], a[168:171], v[128:131]
v_mfma_f32_16x16x32_bf16 v[132:135], a[144:147], a[172:175], v[132:135]
v_mfma_f32_16x16x32_bf16 v[136:139], a[148:151], a[152:155], v[136:139]
v_mfma_f32_16x16x32_bf16 v[140:143], a[148:151], a[156:159], v[140:143]
s_mov_b32 s44, 3670016
s_add_u32 m0, s39, 57344
s_nop 0
buffer_load_dwordx4 v160, s[28:31], s44 offen offset:0 lds
v_mfma_f32_16x16x32_bf16 v[144:147], a[148:151], a[160:163], v[144:147]
v_mfma_f32_16x16x32_bf16 v[148:151], a[148:151], a[164:167], v[148:151]
v_mfma_f32_16x16x32_bf16 v[152:155], a[148:151], a[168:171], v[152:155]
v_mfma_f32_16x16x32_bf16 v[156:159], a[148:151], a[172:175], v[156:159]
buffer_load_dwordx4 v161, s[28:31], s44 offen offset:1024 lds
s_waitcnt lgkmcnt(0)
v_mfma_f32_16x16x32_bf16 v[64:67], a[96:99], a[112:115], v[64:67]
ds_read_b64_tr_b16 a[136:137], v30 offset:8192
buffer_load_dwordx4 v162, s[28:31], s44 offen offset:2048 lds
v_mfma_f32_16x16x32_bf16 v[68:71], a[96:99], a[116:119], v[68:71]
ds_read_b64_tr_b16 a[138:139], v30 offset:9216
v_mfma_f32_16x16x32_bf16 v[72:75], a[96:99], a[120:123], v[72:75]
ds_read_b64_tr_b16 a[140:141], v31 offset:8192
v_mfma_f32_16x16x32_bf16 v[76:79], a[96:99], a[124:127], v[76:79]
ds_read_b64_tr_b16 a[142:143], v31 offset:9216
v_mfma_f32_16x16x32_bf16 v[80:83], a[96:99], a[128:131], v[80:83]
buffer_load_dwordx4 v163, s[28:31], s44 offen offset:3072 lds
ds_read_b64_tr_b16 a[144:145], v32 offset:8192
v_mfma_f32_16x16x32_bf16 v[84:87], a[96:99], a[132:135], v[84:87]
ds_read_b64_tr_b16 a[146:147], v32 offset:9216
v_mfma_f32_16x16x32_bf16 v[88:91], a[100:103], a[112:115], v[88:91]
ds_read_b64_tr_b16 a[148:149], v33 offset:8192
ds_read_b64_tr_b16 a[150:151], v33 offset:9216
v_mfma_f32_16x16x32_bf16 v[92:95], a[100:103], a[116:119], v[92:95]
ds_read_b128 a[152:155], v18 offset:0
v_mfma_f32_16x16x32_bf16 v[96:99], a[100:103], a[120:123], v[96:99]
ds_read_b128 a[156:159], v18 offset:2048
v_mfma_f32_16x16x32_bf16 v[100:103], a[100:103], a[124:127], v[100:103]
ds_read_b128 a[160:163], v18 offset:4096
v_mfma_f32_16x16x32_bf16 v[104:107], a[100:103], a[128:131], v[104:107]
ds_read_b128 a[164:167], v18 offset:12288
v_mfma_f32_16x16x32_bf16 v[108:111], a[100:103], a[132:135], v[108:111]
ds_read_b128 a[168:171], v18 offset:14336
v_mfma_f32_16x16x32_bf16 v[112:115], a[104:107], a[112:115], v[112:115]
ds_read_b128 a[172:175], v18 offset:16384
v_mfma_f32_16x16x32_bf16 v[116:119], a[104:107], a[116:119], v[116:119]
v_mfma_f32_16x16x32_bf16 v[120:123], a[104:107], a[120:123], v[120:123]
v_mfma_f32_16x16x32_bf16 v[124:127], a[104:107], a[124:127], v[124:127]
v_mfma_f32_16x16x32_bf16 v[128:131], a[104:107], a[128:131], v[128:131]
v_mfma_f32_16x16x32_bf16 v[132:135], a[104:107], a[132:135], v[132:135]
v_mfma_f32_16x16x32_bf16 v[136:139], a[108:111], a[112:115], v[136:139]
v_mfma_f32_16x16x32_bf16 v[140:143], a[108:111], a[116:119], v[140:143]
v_mfma_f32_16x16x32_bf16 v[144:147], a[108:111], a[120:123], v[144:147]
v_mfma_f32_16x16x32_bf16 v[148:151], a[108:111], a[124:127], v[148:151]
v_mfma_f32_16x16x32_bf16 v[152:155], a[108:111], a[128:131], v[152:155]
v_mfma_f32_16x16x32_bf16 v[156:159], a[108:111], a[132:135], v[156:159]
s_waitcnt lgkmcnt(0)
s_waitcnt vmcnt(10)
s_barrier
s_mov_b32 s44, 1024
s_add_u32 m0, s42, 114688
s_nop 0
buffer_load_dwordx4 v164, s[16:19], s44 offen offset:0 lds
v_mfma_f32_16x16x32_bf16 v[64:67], a[136:139], a[152:155], v[64:67]
ds_read_b64_tr_b16 a[96:97], v22 offset:0
v_mfma_f32_16x16x32_bf16 v[68:71], a[136:139], a[156:159], v[68:71]
ds_read_b64_tr_b16 a[98:99], v22 offset:1024
v_mfma_f32_16x16x32_bf16 v[72:75], a[136:139], a[160:163], v[72:75]
buffer_load_dwordx4 v165, s[16:19], s44 offen offset:1024 lds
ds_read_b64_tr_b16 a[100:101], v23 offset:0
v_mfma_f32_16x16x32_bf16 v[76:79], a[136:139], a[164:167], v[76:79]
ds_read_b64_tr_b16 a[102:103], v23 offset:1024
v_mfma_f32_16x16x32_bf16 v[80:83], a[136:139], a[168:171], v[80:83]
ds_read_b64_tr_b16 a[104:105], v24 offset:0
v_mfma_f32_16x16x32_bf16 v[84:87], a[136:139], a[172:175], v[84:87]
ds_read_b64_tr_b16 a[106:107], v24 offset:1024
buffer_load_dwordx4 v166, s[16:19], s44 offen offset:2048 lds
v_mfma_f32_16x16x32_bf16 v[88:91], a[140:143], a[152:155], v[88:91]
ds_read_b64_tr_b16 a[108:109], v25 offset:0
ds_read_b64_tr_b16 a[110:111], v25 offset:1024
v_mfma_f32_16x16x32_bf16 v[92:95], a[140:143], a[156:159], v[92:95]
ds_read_b128 a[112:115], v13 offset:0
v_mfma_f32_16x16x32_bf16 v[96:99], a[140:143], a[160:163], v[96:99]
ds_read_b128 a[116:119], v13 offset:2048
buffer_load_dwordx4 v167, s[16:19], s44 offen offset:3072 lds
v_mfma_f32_16x16x32_bf16 v[100:103], a[140:143], a[164:167], v[100:103]
ds_read_b128 a[120:123], v13 offset:4096
v_mfma_f32_16x16x32_bf16 v[104:107], a[140:143], a[168:171], v[104:107]
ds_read_b128 a[124:127], v13 offset:12288
v_mfma_f32_16x16x32_bf16 v[108:111], a[140:143], a[172:175], v[108:111]
ds_read_b128 a[128:131], v13 offset:14336
v_mfma_f32_16x16x32_bf16 v[112:115], a[144:147], a[152:155], v[112:115]
s_add_u32 m0, s42, 118784
s_nop 0
buffer_load_dwordx4 v168, s[16:19], s44 offen offset:0 lds
ds_read_b128 a[132:135], v13 offset:16384
v_mfma_f32_16x16x32_bf16 v[116:119], a[144:147], a[156:159], v[116:119]
v_mfma_f32_16x16x32_bf16 v[120:123], a[144:147], a[160:163], v[120:123]
v_mfma_f32_16x16x32_bf16 v[124:127], a[144:147], a[164:167], v[124:127]
buffer_load_dwordx4 v169, s[16:19], s44 offen offset:1024 lds
v_mfma_f32_16x16x32_bf16 v[128:131], a[144:147], a[168:171], v[128:131]
v_mfma_f32_16x16x32_bf16 v[132:135], a[144:147], a[172:175], v[132:135]
v_mfma_f32_16x16x32_bf16 v[136:139], a[148:151], a[152:155], v[136:139]
v_mfma_f32_16x16x32_bf16 v[140:143], a[148:151], a[156:159], v[140:143]
s_mov_b32 s44, 4194304
s_add_u32 m0, s39, 139264
s_nop 0
buffer_load_dwordx4 v160, s[28:31], s44 offen offset:0 lds
v_mfma_f32_16x16x32_bf16 v[144:147], a[148:151], a[160:163], v[144:147]
v_mfma_f32_16x16x32_bf16 v[148:151], a[148:151], a[164:167], v[148:151]
v_mfma_f32_16x16x32_bf16 v[152:155], a[148:151], a[168:171], v[152:155]
v_mfma_f32_16x16x32_bf16 v[156:159], a[148:151], a[172:175], v[156:159]
buffer_load_dwordx4 v161, s[28:31], s44 offen offset:1024 lds
s_waitcnt lgkmcnt(0)
v_mfma_f32_16x16x32_bf16 v[64:67], a[96:99], a[112:115], v[64:67]
ds_read_b64_tr_b16 a[136:137], v22 offset:8192
buffer_load_dwordx4 v162, s[28:31], s44 offen offset:2048 lds
v_mfma_f32_16x16x32_bf16 v[68:71], a[96:99], a[116:119], v[68:71]
ds_read_b64_tr_b16 a[138:139], v22 offset:9216
v_mfma_f32_16x16x32_bf16 v[72:75], a[96:99], a[120:123], v[72:75]
ds_read_b64_tr_b16 a[140:141], v23 offset:8192
v_mfma_f32_16x16x32_bf16 v[76:79], a[96:99], a[124:127], v[76:79]
ds_read_b64_tr_b16 a[142:143], v23 offset:9216
v_mfma_f32_16x16x32_bf16 v[80:83], a[96:99], a[128:131], v[80:83]
buffer_load_dwordx4 v163, s[28:31], s44 offen offset:3072 lds
ds_read_b64_tr_b16 a[144:145], v24 offset:8192
v_mfma_f32_16x16x32_bf16 v[84:87], a[96:99], a[132:135], v[84:87]
ds_read_b64_tr_b16 a[146:147], v24 offset:9216
v_mfma_f32_16x16x32_bf16 v[88:91], a[100:103], a[112:115], v[88:91]
ds_read_b64_tr_b16 a[148:149], v25 offset:8192
ds_read_b64_tr_b16 a[150:151], v25 offset:9216
v_mfma_f32_16x16x32_bf16 v[92:95], a[100:103], a[116:119], v[92:95]
ds_read_b128 a[152:155], v14 offset:0
v_mfma_f32_16x16x32_bf16 v[96:99], a[100:103], a[120:123], v[96:99]
ds_read_b128 a[156:159], v14 offset:2048
v_mfma_f32_16x16x32_bf16 v[100:103], a[100:103], a[124:127], v[100:103]
ds_read_b128 a[160:163], v14 offset:4096
v_mfma_f32_16x16x32_bf16 v[104:107], a[100:103], a[128:131], v[104:107]
ds_read_b128 a[164:167], v14 offset:12288
v_mfma_f32_16x16x32_bf16 v[108:111], a[100:103], a[132:135], v[108:111]
ds_read_b128 a[168:171], v14 offset:14336
v_mfma_f32_16x16x32_bf16 v[112:115], a[104:107], a[112:115], v[112:115]
ds_read_b128 a[172:175], v14 offset:16384
v_mfma_f32_16x16x32_bf16 v[116:119], a[104:107], a[116:119], v[116:119]
v_mfma_f32_16x16x32_bf16 v[120:123], a[104:107], a[120:123], v[120:123]
v_mfma_f32_16x16x32_bf16 v[124:127], a[104:107], a[124:127], v[124:127]
v_mfma_f32_16x16x32_bf16 v[128:131], a[104:107], a[128:131], v[128:131]
v_mfma_f32_16x16x32_bf16 v[132:135], a[104:107], a[132:135], v[132:135]
v_mfma_f32_16x16x32_bf16 v[136:139], a[108:111], a[112:115], v[136:139]
v_mfma_f32_16x16x32_bf16 v[140:143], a[108:111], a[116:119], v[140:143]
v_mfma_f32_16x16x32_bf16 v[144:147], a[108:111], a[120:123], v[144:147]
v_mfma_f32_16x16x32_bf16 v[148:151], a[108:111], a[124:127], v[148:151]
v_mfma_f32_16x16x32_bf16 v[152:155], a[108:111], a[128:131], v[152:155]
v_mfma_f32_16x16x32_bf16 v[156:159], a[108:111], a[132:135], v[156:159]
s_waitcnt lgkmcnt(0)
s_waitcnt vmcnt(10)
s_barrier
s_mov_b32 s44, 1152
s_add_u32 m0, s42, 73728
s_nop 0
buffer_load_dwordx4 v164, s[16:19], s44 offen offset:0 lds
v_mfma_f32_16x16x32_bf16 v[64:67], a[136:139], a[152:155], v[64:67]
ds_read_b64_tr_b16 a[96:97], v26 offset:0
v_mfma_f32_16x16x32_bf16 v[68:71], a[136:139], a[156:159], v[68:71]
ds_read_b64_tr_b16 a[98:99], v26 offset:1024
v_mfma_f32_16x16x32_bf16 v[72:75], a[136:139], a[160:163], v[72:75]
buffer_load_dwordx4 v165, s[16:19], s44 offen offset:1024 lds
ds_read_b64_tr_b16 a[100:101], v27 offset:0
v_mfma_f32_16x16x32_bf16 v[76:79], a[136:139], a[164:167], v[76:79]
ds_read_b64_tr_b16 a[102:103], v27 offset:1024
v_mfma_f32_16x16x32_bf16 v[80:83], a[136:139], a[168:171], v[80:83]
ds_read_b64_tr_b16 a[104:105], v28 offset:0
v_mfma_f32_16x16x32_bf16 v[84:87], a[136:139], a[172:175], v[84:87]
ds_read_b64_tr_b16 a[106:107], v28 offset:1024
buffer_load_dwordx4 v166, s[16:19], s44 offen offset:2048 lds
v_mfma_f32_16x16x32_bf16 v[88:91], a[140:143], a[152:155], v[88:91]
ds_read_b64_tr_b16 a[108:109], v29 offset:0
ds_read_b64_tr_b16 a[110:111], v29 offset:1024
v_mfma_f32_16x16x32_bf16 v[92:95], a[140:143], a[156:159], v[92:95]
ds_read_b128 a[112:115], v15 offset:0
v_mfma_f32_16x16x32_bf16 v[96:99], a[140:143], a[160:163], v[96:99]
ds_read_b128 a[116:119], v15 offset:2048
buffer_load_dwordx4 v167, s[16:19], s44 offen offset:3072 lds
v_mfma_f32_16x16x32_bf16 v[100:103], a[140:143], a[164:167], v[100:103]
ds_read_b128 a[120:123], v15 offset:4096
v_mfma_f32_16x16x32_bf16 v[104:107], a[140:143], a[168:171], v[104:107]
ds_read_b128 a[124:127], v15 offset:12288
v_mfma_f32_16x16x32_bf16 v[108:111], a[140:143], a[172:175], v[108:111]
ds_read_b128 a[128:131], v15 offset:14336
v_mfma_f32_16x16x32_bf16 v[112:115], a[144:147], a[152:155], v[112:115]
s_add_u32 m0, s42, 77824
s_nop 0
buffer_load_dwordx4 v168, s[16:19], s44 offen offset:0 lds
ds_read_b128 a[132:135], v15 offset:16384
v_mfma_f32_16x16x32_bf16 v[116:119], a[144:147], a[156:159], v[116:119]
v_mfma_f32_16x16x32_bf16 v[120:123], a[144:147], a[160:163], v[120:123]
v_mfma_f32_16x16x32_bf16 v[124:127], a[144:147], a[164:167], v[124:127]
buffer_load_dwordx4 v169, s[16:19], s44 offen offset:1024 lds
v_mfma_f32_16x16x32_bf16 v[128:131], a[144:147], a[168:171], v[128:131]
v_mfma_f32_16x16x32_bf16 v[132:135], a[144:147], a[172:175], v[132:135]
v_mfma_f32_16x16x32_bf16 v[136:139], a[148:151], a[152:155], v[136:139]
v_mfma_f32_16x16x32_bf16 v[140:143], a[148:151], a[156:159], v[140:143]
s_mov_b32 s44, 4718592
s_add_u32 m0, s39, 98304
s_nop 0
buffer_load_dwordx4 v160, s[28:31], s44 offen offset:0 lds
v_mfma_f32_16x16x32_bf16 v[144:147], a[148:151], a[160:163], v[144:147]
v_mfma_f32_16x16x32_bf16 v[148:151], a[148:151], a[164:167], v[148:151]
v_mfma_f32_16x16x32_bf16 v[152:155], a[148:151], a[168:171], v[152:155]
v_mfma_f32_16x16x32_bf16 v[156:159], a[148:151], a[172:175], v[156:159]
buffer_load_dwordx4 v161, s[28:31], s44 offen offset:1024 lds
s_waitcnt lgkmcnt(0)
v_mfma_f32_16x16x32_bf16 v[64:67], a[96:99], a[112:115], v[64:67]
ds_read_b64_tr_b16 a[136:137], v26 offset:8192
buffer_load_dwordx4 v162, s[28:31], s44 offen offset:2048 lds
v_mfma_f32_16x16x32_bf16 v[68:71], a[96:99], a[116:119], v[68:71]
ds_read_b64_tr_b16 a[138:139], v26 offset:9216
v_mfma_f32_16x16x32_bf16 v[72:75], a[96:99], a[120:123], v[72:75]
ds_read_b64_tr_b16 a[140:141], v27 offset:8192
v_mfma_f32_16x16x32_bf16 v[76:79], a[96:99], a[124:127], v[76:79]
ds_read_b64_tr_b16 a[142:143], v27 offset:9216
v_mfma_f32_16x16x32_bf16 v[80:83], a[96:99], a[128:131], v[80:83]
buffer_load_dwordx4 v163, s[28:31], s44 offen offset:3072 lds
ds_read_b64_tr_b16 a[144:145], v28 offset:8192
v_mfma_f32_16x16x32_bf16 v[84:87], a[96:99], a[132:135], v[84:87]
ds_read_b64_tr_b16 a[146:147], v28 offset:9216
v_mfma_f32_16x16x32_bf16 v[88:91], a[100:103], a[112:115], v[88:91]
ds_read_b64_tr_b16 a[148:149], v29 offset:8192
ds_read_b64_tr_b16 a[150:151], v29 offset:9216
v_mfma_f32_16x16x32_bf16 v[92:95], a[100:103], a[116:119], v[92:95]
s_mov_b32 s45, 0
s_add_u32 m0, s39, 0
s_nop 0
buffer_load_dwordx4 v4, s[20:23], s45 offen offset:0 nt lds
ds_read_b128 a[152:155], v16 offset:0
v_mfma_f32_16x16x32_bf16 v[96:99], a[100:103], a[120:123], v[96:99]
ds_read_b128 a[156:159], v16 offset:2048
v_mfma_f32_16x16x32_bf16 v[100:103], a[100:103], a[124:127], v[100:103]
ds_read_b128 a[160:163], v16 offset:4096
v_mfma_f32_16x16x32_bf16 v[104:107], a[100:103], a[128:131], v[104:107]
buffer_load_dwordx4 v5, s[20:23], s45 offen offset:1024 nt lds
ds_read_b128 a[164:167], v16 offset:12288
v_mfma_f32_16x16x32_bf16 v[108:111], a[100:103], a[132:135], v[108:111]
ds_read_b128 a[168:171], v16 offset:14336
v_mfma_f32_16x16x32_bf16 v[112:115], a[104:107], a[112:115], v[112:115]
ds_read_b128 a[172:175], v16 offset:16384
v_mfma_f32_16x16x32_bf16 v[116:119], a[104:107], a[116:119], v[116:119]
v_mfma_f32_16x16x32_bf16 v[120:123], a[104:107], a[120:123], v[120:123]
v_mfma_f32_16x16x32_bf16 v[124:127], a[104:107], a[124:127], v[124:127]
buffer_load_dwordx4 v6, s[20:23], s45 offen offset:2048 nt lds
v_mfma_f32_16x16x32_bf16 v[128:131], a[104:107], a[128:131], v[128:131]
v_mfma_f32_16x16x32_bf16 v[132:135], a[104:107], a[132:135], v[132:135]
v_mfma_f32_16x16x32_bf16 v[136:139], a[108:111], a[112:115], v[136:139]
v_mfma_f32_16x16x32_bf16 v[140:143], a[108:111], a[116:119], v[140:143]
v_mfma_f32_16x16x32_bf16 v[144:147], a[108:111], a[120:123], v[144:147]
v_mfma_f32_16x16x32_bf16 v[148:151], a[108:111], a[124:127], v[148:151]
buffer_load_dwordx4 v7, s[20:23], s45 offen offset:3072 nt lds
v_mfma_f32_16x16x32_bf16 v[152:155], a[108:111], a[128:131], v[152:155]
v_mfma_f32_16x16x32_bf16 v[156:159], a[108:111], a[132:135], v[156:159]
s_waitcnt lgkmcnt(0)
s_waitcnt vmcnt(14)
s_barrier
s_mov_b32 s45, 16384
s_add_u32 m0, s39, 16384
s_nop 0
buffer_load_dwordx4 v4, s[20:23], s45 offen offset:0 nt lds
v_mfma_f32_16x16x32_bf16 v[64:67], a[136:139], a[152:155], v[64:67]
ds_read_b64_tr_b16 a[96:97], v30 offset:0
v_mfma_f32_16x16x32_bf16 v[68:71], a[136:139], a[156:159], v[68:71]
buffer_load_dwordx4 v5, s[20:23], s45 offen offset:1024 nt lds
ds_read_b64_tr_b16 a[98:99], v30 offset:1024
v_mfma_f32_16x16x32_bf16 v[72:75], a[136:139], a[160:163], v[72:75]
ds_read_b64_tr_b16 a[100:101], v31 offset:0
v_mfma_f32_16x16x32_bf16 v[76:79], a[136:139], a[164:167], v[76:79]
ds_read_b64_tr_b16 a[102:103], v31 offset:1024
v_mfma_f32_16x16x32_bf16 v[80:83], a[136:139], a[168:171], v[80:83]
ds_read_b64_tr_b16 a[104:105], v32 offset:0
v_mfma_f32_16x16x32_bf16 v[84:87], a[136:139], a[172:175], v[84:87]
ds_read_b64_tr_b16 a[106:107], v32 offset:1024
buffer_load_dwordx4 v6, s[20:23], s45 offen offset:2048 nt lds
v_mfma_f32_16x16x32_bf16 v[88:91], a[140:143], a[152:155], v[88:91]
ds_read_b64_tr_b16 a[108:109], v33 offset:0
ds_read_b64_tr_b16 a[110:111], v33 offset:1024
v_mfma_f32_16x16x32_bf16 v[92:95], a[140:143], a[156:159], v[92:95]
ds_read_b128 a[112:115], v17 offset:0
v_mfma_f32_16x16x32_bf16 v[96:99], a[140:143], a[160:163], v[96:99]
ds_read_b128 a[116:119], v17 offset:2048
v_mfma_f32_16x16x32_bf16 v[100:103], a[140:143], a[164:167], v[100:103]
ds_read_b128 a[120:123], v17 offset:4096
buffer_load_dwordx4 v7, s[20:23], s45 offen offset:3072 nt lds
v_mfma_f32_16x16x32_bf16 v[104:107], a[140:143], a[168:171], v[104:107]
ds_read_b128 a[124:127], v17 offset:12288
v_mfma_f32_16x16x32_bf16 v[108:111], a[140:143], a[172:175], v[108:111]
ds_read_b128 a[128:131], v17 offset:14336
v_mfma_f32_16x16x32_bf16 v[112:115], a[144:147], a[152:155], v[112:115]
ds_read_b128 a[132:135], v17 offset:16384
v_mfma_f32_16x16x32_bf16 v[116:119], a[144:147], a[156:159], v[116:119]
v_mfma_f32_16x16x32_bf16 v[120:123], a[144:147], a[160:163], v[120:123]
s_mov_b32 s45, 32768
buffer_load_dwordx4 v[176:179], v4, s[20:23], s45 offen offset:0 nt
v_mfma_f32_16x16x32_bf16 v[124:127], a[144:147], a[164:167], v[124:127]
v_mfma_f32_16x16x32_bf16 v[128:131], a[144:147], a[168:171], v[128:131]
v_mfma_f32_16x16x32_bf16 v[132:135], a[144:147], a[172:175], v[132:135]
v_mfma_f32_16x16x32_bf16 v[136:139], a[148:151], a[152:155], v[136:139]
v_mfma_f32_16x16x32_bf16 v[140:143], a[148:151], a[156:159], v[140:143]
buffer_load_dwordx4 v[180:183], v5, s[20:23], s45 offen offset:1024 nt
v_mfma_f32_16x16x32_bf16 v[144:147], a[148:151], a[160:163], v[144:147]
v_mfma_f32_16x16x32_bf16 v[148:151], a[148:151], a[164:167], v[148:151]
v_mfma_f32_16x16x32_bf16 v[152:155], a[148:151], a[168:171], v[152:155]
v_mfma_f32_16x16x32_bf16 v[156:159], a[148:151], a[172:175], v[156:159]
s_waitcnt lgkmcnt(0)
buffer_load_dwordx4 v[184:187], v6, s[20:23], s45 offen offset:2048 nt
v_mfma_f32_16x16x32_bf16 v[64:67], a[96:99], a[112:115], v[64:67]
ds_read_b64_tr_b16 a[136:137], v30 offset:8192
v_mfma_f32_16x16x32_bf16 v[68:71], a[96:99], a[116:119], v[68:71]
ds_read_b64_tr_b16 a[138:139], v30 offset:9216
v_mfma_f32_16x16x32_bf16 v[72:75], a[96:99], a[120:123], v[72:75]
ds_read_b64_tr_b16 a[140:141], v31 offset:8192
v_mfma_f32_16x16x32_bf16 v[76:79], a[96:99], a[124:127], v[76:79]
buffer_load_dwordx4 v[188:191], v7, s[20:23], s45 offen offset:3072 nt
ds_read_b64_tr_b16 a[142:143], v31 offset:9216
v_mfma_f32_16x16x32_bf16 v[80:83], a[96:99], a[128:131], v[80:83]
ds_read_b64_tr_b16 a[144:145], v32 offset:8192
v_mfma_f32_16x16x32_bf16 v[84:87], a[96:99], a[132:135], v[84:87]
ds_read_b64_tr_b16 a[146:147], v32 offset:9216
v_mfma_f32_16x16x32_bf16 v[88:91], a[100:103], a[112:115], v[88:91]
ds_read_b64_tr_b16 a[148:149], v33 offset:8192
ds_read_b64_tr_b16 a[150:151], v33 offset:9216
v_mfma_f32_16x16x32_bf16 v[92:95], a[100:103], a[116:119], v[92:95]
s_mov_b32 s45, 49152
buffer_load_dwordx4 v[192:195], v4, s[20:23], s45 offen offset:0 nt
ds_read_b128 a[152:155], v18 offset:0
v_mfma_f32_16x16x32_bf16 v[96:99], a[100:103], a[120:123], v[96:99]
ds_read_b128 a[156:159], v18 offset:2048
v_mfma_f32_16x16x32_bf16 v[100:103], a[100:103], a[124:127], v[100:103]
ds_read_b128 a[160:163], v18 offset:4096
v_mfma_f32_16x16x32_bf16 v[104:107], a[100:103], a[128:131], v[104:107]
ds_read_b128 a[164:167], v18 offset:12288
v_mfma_f32_16x16x32_bf16 v[108:111], a[100:103], a[132:135], v[108:111]
buffer_load_dwordx4 v[196:199], v5, s[20:23], s45 offen offset:1024 nt
ds_read_b128 a[168:171], v18 offset:14336
v_mfma_f32_16x16x32_bf16 v[112:115], a[104:107], a[112:115], v[112:115]
ds_read_b128 a[172:175], v18 offset:16384
v_mfma_f32_16x16x32_bf16 v[116:119], a[104:107], a[116:119], v[116:119]
v_mfma_f32_16x16x32_bf16 v[120:123], a[104:107], a[120:123], v[120:123]
v_mfma_f32_16x16x32_bf16 v[124:127], a[104:107], a[124:127], v[124:127]
v_mfma_f32_16x16x32_bf16 v[128:131], a[104:107], a[128:131], v[128:131]
buffer_load_dwordx4 v[200:203], v6, s[20:23], s45 offen offset:2048 nt
v_mfma_f32_16x16x32_bf16 v[132:135], a[104:107], a[132:135], v[132:135]
v_mfma_f32_16x16x32_bf16 v[136:139], a[108:111], a[112:115], v[136:139]
v_mfma_f32_16x16x32_bf16 v[140:143], a[108:111], a[116:119], v[140:143]
v_mfma_f32_16x16x32_bf16 v[144:147], a[108:111], a[120:123], v[144:147]
v_mfma_f32_16x16x32_bf16 v[148:151], a[108:111], a[124:127], v[148:151]
v_mfma_f32_16x16x32_bf16 v[152:155], a[108:111], a[128:131], v[152:155]
buffer_load_dwordx4 v[204:207], v7, s[20:23], s45 offen offset:3072 nt
v_mfma_f32_16x16x32_bf16 v[156:159], a[108:111], a[132:135], v[156:159]
s_waitcnt lgkmcnt(0)
s_waitcnt vmcnt(16)
s_barrier
s_mov_b32 s45, 65536
buffer_load_dwordx4 v[208:211], v4, s[20:23], s45 offen offset:0 nt
v_mfma_f32_16x16x32_bf16 v[64:67], a[136:139], a[152:155], v[64:67]
ds_read_b64_tr_b16 a[96:97], v22 offset:0
v_mfma_f32_16x16x32_bf16 v[68:71], a[136:139], a[156:159], v[68:71]
ds_read_b64_tr_b16 a[98:99], v22 offset:1024
v_mfma_f32_16x16x32_bf16 v[72:75], a[136:139], a[160:163], v[72:75]
ds_read_b64_tr_b16 a[100:101], v23 offset:0
buffer_load_dwordx4 v[212:215], v5, s[20:23], s45 offen offset:1024 nt
v_mfma_f32_16x16x32_bf16 v[76:79], a[136:139], a[164:167], v[76:79]
ds_read_b64_tr_b16 a[102:103], v23 offset:1024
v_mfma_f32_16x16x32_bf16 v[80:83], a[136:139], a[168:171], v[80:83]
ds_read_b64_tr_b16 a[104:105], v24 offset:0
v_mfma_f32_16x16x32_bf16 v[84:87], a[136:139], a[172:175], v[84:87]
ds_read_b64_tr_b16 a[106:107], v24 offset:1024
v_mfma_f32_16x16x32_bf16 v[88:91], a[140:143], a[152:155], v[88:91]
ds_read_b64_tr_b16 a[108:109], v25 offset:0
ds_read_b64_tr_b16 a[110:111], v25 offset:1024
buffer_load_dwordx4 v[216:219], v6, s[20:23], s45 offen offset:2048 nt
v_mfma_f32_16x16x32_bf16 v[92:95], a[140:143], a[156:159], v[92:95]
ds_read_b128 a[112:115], v13 offset:0
v_mfma_f32_16x16x32_bf16 v[96:99], a[140:143], a[160:163], v[96:99]
ds_read_b128 a[116:119], v13 offset:2048
v_mfma_f32_16x16x32_bf16 v[100:103], a[140:143], a[164:167], v[100:103]
ds_read_b128 a[120:123], v13 offset:4096
v_mfma_f32_16x16x32_bf16 v[104:107], a[140:143], a[168:171], v[104:107]
ds_read_b128 a[124:127], v13 offset:12288
v_mfma_f32_16x16x32_bf16 v[108:111], a[140:143], a[172:175], v[108:111]
buffer_load_dwordx4 v[220:223], v7, s[20:23], s45 offen offset:3072 nt
ds_read_b128 a[128:131], v13 offset:14336
v_mfma_f32_16x16x32_bf16 v[112:115], a[144:147], a[152:155], v[112:115]
ds_read_b128 a[132:135], v13 offset:16384
v_mfma_f32_16x16x32_bf16 v[116:119], a[144:147], a[156:159], v[116:119]
v_mfma_f32_16x16x32_bf16 v[120:123], a[144:147], a[160:163], v[120:123]
v_mfma_f32_16x16x32_bf16 v[124:127], a[144:147], a[164:167], v[124:127]
v_mfma_f32_16x16x32_bf16 v[128:131], a[144:147], a[168:171], v[128:131]
s_mov_b32 s45, 81920
buffer_load_dwordx4 v[224:227], v4, s[20:23], s45 offen offset:0 nt
v_mfma_f32_16x16x32_bf16 v[132:135], a[144:147], a[172:175], v[132:135]
v_mfma_f32_16x16x32_bf16 v[136:139], a[148:151], a[152:155], v[136:139]
v_mfma_f32_16x16x32_bf16 v[140:143], a[148:151], a[156:159], v[140:143]
v_mfma_f32_16x16x32_bf16 v[144:147], a[148:151], a[160:163], v[144:147]
v_mfma_f32_16x16x32_bf16 v[148:151], a[148:151], a[164:167], v[148:151]
buffer_load_dwordx4 v[228:231], v5, s[20:23], s45 offen offset:1024 nt
v_mfma_f32_16x16x32_bf16 v[152:155], a[148:151], a[168:171], v[152:155]
v_mfma_f32_16x16x32_bf16 v[156:159], a[148:151], a[172:175], v[156:159]
s_waitcnt lgkmcnt(0)
v_mfma_f32_16x16x32_bf16 v[64:67], a[96:99], a[112:115], v[64:67]
buffer_load_dwordx4 v[232:235], v6, s[20:23], s45 offen offset:2048 nt
ds_read_b64_tr_b16 a[136:137], v22 offset:8192
v_mfma_f32_16x16x32_bf16 v[68:71], a[96:99], a[116:119], v[68:71]
ds_read_b64_tr_b16 a[138:139], v22 offset:9216
v_mfma_f32_16x16x32_bf16 v[72:75], a[96:99], a[120:123], v[72:75]
ds_read_b64_tr_b16 a[140:141], v23 offset:8192
v_mfma_f32_16x16x32_bf16 v[76:79], a[96:99], a[124:127], v[76:79]
ds_read_b64_tr_b16 a[142:143], v23 offset:9216
v_mfma_f32_16x16x32_bf16 v[80:83], a[96:99], a[128:131], v[80:83]
buffer_load_dwordx4 v[236:239], v7, s[20:23], s45 offen offset:3072 nt
ds_read_b64_tr_b16 a[144:145], v24 offset:8192
v_mfma_f32_16x16x32_bf16 v[84:87], a[96:99], a[132:135], v[84:87]
ds_read_b64_tr_b16 a[146:147], v24 offset:9216
v_mfma_f32_16x16x32_bf16 v[88:91], a[100:103], a[112:115], v[88:91]
ds_read_b64_tr_b16 a[148:149], v25 offset:8192
ds_read_b64_tr_b16 a[150:151], v25 offset:9216
v_mfma_f32_16x16x32_bf16 v[92:95], a[100:103], a[116:119], v[92:95]
ds_read_b128 a[152:155], v14 offset:0
v_mfma_f32_16x16x32_bf16 v[96:99], a[100:103], a[120:123], v[96:99]
s_mov_b32 s45, 98304
buffer_load_dwordx4 v[240:243], v4, s[20:23], s45 offen offset:0 nt
ds_read_b128 a[156:159], v14 offset:2048
v_mfma_f32_16x16x32_bf16 v[100:103], a[100:103], a[124:127], v[100:103]
ds_read_b128 a[160:163], v14 offset:4096
v_mfma_f32_16x16x32_bf16 v[104:107], a[100:103], a[128:131], v[104:107]
ds_read_b128 a[164:167], v14 offset:12288
v_mfma_f32_16x16x32_bf16 v[108:111], a[100:103], a[132:135], v[108:111]
ds_read_b128 a[168:171], v14 offset:14336
v_mfma_f32_16x16x32_bf16 v[112:115], a[104:107], a[112:115], v[112:115]
buffer_load_dwordx4 v[244:247], v5, s[20:23], s45 offen offset:1024 nt
ds_read_b128 a[172:175], v14 offset:16384
v_mfma_f32_16x16x32_bf16 v[116:119], a[104:107], a[116:119], v[116:119]
v_mfma_f32_16x16x32_bf16 v[120:123], a[104:107], a[120:123], v[120:123]
v_mfma_f32_16x16x32_bf16 v[124:127], a[104:107], a[124:127], v[124:127]
v_mfma_f32_16x16x32_bf16 v[128:131], a[104:107], a[128:131], v[128:131]
v_mfma_f32_16x16x32_bf16 v[132:135], a[104:107], a[132:135], v[132:135]
v_mfma_f32_16x16x32_bf16 v[136:139], a[108:111], a[112:115], v[136:139]
buffer_load_dwordx4 v[248:251], v6, s[20:23], s45 offen offset:2048 nt
v_mfma_f32_16x16x32_bf16 v[140:143], a[108:111], a[116:119], v[140:143]
v_mfma_f32_16x16x32_bf16 v[144:147], a[108:111], a[120:123], v[144:147]
v_mfma_f32_16x16x32_bf16 v[148:151], a[108:111], a[124:127], v[148:151]
v_mfma_f32_16x16x32_bf16 v[152:155], a[108:111], a[128:131], v[152:155]
v_mfma_f32_16x16x32_bf16 v[156:159], a[108:111], a[132:135], v[156:159]
buffer_load_dwordx4 v[252:255], v7, s[20:23], s45 offen offset:3072 nt
s_waitcnt lgkmcnt(0)
v_mfma_f32_16x16x32_bf16 v[64:67], a[136:139], a[152:155], v[64:67]
v_mfma_f32_16x16x32_bf16 v[68:71], a[136:139], a[156:159], v[68:71]
v_mfma_f32_16x16x32_bf16 v[72:75], a[136:139], a[160:163], v[72:75]
v_mfma_f32_16x16x32_bf16 v[76:79], a[136:139], a[164:167], v[76:79]
v_mfma_f32_16x16x32_bf16 v[80:83], a[136:139], a[168:171], v[80:83]
v_mfma_f32_16x16x32_bf16 v[84:87], a[136:139], a[172:175], v[84:87]
v_mfma_f32_16x16x32_bf16 v[88:91], a[140:143], a[152:155], v[88:91]
v_mfma_f32_16x16x32_bf16 v[92:95], a[140:143], a[156:159], v[92:95]
v_mfma_f32_16x16x32_bf16 v[96:99], a[140:143], a[160:163], v[96:99]
v_mfma_f32_16x16x32_bf16 v[100:103], a[140:143], a[164:167], v[100:103]
v_mfma_f32_16x16x32_bf16 v[104:107], a[140:143], a[168:171], v[104:107]
v_mfma_f32_16x16x32_bf16 v[108:111], a[140:143], a[172:175], v[108:111]
v_mfma_f32_16x16x32_bf16 v[112:115], a[144:147], a[152:155], v[112:115]
v_mfma_f32_16x16x32_bf16 v[116:119], a[144:147], a[156:159], v[116:119]
v_mfma_f32_16x16x32_bf16 v[120:123], a[144:147], a[160:163], v[120:123]
v_mfma_f32_16x16x32_bf16 v[124:127], a[144:147], a[164:167], v[124:127]
v_mfma_f32_16x16x32_bf16 v[128:131], a[144:147], a[168:171], v[128:131]
v_mfma_f32_16x16x32_bf16 v[132:135], a[144:147], a[172:175], v[132:135]
v_mfma_f32_16x16x32_bf16 v[136:139], a[148:151], a[152:155], v[136:139]
v_mfma_f32_16x16x32_bf16 v[140:143], a[148:151], a[156:159], v[140:143]
v_mfma_f32_16x16x32_bf16 v[144:147], a[148:151], a[160:163], v[144:147]
v_mfma_f32_16x16x32_bf16 v[148:151], a[148:151], a[164:167], v[148:151]
v_mfma_f32_16x16x32_bf16 v[152:155], a[148:151], a[168:171], v[152:155]
v_mfma_f32_16x16x32_bf16 v[156:159], a[148:151], a[172:175], v[156:159]
s_branch L_merge
L_headB:
s_mov_b32 s44, 0
s_add_u32 m0, s42, 73728
s_nop 0
buffer_load_dwordx4 v164, s[16:19], s44 offen offset:0 lds
buffer_load_dwordx4 v165, s[16:19], s44 offen offset:1024 lds
buffer_load_dwordx4 v166, s[16:19], s44 offen offset:2048 lds
buffer_load_dwordx4 v167, s[16:19], s44 offen offset:3072 lds
s_add_u32 m0, s42, 77824
s_nop 0
buffer_load_dwordx4 v168, s[16:19], s44 offen offset:0 lds
buffer_load_dwordx4 v169, s[16:19], s44 offen offset:1024 lds
s_add_u32 m0, s39, 98304
s_nop 0
buffer_load_dwordx4 v160, s[28:31], s44 offen offset:0 lds
buffer_load_dwordx4 v161, s[28:31], s44 offen offset:1024 lds
buffer_load_dwordx4 v162, s[28:31], s44 offen offset:2048 lds
buffer_load_dwordx4 v163, s[28:31], s44 offen offset:3072 lds
s_mov_b32 s44, 128
s_add_u32 m0, s42, 32768
s_nop 0
buffer_load_dwordx4 v164, s[16:19], s44 offen offset:0 lds
buffer_load_dwordx4 v165, s[16:19], s44 offen offset:1024 lds
buffer_load_dwordx4 v166, s[16:19], s44 offen offset:2048 lds
buffer_load_dwordx4 v167, s[16:19], s44 offen offset:3072 lds
s_add_u32 m0, s42, 36864
s_nop 0
buffer_load_dwordx4 v168, s[16:19], s44 offen offset:0 lds
buffer_load_dwordx4 v169, s[16:19], s44 offen offset:1024 lds
s_mov_b32 s44, 524288
s_add_u32 m0, s39, 57344
s_nop 0
buffer_load_dwordx4 v160, s[28:31], s44 offen offset:0 lds
buffer_load_dwordx4 v161, s[28:31], s44 offen offset:1024 lds
buffer_load_dwordx4 v162, s[28:31], s44 offen offset:2048 lds
buffer_load_dwordx4 v163, s[28:31], s44 offen offset:3072 lds
s_and_b32 s37, s36, 1
s_lshr_b32 s38, s36, 1
s_mov_b32 s40, 0x3e0293ee
s_mov_b32 s41, 0x3e0293ee
s_lshl_b32 s43, s48, 6
s_add_u32 s43, s43, s47
s_lshl_b32 s43, s43, 17
s_add_u32 s24, s8, s43
s_addc_u32 s25, s9, 0
s_and_b32 s25, s25, 0xffff
s_sub_u32 s26, 33554432, s43
s_mov_b32 s27, 0x20000
s_mul_i32 s43, s46, 6291456
s_add_u32 s32, s12, s43
s_addc_u32 s33, s13, 0
s_and_b32 s33, s33, 0xffff
s_mov_b32 s34, 6291456
s_mov_b32 s35, 0x20000
v_lshlrev_b32 v46, 8, v3
v_add_u32 v46, s39, v46
v_add_u32 v41, 0, v3
v_lshlrev_b32 v41, 1, v41
v_xor_b32 v41, v2, v41
v_lshlrev_b32 v41, 4, v41
v_add_u32 v8, v46, v41
v_add_u32 v41, 4, v3
v_lshlrev_b32 v41, 1, v41
v_xor_b32 v41, v2, v41
v_lshlrev_b32 v41, 4, v41
v_add_u32 v9, v46, v41
s_lshl_b32 s43, s38, 5
v_add_u32 v40, s43, v2
v_lshlrev_b32 v40, 8, v40
v_xor_b32 v41, v3, v2
v_lshlrev_b32 v41, 4, v41
v_add_u32 v10, v40, v41
v_lshrrev_b32 v42, 2, v2
v_and_b32 v43, 3, v2
v_lshlrev_b32 v44, 2, v3
v_add_u32 v44, v44, v42
v_add_u32 v40, s43, v44
v_lshlrev_b32 v40, 8, v40
v_and_b32 v45, 7, v44
s_lshl_b32 s51, s38, 2
v_xor_b32 v45, s51, v45
v_lshlrev_b32 v45, 5, v45
v_lshlrev_b32 v46, 3, v43
v_add3_u32 v11, v40, v45, v46
v_lshlrev_b32 v12, 4, v1
s_mul_i32 s43, s37, 6144
v_lshrrev_b32 v40, 3, v2
v_lshlrev_b32 v40, 10, v40
v_and_b32 v41, 7, v2
v_lshlrev_b32 v41, 7, v41
v_lshrrev_b32 v47, 1, v2
v_and_b32 v47, 7, v47
v_xor_b32 v47, v3, v47
v_lshlrev_b32 v47, 4, v47
v_add3_u32 v170, v40, v41, v47
v_add_u32 v170, s43, v170
v_lshlrev_b32 v40, 3, v3
v_add_u32 v40, v40, v42
v_lshlrev_b32 v40, 8, v40
v_and_b32 v41, 1, v3
v_lshlrev_b32 v41, 2, v41
v_add_u32 v41, v41, v42
v_xor_b32 v41, s51, v41
v_lshlrev_b32 v41, 5, v41
v_add3_u32 v171, v40, v41, v46
v_add_u32 v171, 24576, v171
s_mov_b32 s80, s76
s_and_b32 s81, s77, 0xffff
s_mov_b32 s82, 256
s_mov_b32 s83, 0x20000
s_add_u32 s84, s12, 25165824
s_addc_u32 s85, s13, 0
s_and_b32 s85, s85, 0xffff
s_mov_b32 s86, 65536
s_mov_b32 s87, 0x20000
s_or_b32 s79, s98, 1
v_add_u32 v57, s36, v1
v_add_u32 v57, s2, v57
v_cmp_eq_u32 vcc, 0, v57
v_mov_b32 v56, 0x1000
v_mov_b32 v58, 0
v_cndmask_b32 v57, v56, v58, vcc
v_mov_b32 v58, s79
buffer_store_dword v58, v57, s[80:83], 0 offen sc1
v_mov_b32 v40, 0x3f803f80
v_accvgpr_write_b32 a176, v40
v_accvgpr_write_b32 a177, v40
v_accvgpr_write_b32 a178, v40
v_accvgpr_write_b32 a179, v40
v_add_u32 v13, 73728, v170
v_xor_b32 v14, 64, v13
v_add_u32 v22, 73728, v171
v_xor_b32 v23, 32, v22
v_xor_b32 v24, 64, v22
v_xor_b32 v25, 96, v22
v_add_u32 v15, 32768, v170
v_xor_b32 v16, 64, v15
v_add_u32 v26, 32768, v171
v_xor_b32 v27, 32, v26
v_xor_b32 v28, 64, v26
v_xor_b32 v29, 96, v26
v_add_u32 v17, 114688, v170
v_xor_b32 v18, 64, v17
v_add_u32 v30, 114688, v171
v_xor_b32 v31, 32, v30
v_xor_b32 v32, 64, v30
v_xor_b32 v33, 96, v30
s_waitcnt vmcnt(10)
s_barrier
s_mov_b32 s44, 256
s_add_u32 m0, s42, 114688
s_nop 0
buffer_load_dwordx4 v164, s[16:19], s44 offen offset:0 lds
buffer_load_dwordx4 v165, s[16:19], s44 offen offset:1024 lds
buffer_load_dwordx4 v166, s[16:19], s44 offen offset:2048 lds
buffer_load_dwordx4 v167, s[16:19], s44 offen offset:3072 lds
s_add_u32 m0, s42, 118784
s_nop 0
buffer_load_dwordx4 v168, s[16:19], s44 offen offset:0 lds
buffer_load_dwordx4 v169, s[16:19], s44 offen offset:1024 lds
s_mov_b32 s44, 1048576
s_add_u32 m0, s39, 139264
s_nop 0
buffer_load_dwordx4 v160, s[28:31], s44 offen offset:0 lds
buffer_load_dwordx4 v161, s[28:31], s44 offen offset:1024 lds
buffer_load_dwordx4 v162, s[28:31], s44 offen offset:2048 lds
buffer_load_dwordx4 v163, s[28:31], s44 offen offset:3072 lds
ds_read_b64_tr_b16 a[96:97], v22 offset:0
ds_read_b64_tr_b16 a[98:99], v22 offset:1024
ds_read_b64_tr_b16 a[100:101], v23 offset:0
ds_read_b64_tr_b16 a[102:103], v23 offset:1024
ds_read_b64_tr_b16 a[104:105], v24 offset:0
ds_read_b64_tr_b16 a[106:107], v24 offset:1024
ds_read_b64_tr_b16 a[108:109], v25 offset:0
ds_read_b64_tr_b16 a[110:111], v25 offset:1024
ds_read_b128 a[112:115], v13 offset:0
ds_read_b128 a[116:119], v13 offset:2048
ds_read_b128 a[120:123], v13 offset:4096
ds_read_b128 a[124:127], v13 offset:12288
ds_read_b128 a[128:131], v13 offset:14336
ds_read_b128 a[132:135], v13 offset:16384
s_waitcnt lgkmcnt(0)
v_mfma_f32_16x16x32_bf16 v[64:67], a[96:99], a[112:115], 0
ds_read_b64_tr_b16 a[136:137], v22 offset:8192
v_mfma_f32_16x16x32_bf16 v[68:71], a[96:99], a[116:119], 0
ds_read_b64_tr_b16 a[138:139], v22 offset:9216
v_mfma_f32_16x16x32_bf16 v[72:75], a[96:99], a[120:123], 0
ds_read_b64_tr_b16 a[140:141], v23 offset:8192
v_mfma_f32_16x16x32_bf16 v[76:79], a[96:99], a[124:127], 0
ds_read_b64_tr_b16 a[142:143], v23 offset:9216
v_mfma_f32_16x16x32_bf16 v[80:83], a[96:99], a[128:131], 0
ds_read_b64_tr_b16 a[144:145], v24 offset:8192
v_mfma_f32_16x16x32_bf16 v[84:87], a[96:99], a[132:135], 0
ds_read_b64_tr_b16 a[146:147], v24 offset:9216
v_mfma_f32_16x16x32_bf16 v[88:91], a[100:103], a[112:115], 0
ds_read_b64_tr_b16 a[148:149], v25 offset:8192
ds_read_b64_tr_b16 a[150:151], v25 offset:9216
v_mfma_f32_16x16x32_bf16 v[92:95], a[100:103], a[116:119], 0
ds_read_b128 a[152:155], v14 offset:0
v_mfma_f32_16x16x32_bf16 v[96:99], a[100:103], a[120:123], 0
ds_read_b128 a[156:159], v14 offset:2048
v_mfma_f32_16x16x32_bf16 v[100:103], a[100:103], a[124:127], 0
ds_read_b128 a[160:163], v14 offset:4096
v_mfma_f32_16x16x32_bf16 v[104:107], a[100:103], a[128:131], 0
ds_read_b128 a[164:167], v14 offset:12288
v_mfma_f32_16x16x32_bf16 v[108:111], a[100:103], a[132:135], 0
ds_read_b128 a[168:171], v14 offset:14336
v_mfma_f32_16x16x32_bf16 v[112:115], a[104:107], a[112:115], 0
ds_read_b128 a[172:175], v14 offset:16384
v_mfma_f32_16x16x32_bf16 v[116:119], a[104:107], a[116:119], 0
v_mfma_f32_16x16x32_bf16 v[120:123], a[104:107], a[120:123], 0
v_mfma_f32_16x16x32_bf16 v[124:127], a[104:107], a[124:127], 0
v_mfma_f32_16x16x32_bf16 v[128:131], a[104:107], a[128:131], 0
v_mfma_f32_16x16x32_bf16 v[132:135], a[104:107], a[132:135], 0
v_mfma_f32_16x16x32_bf16 v[136:139], a[108:111], a[112:115], 0
v_mfma_f32_16x16x32_bf16 v[140:143], a[108:111], a[116:119], 0
v_mfma_f32_16x16x32_bf16 v[144:147], a[108:111], a[120:123], 0
v_mfma_f32_16x16x32_bf16 v[148:151], a[108:111], a[124:127], 0
v_mfma_f32_16x16x32_bf16 v[152:155], a[108:111], a[128:131], 0
v_mfma_f32_16x16x32_bf16 v[156:159], a[108:111], a[132:135], 0
s_waitcnt lgkmcnt(0)
s_waitcnt vmcnt(10)
s_barrier
s_mov_b32 s44, 384
s_add_u32 m0, s42, 73728
s_nop 0
buffer_load_dwordx4 v164, s[16:19], s44 offen offset:0 lds
v_mfma_f32_16x16x32_bf16 v[64:67], a[136:139], a[152:155], v[64:67]
ds_read_b64_tr_b16 a[96:97], v26 offset:0
v_mfma_f32_16x16x32_bf16 v[68:71], a[136:139], a[156:159], v[68:71]
ds_read_b64_tr_b16 a[98:99], v26 offset:1024
v_mfma_f32_16x16x32_bf16 v[72:75], a[136:139], a[160:163], v[72:75]
buffer_load_dwordx4 v165, s[16:19], s44 offen offset:1024 lds
ds_read_b64_tr_b16 a[100:101], v27 offset:0
v_mfma_f32_16x16x32_bf16 v[76:79], a[136:139], a[164:167], v[76:79]
ds_read_b64_tr_b16 a[102:103], v27 offset:1024
v_mfma_f32_16x16x32_bf16 v[80:83], a[136:139], a[168:171], v[80:83]
ds_read_b64_tr_b16 a[104:105], v28 offset:0
v_mfma_f32_16x16x32_bf16 v[84:87], a[136:139], a[172:175], v[84:87]
ds_read_b64_tr_b16 a[106:107], v28 offset:1024
buffer_load_dwordx4 v166, s[16:19], s44 offen offset:2048 lds
v_mfma_f32_16x16x32_bf16 v[88:91], a[140:143], a[152:155], v[88:91]
ds_read_b64_tr_b16 a[108:109], v29 offset:0
ds_read_b64_tr_b16 a[110:111], v29 offset:1024
v_mfma_f32_16x16x32_bf16 v[92:95], a[140:143], a[156:159], v[92:95]
ds_read_b128 a[112:115], v15 offset:0
v_mfma_f32_16x16x32_bf16 v[96:99], a[140:143], a[160:163], v[96:99]
ds_read_b128 a[116:119], v15 offset:2048
buffer_load_dwordx4 v167, s[16:19], s44 offen offset:3072 lds
v_mfma_f32_16x16x32_bf16 v[100:103], a[140:143], a[164:167], v[100:103]
ds_read_b128 a[120:123], v15 offset:4096
v_mfma_f32_16x16x32_bf16 v[104:107], a[140:143], a[168:171], v[104:107]
ds_read_b128 a[124:127], v15 offset:12288
v_mfma_f32_16x16x32_bf16 v[108:111], a[140:143], a[172:175], v[108:111]
ds_read_b128 a[128:131], v15 offset:14336
v_mfma_f32_16x16x32_bf16 v[112:115], a[144:147], a[152:155], v[112:115]
s_add_u32 m0, s42, 77824
s_nop 0
buffer_load_dwordx4 v168, s[16:19], s44 offen offset:0 lds
ds_read_b128 a[132:135], v15 offset:16384
v_mfma_f32_16x16x32_bf16 v[116:119], a[144:147], a[156:159], v[116:119]
v_mfma_f32_16x16x32_bf16 v[120:123], a[144:147], a[160:163], v[120:123]
v_mfma_f32_16x16x32_bf16 v[124:127], a[144:147], a[164:167], v[124:127]
buffer_load_dwordx4 v169, s[16:19], s44 offen offset:1024 lds
v_mfma_f32_16x16x32_bf16 v[128:131], a[144:147], a[168:171], v[128:131]
v_mfma_f32_16x16x32_bf16 v[132:135], a[144:147], a[172:175], v[132:135]
v_mfma_f32_16x16x32_bf16 v[136:139], a[148:151], a[152:155], v[136:139]
v_mfma_f32_16x16x32_bf16 v[140:143], a[148:151], a[156:159], v[140:143]
s_mov_b32 s44, 1572864
s_add_u32 m0, s39, 98304
s_nop 0
buffer_load_dwordx4 v160, s[28:31], s44 offen offset:0 lds
v_mfma_f32_16x16x32_bf16 v[144:147], a[148:151], a[160:163], v[144:147]
v_mfma_f32_16x16x32_bf16 v[148:151], a[148:151], a[164:167], v[148:151]
v_mfma_f32_16x16x32_bf16 v[152:155], a[148:151], a[168:171], v[152:155]
v_mfma_f32_16x16x32_bf16 v[156:159], a[148:151], a[172:175], v[156:159]
buffer_load_dwordx4 v161, s[28:31], s44 offen offset:1024 lds
s_waitcnt lgkmcnt(0)
v_mfma_f32_16x16x32_bf16 v[64:67], a[96:99], a[112:115], v[64:67]
ds_read_b64_tr_b16 a[136:137], v26 offset:8192
buffer_load_dwordx4 v162, s[28:31], s44 offen offset:2048 lds
v_mfma_f32_16x16x32_bf16 v[68:71], a[96:99], a[116:119], v[68:71]
ds_read_b64_tr_b16 a[138:139], v26 offset:9216
v_mfma_f32_16x16x32_bf16 v[72:75], a[96:99], a[120:123], v[72:75]
ds_read_b64_tr_b16 a[140:141], v27 offset:8192
v_mfma_f32_16x16x32_bf16 v[76:79], a[96:99], a[124:127], v[76:79]
ds_read_b64_tr_b16 a[142:143], v27 offset:9216
v_mfma_f32_16x16x32_bf16 v[80:83], a[96:99], a[128:131], v[80:83]
buffer_load_dwordx4 v163, s[28:31], s44 offen offset:3072 lds
ds_read_b64_tr_b16 a[144:145], v28 offset:8192
v_mfma_f32_16x16x32_bf16 v[84:87], a[96:99], a[132:135], v[84:87]
ds_read_b64_tr_b16 a[146:147], v28 offset:9216
v_mfma_f32_16x16x32_bf16 v[88:91], a[100:103], a[112:115], v[88:91]
ds_read_b64_tr_b16 a[148:149], v29 offset:8192
ds_read_b64_tr_b16 a[150:151], v29 offset:9216
v_mfma_f32_16x16x32_bf16 v[92:95], a[100:103], a[116:119], v[92:95]
ds_read_b128 a[152:155], v16 offset:0
v_mfma_f32_16x16x32_bf16 v[96:99], a[100:103], a[120:123], v[96:99]
ds_read_b128 a[156:159], v16 offset:2048
v_mfma_f32_16x16x32_bf16 v[100:103], a[100:103], a[124:127], v[100:103]
ds_read_b128 a[160:163], v16 offset:4096
v_mfma_f32_16x16x32_bf16 v[104:107], a[100:103], a[128:131], v[104:107]
ds_read_b128 a[164:167], v16 offset:12288
v_mfma_f32_16x16x32_bf16 v[108:111], a[100:103], a[132:135], v[108:111]
ds_read_b128 a[168:171], v16 offset:14336
v_mfma_f32_16x16x32_bf16 v[112:115], a[104:107], a[112:115], v[112:115]
ds_read_b128 a[172:175], v16 offset:16384
v_mfma_f32_16x16x32_bf16 v[116:119], a[104:107], a[116:119], v[116:119]
v_mfma_f32_16x16x32_bf16 v[120:123], a[104:107], a[120:123], v[120:123]
v_mfma_f32_16x16x32_bf16 v[124:127], a[104:107], a[124:127], v[124:127]
v_mfma_f32_16x16x32_bf16 v[128:131], a[104:107], a[128:131], v[128:131]
v_mfma_f32_16x16x32_bf16 v[132:135], a[104:107], a[132:135], v[132:135]
v_mfma_f32_16x16x32_bf16 v[136:139], a[108:111], a[112:115], v[136:139]
v_mfma_f32_16x16x32_bf16 v[140:143], a[108:111], a[116:119], v[140:143]
v_mfma_f32_16x16x32_bf16 v[144:147], a[108:111], a[120:123], v[144:147]
v_mfma_f32_16x16x32_bf16 v[148:151], a[108:111], a[124:127], v[148:151]
v_mfma_f32_16x16x32_bf16 v[152:155], a[108:111], a[128:131], v[152:155]
v_mfma_f32_16x16x32_bf16 v[156:159], a[108:111], a[132:135], v[156:159]
s_waitcnt lgkmcnt(0)
s_waitcnt vmcnt(10)
s_barrier
s_mov_b32 s44, 512
s_add_u32 m0, s42, 32768
s_nop 0
buffer_load_dwordx4 v164, s[16:19], s44 offen offset:0 lds
v_mfma_f32_16x16x32_bf16 v[64:67], a[136:139], a[152:155], v[64:67]
ds_read_b64_tr_b16 a[96:97], v30 offset:0
v_mfma_f32_16x16x32_bf16 v[68:71], a[136:139], a[156:159], v[68:71]
ds_read_b64_tr_b16 a[98:99], v30 offset:1024
v_mfma_f32_16x16x32_bf16 v[72:75], a[136:139], a[160:163], v[72:75]
buffer_load_dwordx4 v165, s[16:19], s44 offen offset:1024 lds
ds_read_b64_tr_b16 a[100:101], v31 offset:0
v_mfma_f32_16x16x32_bf16 v[76:79], a[136:139], a[164:167], v[76:79]
ds_read_b64_tr_b16 a[102:103], v31 offset:1024
v_mfma_f32_16x16x32_bf16 v[80:83], a[136:139], a[168:171], v[80:83]
ds_read_b64_tr_b16 a[104:105], v32 offset:0
v_mfma_f32_16x16x32_bf16 v[84:87], a[136:139], a[172:175], v[84:87]
ds_read_b64_tr_b16 a[106:107], v32 offset:1024
buffer_load_dwordx4 v166, s[16:19], s44 offen offset:2048 lds
v_mfma_f32_16x16x32_bf16 v[88:91], a[140:143], a[152:155], v[88:91]
ds_read_b64_tr_b16 a[108:109], v33 offset:0
ds_read_b64_tr_b16 a[110:111], v33 offset:1024
v_mfma_f32_16x16x32_bf16 v[92:95], a[140:143], a[156:159], v[92:95]
ds_read_b128 a[112:115], v17 offset:0
v_mfma_f32_16x16x32_bf16 v[96:99], a[140:143], a[160:163], v[96:99]
ds_read_b128 a[116:119], v17 offset:2048
buffer_load_dwordx4 v167, s[16:19], s44 offen offset:3072 lds
v_mfma_f32_16x16x32_bf16 v[100:103], a[140:143], a[164:167], v[100:103]
ds_read_b128 a[120:123], v17 offset:4096
v_mfma_f32_16x16x32_bf16 v[104:107], a[140:143], a[168:171], v[104:107]
ds_read_b128 a[124:127], v17 offset:12288
v_mfma_f32_16x16x32_bf16 v[108:111], a[140:143], a[172:175], v[108:111]
ds_read_b128 a[128:131], v17 offset:14336
v_mfma_f32_16x16x32_bf16 v[112:115], a[144:147], a[152:155], v[112:115]
s_add_u32 m0, s42, 36864
s_nop 0
buffer_load_dwordx4 v168, s[16:19], s44 offen offset:0 lds
ds_read_b128 a[132:135], v17 offset:16384
v_mfma_f32_16x16x32_bf16 v[116:119], a[144:147], a[156:159], v[116:119]
v_mfma_f32_16x16x32_bf16 v[120:123], a[144:147], a[160:163], v[120:123]
v_mfma_f32_16x16x32_bf16 v[124:127], a[144:147], a[164:167], v[124:127]
buffer_load_dwordx4 v169, s[16:19], s44 offen offset:1024 lds
v_mfma_f32_16x16x32_bf16 v[128:131], a[144:147], a[168:171], v[128:131]
v_mfma_f32_16x16x32_bf16 v[132:135], a[144:147], a[172:175], v[132:135]
v_mfma_f32_16x16x32_bf16 v[136:139], a[148:151], a[152:155], v[136:139]
v_mfma_f32_16x16x32_bf16 v[140:143], a[148:151], a[156:159], v[140:143]
s_mov_b32 s44, 2097152
s_add_u32 m0, s39, 57344
s_nop 0
buffer_load_dwordx4 v160, s[28:31], s44 offen offset:0 lds
v_mfma_f32_16x16x32_bf16 v[144:147], a[148:151], a[160:163], v[144:147]
v_mfma_f32_16x16x32_bf16 v[148:151], a[148:151], a[164:167], v[148:151]
v_mfma_f32_16x16x32_bf16 v[152:155], a[148:151], a[168:171], v[152:155]
v_mfma_f32_16x16x32_bf16 v[156:159], a[148:151], a[172:175], v[156:159]
buffer_load_dwordx4 v161, s[28:31], s44 offen offset:1024 lds
s_waitcnt lgkmcnt(0)
v_mfma_f32_16x16x32_bf16 v[64:67], a[96:99], a[112:115], v[64:67]
ds_read_b64_tr_b16 a[136:137], v30 offset:8192
buffer_load_dwordx4 v162, s[28:31], s44 offen offset:2048 lds
v_mfma_f32_16x16x32_bf16 v[68:71], a[96:99], a[116:119], v[68:71]
ds_read_b64_tr_b16 a[138:139], v30 offset:9216
v_mfma_f32_16x16x32_bf16 v[72:75], a[96:99], a[120:123], v[72:75]
ds_read_b64_tr_b16 a[140:141], v31 offset:8192
v_mfma_f32_16x16x32_bf16 v[76:79], a[96:99], a[124:127], v[76:79]
ds_read_b64_tr_b16 a[142:143], v31 offset:9216
v_mfma_f32_16x16x32_bf16 v[80:83], a[96:99], a[128:131], v[80:83]
buffer_load_dwordx4 v163, s[28:31], s44 offen offset:3072 lds
ds_read_b64_tr_b16 a[144:145], v32 offset:8192
v_mfma_f32_16x16x32_bf16 v[84:87], a[96:99], a[132:135], v[84:87]
ds_read_b64_tr_b16 a[146:147], v32 offset:9216
v_mfma_f32_16x16x32_bf16 v[88:91], a[100:103], a[112:115], v[88:91]
ds_read_b64_tr_b16 a[148:149], v33 offset:8192
ds_read_b64_tr_b16 a[150:151], v33 offset:9216
v_mfma_f32_16x16x32_bf16 v[92:95], a[100:103], a[116:119], v[92:95]
ds_read_b128 a[152:155], v18 offset:0
v_mfma_f32_16x16x32_bf16 v[96:99], a[100:103], a[120:123], v[96:99]
ds_read_b128 a[156:159], v18 offset:2048
v_mfma_f32_16x16x32_bf16 v[100:103], a[100:103], a[124:127], v[100:103]
ds_read_b128 a[160:163], v18 offset:4096
v_mfma_f32_16x16x32_bf16 v[104:107], a[100:103], a[128:131], v[104:107]
ds_read_b128 a[164:167], v18 offset:12288
v_mfma_f32_16x16x32_bf16 v[108:111], a[100:103], a[132:135], v[108:111]
ds_read_b128 a[168:171], v18 offset:14336
v_mfma_f32_16x16x32_bf16 v[112:115], a[104:107], a[112:115], v[112:115]
ds_read_b128 a[172:175], v18 offset:16384
v_mfma_f32_16x16x32_bf16 v[116:119], a[104:107], a[116:119], v[116:119]
v_mfma_f32_16x16x32_bf16 v[120:123], a[104:107], a[120:123], v[120:123]
v_mfma_f32_16x16x32_bf16 v[124:127], a[104:107], a[124:127], v[124:127]
v_mfma_f32_16x16x32_bf16 v[128:131], a[104:107], a[128:131], v[128:131]
v_mfma_f32_16x16x32_bf16 v[132:135], a[104:107], a[132:135], v[132:135]
v_mfma_f32_16x16x32_bf16 v[136:139], a[108:111], a[112:115], v[136:139]
v_mfma_f32_16x16x32_bf16 v[140:143], a[108:111], a[116:119], v[140:143]
v_mfma_f32_16x16x32_bf16 v[144:147], a[108:111], a[120:123], v[144:147]
v_mfma_f32_16x16x32_bf16 v[148:151], a[108:111], a[124:127], v[148:151]
v_mfma_f32_16x16x32_bf16 v[152:155], a[108:111], a[128:131], v[152:155]
v_mfma_f32_16x16x32_bf16 v[156:159], a[108:111], a[132:135], v[156:159]
s_waitcnt lgkmcnt(0)
s_waitcnt vmcnt(10)
s_barrier
s_mov_b32 s44, 640
s_add_u32 m0, s42, 114688
s_nop 0
buffer_load_dwordx4 v164, s[16:19], s44 offen offset:0 lds
v_mfma_f32_16x16x32_bf16 v[64:67], a[136:139], a[152:155], v[64:67]
ds_read_b64_tr_b16 a[96:97], v22 offset:0
v_mfma_f32_16x16x32_bf16 v[68:71], a[136:139], a[156:159], v[68:71]
ds_read_b64_tr_b16 a[98:99], v22 offset:1024
v_mfma_f32_16x16x32_bf16 v[72:75], a[136:139], a[160:163], v[72:75]
buffer_load_dwordx4 v165, s[16:19], s44 offen offset:1024 lds
ds_read_b64_tr_b16 a[100:101], v23 offset:0
v_mfma_f32_16x16x32_bf16 v[76:79], a[136:139], a[164:167], v[76:79]
ds_read_b64_tr_b16 a[102:103], v23 offset:1024
v_mfma_f32_16x16x32_bf16 v[80:83], a[136:139], a[168:171], v[80:83]
ds_read_b64_tr_b16 a[104:105], v24 offset:0
v_mfma_f32_16x16x32_bf16 v[84:87], a[136:139], a[172:175], v[84:87]
ds_read_b64_tr_b16 a[106:107], v24 offset:1024
buffer_load_dwordx4 v166, s[16:19], s44 offen offset:2048 lds
v_mfma_f32_16x16x32_bf16 v[88:91], a[140:143], a[152:155], v[88:91]
ds_read_b64_tr_b16 a[108:109], v25 offset:0
ds_read_b64_tr_b16 a[110:111], v25 offset:1024
v_mfma_f32_16x16x32_bf16 v[92:95], a[140:143], a[156:159], v[92:95]
ds_read_b128 a[112:115], v13 offset:0
v_mfma_f32_16x16x32_bf16 v[96:99], a[140:143], a[160:163], v[96:99]
ds_read_b128 a[116:119], v13 offset:2048
buffer_load_dwordx4 v167, s[16:19], s44 offen offset:3072 lds
v_mfma_f32_16x16x32_bf16 v[100:103], a[140:143], a[164:167], v[100:103]
ds_read_b128 a[120:123], v13 offset:4096
v_mfma_f32_16x16x32_bf16 v[104:107], a[140:143], a[168:171], v[104:107]
ds_read_b128 a[124:127], v13 offset:12288
v_mfma_f32_16x16x32_bf16 v[108:111], a[140:143], a[172:175], v[108:111]
ds_read_b128 a[128:131], v13 offset:14336
v_mfma_f32_16x16x32_bf16 v[112:115], a[144:147], a[152:155], v[112:115]
s_add_u32 m0, s42, 118784
s_nop 0
buffer_load_dwordx4 v168, s[16:19], s44 offen offset:0 lds
ds_read_b128 a[132:135], v13 offset:16384
v_mfma_f32_16x16x32_bf16 v[116:119], a[144:147], a[156:159], v[116:119]
v_mfma_f32_16x16x32_bf16 v[120:123], a[144:147], a[160:163], v[120:123]
v_mfma_f32_16x16x32_bf16 v[124:127], a[144:147], a[164:167], v[124:127]
buffer_load_dwordx4 v169, s[16:19], s44 offen offset:1024 lds
v_mfma_f32_16x16x32_bf16 v[128:131], a[144:147], a[168:171], v[128:131]
v_mfma_f32_16x16x32_bf16 v[132:135], a[144:147], a[172:175], v[132:135]
v_mfma_f32_16x16x32_bf16 v[136:139], a[148:151], a[152:155], v[136:139]
v_mfma_f32_16x16x32_bf16 v[140:143], a[148:151], a[156:159], v[140:143]
s_mov_b32 s44, 2621440
s_add_u32 m0, s39, 139264
s_nop 0
buffer_load_dwordx4 v160, s[28:31], s44 offen offset:0 lds
v_mfma_f32_16x16x32_bf16 v[144:147], a[148:151], a[160:163], v[144:147]
v_mfma_f32_16x16x32_bf16 v[148:151], a[148:151], a[164:167], v[148:151]
v_mfma_f32_16x16x32_bf16 v[152:155], a[148:151], a[168:171], v[152:155]
v_mfma_f32_16x16x32_bf16 v[156:159], a[148:151], a[172:175], v[156:159]
buffer_load_dwordx4 v161, s[28:31], s44 offen offset:1024 lds
s_waitcnt lgkmcnt(0)
v_mfma_f32_16x16x32_bf16 v[64:67], a[96:99], a[112:115], v[64:67]
ds_read_b64_tr_b16 a[136:137], v22 offset:8192
buffer_load_dwordx4 v162, s[28:31], s44 offen offset:2048 lds
v_mfma_f32_16x16x32_bf16 v[68:71], a[96:99], a[116:119], v[68:71]
ds_read_b64_tr_b16 a[138:139], v22 offset:9216
v_mfma_f32_16x16x32_bf16 v[72:75], a[96:99], a[120:123], v[72:75]
ds_read_b64_tr_b16 a[140:141], v23 offset:8192
v_mfma_f32_16x16x32_bf16 v[76:79], a[96:99], a[124:127], v[76:79]
ds_read_b64_tr_b16 a[142:143], v23 offset:9216
v_mfma_f32_16x16x32_bf16 v[80:83], a[96:99], a[128:131], v[80:83]
buffer_load_dwordx4 v163, s[28:31], s44 offen offset:3072 lds
ds_read_b64_tr_b16 a[144:145], v24 offset:8192
v_mfma_f32_16x16x32_bf16 v[84:87], a[96:99], a[132:135], v[84:87]
ds_read_b64_tr_b16 a[146:147], v24 offset:9216
v_mfma_f32_16x16x32_bf16 v[88:91], a[100:103], a[112:115], v[88:91]
ds_read_b64_tr_b16 a[148:149], v25 offset:8192
ds_read_b64_tr_b16 a[150:151], v25 offset:9216
v_mfma_f32_16x16x32_bf16 v[92:95], a[100:103], a[116:119], v[92:95]
ds_read_b128 a[152:155], v14 offset:0
v_mfma_f32_16x16x32_bf16 v[96:99], a[100:103], a[120:123], v[96:99]
ds_read_b128 a[156:159], v14 offset:2048
v_mfma_f32_16x16x32_bf16 v[100:103], a[100:103], a[124:127], v[100:103]
ds_read_b128 a[160:163], v14 offset:4096
v_mfma_f32_16x16x32_bf16 v[104:107], a[100:103], a[128:131], v[104:107]
ds_read_b128 a[164:167], v14 offset:12288
v_mfma_f32_16x16x32_bf16 v[108:111], a[100:103], a[132:135], v[108:111]
ds_read_b128 a[168:171], v14 offset:14336
v_mfma_f32_16x16x32_bf16 v[112:115], a[104:107], a[112:115], v[112:115]
ds_read_b128 a[172:175], v14 offset:16384
v_mfma_f32_16x16x32_bf16 v[116:119], a[104:107], a[116:119], v[116:119]
v_mfma_f32_16x16x32_bf16 v[120:123], a[104:107], a[120:123], v[120:123]
v_mfma_f32_16x16x32_bf16 v[124:127], a[104:107], a[124:127], v[124:127]
v_mfma_f32_16x16x32_bf16 v[128:131], a[104:107], a[128:131], v[128:131]
v_mfma_f32_16x16x32_bf16 v[132:135], a[104:107], a[132:135], v[132:135]
v_mfma_f32_16x16x32_bf16 v[136:139], a[108:111], a[112:115], v[136:139]
v_mfma_f32_16x16x32_bf16 v[140:143], a[108:111], a[116:119], v[140:143]
v_mfma_f32_16x16x32_bf16 v[144:147], a[108:111], a[120:123], v[144:147]
v_mfma_f32_16x16x32_bf16 v[148:151], a[108:111], a[124:127], v[148:151]
v_mfma_f32_16x16x32_bf16 v[152:155], a[108:111], a[128:131], v[152:155]
v_mfma_f32_16x16x32_bf16 v[156:159], a[108:111], a[132:135], v[156:159]
s_waitcnt lgkmcnt(0)
s_waitcnt vmcnt(10)
s_barrier
s_mov_b32 s44, 768
s_add_u32 m0, s42, 73728
s_nop 0
buffer_load_dwordx4 v164, s[16:19], s44 offen offset:0 lds
v_mfma_f32_16x16x32_bf16 v[64:67], a[136:139], a[152:155], v[64:67]
ds_read_b64_tr_b16 a[96:97], v26 offset:0
v_mfma_f32_16x16x32_bf16 v[68:71], a[136:139], a[156:159], v[68:71]
ds_read_b64_tr_b16 a[98:99], v26 offset:1024
v_mfma_f32_16x16x32_bf16 v[72:75], a[136:139], a[160:163], v[72:75]
buffer_load_dwordx4 v165, s[16:19], s44 offen offset:1024 lds
ds_read_b64_tr_b16 a[100:101], v27 offset:0
v_mfma_f32_16x16x32_bf16 v[76:79], a[136:139], a[164:167], v[76:79]
ds_read_b64_tr_b16 a[102:103], v27 offset:1024
v_mfma_f32_16x16x32_bf16 v[80:83], a[136:139], a[168:171], v[80:83]
ds_read_b64_tr_b16 a[104:105], v28 offset:0
v_mfma_f32_16x16x32_bf16 v[84:87], a[136:139], a[172:175], v[84:87]
ds_read_b64_tr_b16 a[106:107], v28 offset:1024
buffer_load_dwordx4 v166, s[16:19], s44 offen offset:2048 lds
v_mfma_f32_16x16x32_bf16 v[88:91], a[140:143], a[152:155], v[88:91]
ds_read_b64_tr_b16 a[108:109], v29 offset:0
ds_read_b64_tr_b16 a[110:111], v29 offset:1024
v_mfma_f32_16x16x32_bf16 v[92:95], a[140:143], a[156:159], v[92:95]
ds_read_b128 a[112:115], v15 offset:0
v_mfma_f32_16x16x32_bf16 v[96:99], a[140:143], a[160:163], v[96:99]
ds_read_b128 a[116:119], v15 offset:2048
buffer_load_dwordx4 v167, s[16:19], s44 offen offset:3072 lds
v_mfma_f32_16x16x32_bf16 v[100:103], a[140:143], a[164:167], v[100:103]
ds_read_b128 a[120:123], v15 offset:4096
v_mfma_f32_16x16x32_bf16 v[104:107], a[140:143], a[168:171], v[104:107]
ds_read_b128 a[124:127], v15 offset:12288
v_mfma_f32_16x16x32_bf16 v[108:111], a[140:143], a[172:175], v[108:111]
ds_read_b128 a[128:131], v15 offset:14336
v_mfma_f32_16x16x32_bf16 v[112:115], a[144:147], a[152:155], v[112:115]
s_add_u32 m0, s42, 77824
s_nop 0
buffer_load_dwordx4 v168, s[16:19], s44 offen offset:0 lds
ds_read_b128 a[132:135], v15 offset:16384
v_mfma_f32_16x16x32_bf16 v[116:119], a[144:147], a[156:159], v[116:119]
v_mfma_f32_16x16x32_bf16 v[120:123], a[144:147], a[160:163], v[120:123]
v_mfma_f32_16x16x32_bf16 v[124:127], a[144:147], a[164:167], v[124:127]
buffer_load_dwordx4 v169, s[16:19], s44 offen offset:1024 lds
v_mfma_f32_16x16x32_bf16 v[128:131], a[144:147], a[168:171], v[128:131]
v_mfma_f32_16x16x32_bf16 v[132:135], a[144:147], a[172:175], v[132:135]
v_mfma_f32_16x16x32_bf16 v[136:139], a[148:151], a[152:155], v[136:139]
v_mfma_f32_16x16x32_bf16 v[140:143], a[148:151], a[156:159], v[140:143]
s_mov_b32 s44, 3145728
s_add_u32 m0, s39, 98304
s_nop 0
buffer_load_dwordx4 v160, s[28:31], s44 offen offset:0 lds
v_mfma_f32_16x16x32_bf16 v[144:147], a[148:151], a[160:163], v[144:147]
v_mfma_f32_16x16x32_bf16 v[148:151], a[148:151], a[164:167], v[148:151]
v_mfma_f32_16x16x32_bf16 v[152:155], a[148:151], a[168:171], v[152:155]
v_mfma_f32_16x16x32_bf16 v[156:159], a[148:151], a[172:175], v[156:159]
buffer_load_dwordx4 v161, s[28:31], s44 offen offset:1024 lds
s_waitcnt lgkmcnt(0)
v_mfma_f32_16x16x32_bf16 v[64:67], a[96:99], a[112:115], v[64:67]
ds_read_b64_tr_b16 a[136:137], v26 offset:8192
buffer_load_dwordx4 v162, s[28:31], s44 offen offset:2048 lds
v_mfma_f32_16x16x32_bf16 v[68:71], a[96:99], a[116:119], v[68:71]
ds_read_b64_tr_b16 a[138:139], v26 offset:9216
v_mfma_f32_16x16x32_bf16 v[72:75], a[96:99], a[120:123], v[72:75]
ds_read_b64_tr_b16 a[140:141], v27 offset:8192
v_mfma_f32_16x16x32_bf16 v[76:79], a[96:99], a[124:127], v[76:79]
ds_read_b64_tr_b16 a[142:143], v27 offset:9216
v_mfma_f32_16x16x32_bf16 v[80:83], a[96:99], a[128:131], v[80:83]
buffer_load_dwordx4 v163, s[28:31], s44 offen offset:3072 lds
ds_read_b64_tr_b16 a[144:145], v28 offset:8192
v_mfma_f32_16x16x32_bf16 v[84:87], a[96:99], a[132:135], v[84:87]
ds_read_b64_tr_b16 a[146:147], v28 offset:9216
v_mfma_f32_16x16x32_bf16 v[88:91], a[100:103], a[112:115], v[88:91]
ds_read_b64_tr_b16 a[148:149], v29 offset:8192
ds_read_b64_tr_b16 a[150:151], v29 offset:9216
v_mfma_f32_16x16x32_bf16 v[92:95], a[100:103], a[116:119], v[92:95]
ds_read_b128 a[152:155], v16 offset:0
v_mfma_f32_16x16x32_bf16 v[96:99], a[100:103], a[120:123], v[96:99]
ds_read_b128 a[156:159], v16 offset:2048
v_mfma_f32_16x16x32_bf16 v[100:103], a[100:103], a[124:127], v[100:103]
ds_read_b128 a[160:163], v16 offset:4096
v_mfma_f32_16x16x32_bf16 v[104:107], a[100:103], a[128:131], v[104:107]
ds_read_b128 a[164:167], v16 offset:12288
v_mfma_f32_16x16x32_bf16 v[108:111], a[100:103], a[132:135], v[108:111]
ds_read_b128 a[168:171], v16 offset:14336
v_mfma_f32_16x16x32_bf16 v[112:115], a[104:107], a[112:115], v[112:115]
ds_read_b128 a[172:175], v16 offset:16384
v_mfma_f32_16x16x32_bf16 v[116:119], a[104:107], a[116:119], v[116:119]
v_mfma_f32_16x16x32_bf16 v[120:123], a[104:107], a[120:123], v[120:123]
v_mfma_f32_16x16x32_bf16 v[124:127], a[104:107], a[124:127], v[124:127]
v_mfma_f32_16x16x32_bf16 v[128:131], a[104:107], a[128:131], v[128:131]
v_mfma_f32_16x16x32_bf16 v[132:135], a[104:107], a[132:135], v[132:135]
v_mfma_f32_16x16x32_bf16 v[136:139], a[108:111], a[112:115], v[136:139]
v_mfma_f32_16x16x32_bf16 v[140:143], a[108:111], a[116:119], v[140:143]
v_mfma_f32_16x16x32_bf16 v[144:147], a[108:111], a[120:123], v[144:147]
v_mfma_f32_16x16x32_bf16 v[148:151], a[108:111], a[124:127], v[148:151]
v_mfma_f32_16x16x32_bf16 v[152:155], a[108:111], a[128:131], v[152:155]
v_mfma_f32_16x16x32_bf16 v[156:159], a[108:111], a[132:135], v[156:159]
s_waitcnt lgkmcnt(0)
s_waitcnt vmcnt(10)
s_barrier
s_mov_b32 s44, 896
s_add_u32 m0, s42, 32768
s_nop 0
buffer_load_dwordx4 v164, s[16:19], s44 offen offset:0 lds
v_mfma_f32_16x16x32_bf16 v[64:67], a[136:139], a[152:155], v[64:67]
ds_read_b64_tr_b16 a[96:97], v30 offset:0
v_mfma_f32_16x16x32_bf16 v[68:71], a[136:139], a[156:159], v[68:71]
ds_read_b64_tr_b16 a[98:99], v30 offset:1024
v_mfma_f32_16x16x32_bf16 v[72:75], a[136:139], a[160:163], v[72:75]
buffer_load_dwordx4 v165, s[16:19], s44 offen offset:1024 lds
ds_read_b64_tr_b16 a[100:101], v31 offset:0
v_mfma_f32_16x16x32_bf16 v[76:79], a[136:139], a[164:167], v[76:79]
ds_read_b64_tr_b16 a[102:103], v31 offset:1024
v_mfma_f32_16x16x32_bf16 v[80:83], a[136:139], a[168:171], v[80:83]
ds_read_b64_tr_b16 a[104:105], v32 offset:0
v_mfma_f32_16x16x32_bf16 v[84:87], a[136:139], a[172:175], v[84:87]
ds_read_b64_tr_b16 a[106:107], v32 offset:1024
buffer_load_dwordx4 v166, s[16:19], s44 offen offset:2048 lds
v_mfma_f32_16x16x32_bf16 v[88:91], a[140:143], a[152:155], v[88:91]
ds_read_b64_tr_b16 a[108:109], v33 offset:0
ds_read_b64_tr_b16 a[110:111], v33 offset:1024
v_mfma_f32_16x16x32_bf16 v[92:95], a[140:143], a[156:159], v[92:95]
ds_read_b128 a[112:115], v17 offset:0
v_mfma_f32_16x16x32_bf16 v[96:99], a[140:143], a[160:163], v[96:99]
ds_read_b128 a[116:119], v17 offset:2048
buffer_load_dwordx4 v167, s[16:19], s44 offen offset:3072 lds
v_mfma_f32_16x16x32_bf16 v[100:103], a[140:143], a[164:167], v[100:103]
ds_read_b128 a[120:123], v17 offset:4096
v_mfma_f32_16x16x32_bf16 v[104:107], a[140:143], a[168:171], v[104:107]
ds_read_b128 a[124:127], v17 offset:12288
v_mfma_f32_16x16x32_bf16 v[108:111], a[140:143], a[172:175], v[108:111]
ds_read_b128 a[128:131], v17 offset:14336
v_mfma_f32_16x16x32_bf16 v[112:115], a[144:147], a[152:155], v[112:115]
s_add_u32 m0, s42, 36864
s_nop 0
buffer_load_dwordx4 v168, s[16:19], s44 offen offset:0 lds
ds_read_b128 a[132:135], v17 offset:16384
v_mfma_f32_16x16x32_bf16 v[116:119], a[144:147], a[156:159], v[116:119]
v_mfma_f32_16x16x32_bf16 v[120:123], a[144:147], a[160:163], v[120:123]
v_mfma_f32_16x16x32_bf16 v[124:127], a[144:147], a[164:167], v[124:127]
buffer_load_dwordx4 v169, s[16:19], s44 offen offset:1024 lds
v_mfma_f32_16x16x32_bf16 v[128:131], a[144:147], a[168:171], v[128:131]
v_mfma_f32_16x16x32_bf16 v[132:135], a[144:147], a[172:175], v[132:135]
v_mfma_f32_16x16x32_bf16 v[136:139], a[148:151], a[152:155], v[136:139]
v_mfma_f32_16x16x32_bf16 v[140:143], a[148:151], a[156:159], v[140:143]
s_mov_b32 s44, 3670016
s_add_u32 m0, s39, 57344
s_nop 0
buffer_load_dwordx4 v160, s[28:31], s44 offen offset:0 lds
v_mfma_f32_16x16x32_bf16 v[144:147], a[148:151], a[160:163], v[144:147]
v_mfma_f32_16x16x32_bf16 v[148:151], a[148:151], a[164:167], v[148:151]
v_mfma_f32_16x16x32_bf16 v[152:155], a[148:151], a[168:171], v[152:155]
v_mfma_f32_16x16x32_bf16 v[156:159], a[148:151], a[172:175], v[156:159]
buffer_load_dwordx4 v161, s[28:31], s44 offen offset:1024 lds
s_waitcnt lgkmcnt(0)
v_mfma_f32_16x16x32_bf16 v[64:67], a[96:99], a[112:115], v[64:67]
ds_read_b64_tr_b16 a[136:137], v30 offset:8192
buffer_load_dwordx4 v162, s[28:31], s44 offen offset:2048 lds
v_mfma_f32_16x16x32_bf16 v[68:71], a[96:99], a[116:119], v[68:71]
ds_read_b64_tr_b16 a[138:139], v30 offset:9216
v_mfma_f32_16x16x32_bf16 v[72:75], a[96:99], a[120:123], v[72:75]
ds_read_b64_tr_b16 a[140:141], v31 offset:8192
v_mfma_f32_16x16x32_bf16 v[76:79], a[96:99], a[124:127], v[76:79]
ds_read_b64_tr_b16 a[142:143], v31 offset:9216
v_mfma_f32_16x16x32_bf16 v[80:83], a[96:99], a[128:131], v[80:83]
buffer_load_dwordx4 v163, s[28:31], s44 offen offset:3072 lds
ds_read_b64_tr_b16 a[144:145], v32 offset:8192
v_mfma_f32_16x16x32_bf16 v[84:87], a[96:99], a[132:135], v[84:87]
ds_read_b64_tr_b16 a[146:147], v32 offset:9216
v_mfma_f32_16x16x32_bf16 v[88:91], a[100:103], a[112:115], v[88:91]
ds_read_b64_tr_b16 a[148:149], v33 offset:8192
ds_read_b64_tr_b16 a[150:151], v33 offset:9216
v_mfma_f32_16x16x32_bf16 v[92:95], a[100:103], a[116:119], v[92:95]
ds_read_b128 a[152:155], v18 offset:0
v_mfma_f32_16x16x32_bf16 v[96:99], a[100:103], a[120:123], v[96:99]
ds_read_b128 a[156:159], v18 offset:2048
v_mfma_f32_16x16x32_bf16 v[100:103], a[100:103], a[124:127], v[100:103]
ds_read_b128 a[160:163], v18 offset:4096
v_mfma_f32_16x16x32_bf16 v[104:107], a[100:103], a[128:131], v[104:107]
ds_read_b128 a[164:167], v18 offset:12288
v_mfma_f32_16x16x32_bf16 v[108:111], a[100:103], a[132:135], v[108:111]
ds_read_b128 a[168:171], v18 offset:14336
v_mfma_f32_16x16x32_bf16 v[112:115], a[104:107], a[112:115], v[112:115]
ds_read_b128 a[172:175], v18 offset:16384
v_mfma_f32_16x16x32_bf16 v[116:119], a[104:107], a[116:119], v[116:119]
v_mfma_f32_16x16x32_bf16 v[120:123], a[104:107], a[120:123], v[120:123]
v_mfma_f32_16x16x32_bf16 v[124:127], a[104:107], a[124:127], v[124:127]
v_mfma_f32_16x16x32_bf16 v[128:131], a[104:107], a[128:131], v[128:131]
v_mfma_f32_16x16x32_bf16 v[132:135], a[104:107], a[132:135], v[132:135]
v_mfma_f32_16x16x32_bf16 v[136:139], a[108:111], a[112:115], v[136:139]
v_mfma_f32_16x16x32_bf16 v[140:143], a[108:111], a[116:119], v[140:143]
v_mfma_f32_16x16x32_bf16 v[144:147], a[108:111], a[120:123], v[144:147]
v_mfma_f32_16x16x32_bf16 v[148:151], a[108:111], a[124:127], v[148:151]
v_mfma_f32_16x16x32_bf16 v[152:155], a[108:111], a[128:131], v[152:155]
v_mfma_f32_16x16x32_bf16 v[156:159], a[108:111], a[132:135], v[156:159]
s_waitcnt lgkmcnt(0)
s_waitcnt vmcnt(10)
s_barrier
s_mov_b32 s44, 1024
s_add_u32 m0, s42, 114688
s_nop 0
buffer_load_dwordx4 v164, s[16:19], s44 offen offset:0 lds
v_mfma_f32_16x16x32_bf16 v[64:67], a[136:139], a[152:155], v[64:67]
ds_read_b64_tr_b16 a[96:97], v22 offset:0
v_mfma_f32_16x16x32_bf16 v[68:71], a[136:139], a[156:159], v[68:71]
ds_read_b64_tr_b16 a[98:99], v22 offset:1024
v_mfma_f32_16x16x32_bf16 v[72:75], a[136:139], a[160:163], v[72:75]
buffer_load_dwordx4 v165, s[16:19], s44 offen offset:1024 lds
ds_read_b64_tr_b16 a[100:101], v23 offset:0
v_mfma_f32_16x16x32_bf16 v[76:79], a[136:139], a[164:167], v[76:79]
ds_read_b64_tr_b16 a[102:103], v23 offset:1024
v_mfma_f32_16x16x32_bf16 v[80:83], a[136:139], a[168:171], v[80:83]
ds_read_b64_tr_b16 a[104:105], v24 offset:0
v_mfma_f32_16x16x32_bf16 v[84:87], a[136:139], a[172:175], v[84:87]
ds_read_b64_tr_b16 a[106:107], v24 offset:1024
buffer_load_dwordx4 v166, s[16:19], s44 offen offset:2048 lds
v_mfma_f32_16x16x32_bf16 v[88:91], a[140:143], a[152:155], v[88:91]
ds_read_b64_tr_b16 a[108:109], v25 offset:0
ds_read_b64_tr_b16 a[110:111], v25 offset:1024
v_mfma_f32_16x16x32_bf16 v[92:95], a[140:143], a[156:159], v[92:95]
ds_read_b128 a[112:115], v13 offset:0
v_mfma_f32_16x16x32_bf16 v[96:99], a[140:143], a[160:163], v[96:99]
ds_read_b128 a[116:119], v13 offset:2048
buffer_load_dwordx4 v167, s[16:19], s44 offen offset:3072 lds
v_mfma_f32_16x16x32_bf16 v[100:103], a[140:143], a[164:167], v[100:103]
ds_read_b128 a[120:123], v13 offset:4096
v_mfma_f32_16x16x32_bf16 v[104:107], a[140:143], a[168:171], v[104:107]
ds_read_b128 a[124:127], v13 offset:12288
v_mfma_f32_16x16x32_bf16 v[108:111], a[140:143], a[172:175], v[108:111]
ds_read_b128 a[128:131], v13 offset:14336
v_mfma_f32_16x16x32_bf16 v[112:115], a[144:147], a[152:155], v[112:115]
s_add_u32 m0, s42, 118784
s_nop 0
buffer_load_dwordx4 v168, s[16:19], s44 offen offset:0 lds
ds_read_b128 a[132:135], v13 offset:16384
v_mfma_f32_16x16x32_bf16 v[116:119], a[144:147], a[156:159], v[116:119]
v_mfma_f32_16x16x32_bf16 v[120:123], a[144:147], a[160:163], v[120:123]
v_mfma_f32_16x16x32_bf16 v[124:127], a[144:147], a[164:167], v[124:127]
buffer_load_dwordx4 v169, s[16:19], s44 offen offset:1024 lds
v_mfma_f32_16x16x32_bf16 v[128:131], a[144:147], a[168:171], v[128:131]
v_mfma_f32_16x16x32_bf16 v[132:135], a[144:147], a[172:175], v[132:135]
v_mfma_f32_16x16x32_bf16 v[136:139], a[148:151], a[152:155], v[136:139]
v_mfma_f32_16x16x32_bf16 v[140:143], a[148:151], a[156:159], v[140:143]
s_mov_b32 s44, 4194304
s_add_u32 m0, s39, 139264
s_nop 0
buffer_load_dwordx4 v160, s[28:31], s44 offen offset:0 lds
v_mfma_f32_16x16x32_bf16 v[144:147], a[148:151], a[160:163], v[144:147]
v_mfma_f32_16x16x32_bf16 v[148:151], a[148:151], a[164:167], v[148:151]
v_mfma_f32_16x16x32_bf16 v[152:155], a[148:151], a[168:171], v[152:155]
v_mfma_f32_16x16x32_bf16 v[156:159], a[148:151], a[172:175], v[156:159]
buffer_load_dwordx4 v161, s[28:31], s44 offen offset:1024 lds
s_waitcnt lgkmcnt(0)
v_mfma_f32_16x16x32_bf16 v[64:67], a[96:99], a[112:115], v[64:67]
ds_read_b64_tr_b16 a[136:137], v22 offset:8192
buffer_load_dwordx4 v162, s[28:31], s44 offen offset:2048 lds
v_mfma_f32_16x16x32_bf16 v[68:71], a[96:99], a[116:119], v[68:71]
ds_read_b64_tr_b16 a[138:139], v22 offset:9216
v_mfma_f32_16x16x32_bf16 v[72:75], a[96:99], a[120:123], v[72:75]
ds_read_b64_tr_b16 a[140:141], v23 offset:8192
v_mfma_f32_16x16x32_bf16 v[76:79], a[96:99], a[124:127], v[76:79]
ds_read_b64_tr_b16 a[142:143], v23 offset:9216
v_mfma_f32_16x16x32_bf16 v[80:83], a[96:99], a[128:131], v[80:83]
buffer_load_dwordx4 v163, s[28:31], s44 offen offset:3072 lds
ds_read_b64_tr_b16 a[144:145], v24 offset:8192
v_mfma_f32_16x16x32_bf16 v[84:87], a[96:99], a[132:135], v[84:87]
ds_read_b64_tr_b16 a[146:147], v24 offset:9216
v_mfma_f32_16x16x32_bf16 v[88:91], a[100:103], a[112:115], v[88:91]
ds_read_b64_tr_b16 a[148:149], v25 offset:8192
ds_read_b64_tr_b16 a[150:151], v25 offset:9216
v_mfma_f32_16x16x32_bf16 v[92:95], a[100:103], a[116:119], v[92:95]
ds_read_b128 a[152:155], v14 offset:0
v_mfma_f32_16x16x32_bf16 v[96:99], a[100:103], a[120:123], v[96:99]
ds_read_b128 a[156:159], v14 offset:2048
v_mfma_f32_16x16x32_bf16 v[100:103], a[100:103], a[124:127], v[100:103]
ds_read_b128 a[160:163], v14 offset:4096
v_mfma_f32_16x16x32_bf16 v[104:107], a[100:103], a[128:131], v[104:107]
ds_read_b128 a[164:167], v14 offset:12288
v_mfma_f32_16x16x32_bf16 v[108:111], a[100:103], a[132:135], v[108:111]
ds_read_b128 a[168:171], v14 offset:14336
v_mfma_f32_16x16x32_bf16 v[112:115], a[104:107], a[112:115], v[112:115]
ds_read_b128 a[172:175], v14 offset:16384
v_mfma_f32_16x16x32_bf16 v[116:119], a[104:107], a[116:119], v[116:119]
v_mfma_f32_16x16x32_bf16 v[120:123], a[104:107], a[120:123], v[120:123]
v_mfma_f32_16x16x32_bf16 v[124:127], a[104:107], a[124:127], v[124:127]
v_mfma_f32_16x16x32_bf16 v[128:131], a[104:107], a[128:131], v[128:131]
v_mfma_f32_16x16x32_bf16 v[132:135], a[104:107], a[132:135], v[132:135]
v_mfma_f32_16x16x32_bf16 v[136:139], a[108:111], a[112:115], v[136:139]
v_mfma_f32_16x16x32_bf16 v[140:143], a[108:111], a[116:119], v[140:143]
v_mfma_f32_16x16x32_bf16 v[144:147], a[108:111], a[120:123], v[144:147]
v_mfma_f32_16x16x32_bf16 v[148:151], a[108:111], a[124:127], v[148:151]
v_mfma_f32_16x16x32_bf16 v[152:155], a[108:111], a[128:131], v[152:155]
v_mfma_f32_16x16x32_bf16 v[156:159], a[108:111], a[132:135], v[156:159]
s_waitcnt lgkmcnt(0)
s_waitcnt vmcnt(10)
s_barrier
s_mov_b32 s44, 1152
s_add_u32 m0, s42, 73728
s_nop 0
buffer_load_dwordx4 v164, s[16:19], s44 offen offset:0 lds
v_mfma_f32_16x16x32_bf16 v[64:67], a[136:139], a[152:155], v[64:67]
ds_read_b64_tr_b16 a[96:97], v26 offset:0
v_mfma_f32_16x16x32_bf16 v[68:71], a[136:139], a[156:159], v[68:71]
ds_read_b64_tr_b16 a[98:99], v26 offset:1024
v_mfma_f32_16x16x32_bf16 v[72:75], a[136:139], a[160:163], v[72:75]
buffer_load_dwordx4 v165, s[16:19], s44 offen offset:1024 lds
ds_read_b64_tr_b16 a[100:101], v27 offset:0
v_mfma_f32_16x16x32_bf16 v[76:79], a[136:139], a[164:167], v[76:79]
ds_read_b64_tr_b16 a[102:103], v27 offset:1024
v_mfma_f32_16x16x32_bf16 v[80:83], a[136:139], a[168:171], v[80:83]
ds_read_b64_tr_b16 a[104:105], v28 offset:0
v_mfma_f32_16x16x32_bf16 v[84:87], a[136:139], a[172:175], v[84:87]
ds_read_b64_tr_b16 a[106:107], v28 offset:1024
buffer_load_dwordx4 v166, s[16:19], s44 offen offset:2048 lds
v_mfma_f32_16x16x32_bf16 v[88:91], a[140:143], a[152:155], v[88:91]
ds_read_b64_tr_b16 a[108:109], v29 offset:0
ds_read_b64_tr_b16 a[110:111], v29 offset:1024
v_mfma_f32_16x16x32_bf16 v[92:95], a[140:143], a[156:159], v[92:95]
ds_read_b128 a[112:115], v15 offset:0
v_mfma_f32_16x16x32_bf16 v[96:99], a[140:143], a[160:163], v[96:99]
ds_read_b128 a[116:119], v15 offset:2048
buffer_load_dwordx4 v167, s[16:19], s44 offen offset:3072 lds
v_mfma_f32_16x16x32_bf16 v[100:103], a[140:143], a[164:167], v[100:103]
ds_read_b128 a[120:123], v15 offset:4096
v_mfma_f32_16x16x32_bf16 v[104:107], a[140:143], a[168:171], v[104:107]
ds_read_b128 a[124:127], v15 offset:12288
v_mfma_f32_16x16x32_bf16 v[108:111], a[140:143], a[172:175], v[108:111]
ds_read_b128 a[128:131], v15 offset:14336
v_mfma_f32_16x16x32_bf16 v[112:115], a[144:147], a[152:155], v[112:115]
s_add_u32 m0, s42, 77824
s_nop 0
buffer_load_dwordx4 v168, s[16:19], s44 offen offset:0 lds
ds_read_b128 a[132:135], v15 offset:16384
v_mfma_f32_16x16x32_bf16 v[116:119], a[144:147], a[156:159], v[116:119]
v_mfma_f32_16x16x32_bf16 v[120:123], a[144:147], a[160:163], v[120:123]
v_mfma_f32_16x16x32_bf16 v[124:127], a[144:147], a[164:167], v[124:127]
buffer_load_dwordx4 v169, s[16:19], s44 offen offset:1024 lds
v_mfma_f32_16x16x32_bf16 v[128:131], a[144:147], a[168:171], v[128:131]
v_mfma_f32_16x16x32_bf16 v[132:135], a[144:147], a[172:175], v[132:135]
v_mfma_f32_16x16x32_bf16 v[136:139], a[148:151], a[152:155], v[136:139]
v_mfma_f32_16x16x32_bf16 v[140:143], a[148:151], a[156:159], v[140:143]
s_mov_b32 s44, 4718592
s_add_u32 m0, s39, 98304
s_nop 0
buffer_load_dwordx4 v160, s[28:31], s44 offen offset:0 lds
v_mfma_f32_16x16x32_bf16 v[144:147], a[148:151], a[160:163], v[144:147]
v_mfma_f32_16x16x32_bf16 v[148:151], a[148:151], a[164:167], v[148:151]
v_mfma_f32_16x16x32_bf16 v[152:155], a[148:151], a[168:171], v[152:155]
v_mfma_f32_16x16x32_bf16 v[156:159], a[148:151], a[172:175], v[156:159]
buffer_load_dwordx4 v161, s[28:31], s44 offen offset:1024 lds
s_waitcnt lgkmcnt(0)
v_mfma_f32_16x16x32_bf16 v[64:67], a[96:99], a[112:115], v[64:67]
ds_read_b64_tr_b16 a[136:137], v26 offset:8192
buffer_load_dwordx4 v162, s[28:31], s44 offen offset:2048 lds
v_mfma_f32_16x16x32_bf16 v[68:71], a[96:99], a[116:119], v[68:71]
ds_read_b64_tr_b16 a[138:139], v26 offset:9216
v_mfma_f32_16x16x32_bf16 v[72:75], a[96:99], a[120:123], v[72:75]
ds_read_b64_tr_b16 a[140:141], v27 offset:8192
v_mfma_f32_16x16x32_bf16 v[76:79], a[96:99], a[124:127], v[76:79]
ds_read_b64_tr_b16 a[142:143], v27 offset:9216
v_mfma_f32_16x16x32_bf16 v[80:83], a[96:99], a[128:131], v[80:83]
buffer_load_dwordx4 v163, s[28:31], s44 offen offset:3072 lds
ds_read_b64_tr_b16 a[144:145], v28 offset:8192
v_mfma_f32_16x16x32_bf16 v[84:87], a[96:99], a[132:135], v[84:87]
ds_read_b64_tr_b16 a[146:147], v28 offset:9216
v_mfma_f32_16x16x32_bf16 v[88:91], a[100:103], a[112:115], v[88:91]
ds_read_b64_tr_b16 a[148:149], v29 offset:8192
ds_read_b64_tr_b16 a[150:151], v29 offset:9216
v_mfma_f32_16x16x32_bf16 v[92:95], a[100:103], a[116:119], v[92:95]
s_mov_b32 s45, 0
s_add_u32 m0, s39, 0
s_nop 0
buffer_load_dwordx4 v4, s[20:23], s45 offen offset:0 nt lds
ds_read_b128 a[152:155], v16 offset:0
v_mfma_f32_16x16x32_bf16 v[96:99], a[100:103], a[120:123], v[96:99]
ds_read_b128 a[156:159], v16 offset:2048
v_mfma_f32_16x16x32_bf16 v[100:103], a[100:103], a[124:127], v[100:103]
ds_read_b128 a[160:163], v16 offset:4096
v_mfma_f32_16x16x32_bf16 v[104:107], a[100:103], a[128:131], v[104:107]
buffer_load_dwordx4 v5, s[20:23], s45 offen offset:1024 nt lds
ds_read_b128 a[164:167], v16 offset:12288
v_mfma_f32_16x16x32_bf16 v[108:111], a[100:103], a[132:135], v[108:111]
ds_read_b128 a[168:171], v16 offset:14336
v_mfma_f32_16x16x32_bf16 v[112:115], a[104:107], a[112:115], v[112:115]
ds_read_b128 a[172:175], v16 offset:16384
v_mfma_f32_16x16x32_bf16 v[116:119], a[104:107], a[116:119], v[116:119]
v_mfma_f32_16x16x32_bf16 v[120:123], a[104:107], a[120:123], v[120:123]
v_mfma_f32_16x16x32_bf16 v[124:127], a[104:107], a[124:127], v[124:127]
buffer_load_dwordx4 v6, s[20:23], s45 offen offset:2048 nt lds
v_mfma_f32_16x16x32_bf16 v[128:131], a[104:107], a[128:131], v[128:131]
v_mfma_f32_16x16x32_bf16 v[132:135], a[104:107], a[132:135], v[132:135]
v_mfma_f32_16x16x32_bf16 v[136:139], a[108:111], a[112:115], v[136:139]
v_mfma_f32_16x16x32_bf16 v[140:143], a[108:111], a[116:119], v[140:143]
v_mfma_f32_16x16x32_bf16 v[144:147], a[108:111], a[120:123], v[144:147]
v_mfma_f32_16x16x32_bf16 v[148:151], a[108:111], a[124:127], v[148:151]
buffer_load_dwordx4 v7, s[20:23], s45 offen offset:3072 nt lds
v_mfma_f32_16x16x32_bf16 v[152:155], a[108:111], a[128:131], v[152:155]
v_mfma_f32_16x16x32_bf16 v[156:159], a[108:111], a[132:135], v[156:159]
s_waitcnt lgkmcnt(0)
s_waitcnt vmcnt(14)
s_barrier
s_mov_b32 s45, 16384
s_add_u32 m0, s39, 16384
s_nop 0
buffer_load_dwordx4 v4, s[20:23], s45 offen offset:0 nt lds
v_mfma_f32_16x16x32_bf16 v[64:67], a[136:139], a[152:155], v[64:67]
ds_read_b64_tr_b16 a[96:97], v30 offset:0
v_mfma_f32_16x16x32_bf16 v[68:71], a[136:139], a[156:159], v[68:71]
buffer_load_dwordx4 v5, s[20:23], s45 offen offset:1024 nt lds
ds_read_b64_tr_b16 a[98:99], v30 offset:1024
v_mfma_f32_16x16x32_bf16 v[72:75], a[136:139], a[160:163], v[72:75]
ds_read_b64_tr_b16 a[100:101], v31 offset:0
v_mfma_f32_16x16x32_bf16 v[76:79], a[136:139], a[164:167], v[76:79]
ds_read_b64_tr_b16 a[102:103], v31 offset:1024
v_mfma_f32_16x16x32_bf16 v[80:83], a[136:139], a[168:171], v[80:83]
ds_read_b64_tr_b16 a[104:105], v32 offset:0
v_mfma_f32_16x16x32_bf16 v[84:87], a[136:139], a[172:175], v[84:87]
ds_read_b64_tr_b16 a[106:107], v32 offset:1024
buffer_load_dwordx4 v6, s[20:23], s45 offen offset:2048 nt lds
v_mfma_f32_16x16x32_bf16 v[88:91], a[140:143], a[152:155], v[88:91]
ds_read_b64_tr_b16 a[108:109], v33 offset:0
ds_read_b64_tr_b16 a[110:111], v33 offset:1024
v_mfma_f32_16x16x32_bf16 v[92:95], a[140:143], a[156:159], v[92:95]
ds_read_b128 a[112:115], v17 offset:0
v_mfma_f32_16x16x32_bf16 v[96:99], a[140:143], a[160:163], v[96:99]
ds_read_b128 a[116:119], v17 offset:2048
v_mfma_f32_16x16x32_bf16 v[100:103], a[140:143], a[164:167], v[100:103]
ds_read_b128 a[120:123], v17 offset:4096
buffer_load_dwordx4 v7, s[20:23], s45 offen offset:3072 nt lds
v_mfma_f32_16x16x32_bf16 v[104:107], a[140:143], a[168:171], v[104:107]
ds_read_b128 a[124:127], v17 offset:12288
v_mfma_f32_16x16x32_bf16 v[108:111], a[140:143], a[172:175], v[108:111]
ds_read_b128 a[128:131], v17 offset:14336
v_mfma_f32_16x16x32_bf16 v[112:115], a[144:147], a[152:155], v[112:115]
ds_read_b128 a[132:135], v17 offset:16384
v_mfma_f32_16x16x32_bf16 v[116:119], a[144:147], a[156:159], v[116:119]
v_mfma_f32_16x16x32_bf16 v[120:123], a[144:147], a[160:163], v[120:123]
s_mov_b32 s45, 32768
buffer_load_dwordx4 v[176:179], v4, s[20:23], s45 offen offset:0 nt
v_mfma_f32_16x16x32_bf16 v[124:127], a[144:147], a[164:167], v[124:127]
v_mfma_f32_16x16x32_bf16 v[128:131], a[144:147], a[168:171], v[128:131]
v_mfma_f32_16x16x32_bf16 v[132:135], a[144:147], a[172:175], v[132:135]
v_mfma_f32_16x16x32_bf16 v[136:139], a[148:151], a[152:155], v[136:139]
v_mfma_f32_16x16x32_bf16 v[140:143], a[148:151], a[156:159], v[140:143]
buffer_load_dwordx4 v[180:183], v5, s[20:23], s45 offen offset:1024 nt
v_mfma_f32_16x16x32_bf16 v[144:147], a[148:151], a[160:163], v[144:147]
v_mfma_f32_16x16x32_bf16 v[148:151], a[148:151], a[164:167], v[148:151]
v_mfma_f32_16x16x32_bf16 v[152:155], a[148:151], a[168:171], v[152:155]
v_mfma_f32_16x16x32_bf16 v[156:159], a[148:151], a[172:175], v[156:159]
s_waitcnt lgkmcnt(0)
buffer_load_dwordx4 v[184:187], v6, s[20:23], s45 offen offset:2048 nt
v_mfma_f32_16x16x32_bf16 v[64:67], a[96:99], a[112:115], v[64:67]
ds_read_b64_tr_b16 a[136:137], v30 offset:8192
v_mfma_f32_16x16x32_bf16 v[68:71], a[96:99], a[116:119], v[68:71]
ds_read_b64_tr_b16 a[138:139], v30 offset:9216
v_mfma_f32_16x16x32_bf16 v[72:75], a[96:99], a[120:123], v[72:75]
ds_read_b64_tr_b16 a[140:141], v31 offset:8192
v_mfma_f32_16x16x32_bf16 v[76:79], a[96:99], a[124:127], v[76:79]
buffer_load_dwordx4 v[188:191], v7, s[20:23], s45 offen offset:3072 nt
ds_read_b64_tr_b16 a[142:143], v31 offset:9216
v_mfma_f32_16x16x32_bf16 v[80:83], a[96:99], a[128:131], v[80:83]
ds_read_b64_tr_b16 a[144:145], v32 offset:8192
v_mfma_f32_16x16x32_bf16 v[84:87], a[96:99], a[132:135], v[84:87]
ds_read_b64_tr_b16 a[146:147], v32 offset:9216
v_mfma_f32_16x16x32_bf16 v[88:91], a[100:103], a[112:115], v[88:91]
ds_read_b64_tr_b16 a[148:149], v33 offset:8192
ds_read_b64_tr_b16 a[150:151], v33 offset:9216
v_mfma_f32_16x16x32_bf16 v[92:95], a[100:103], a[116:119], v[92:95]
s_mov_b32 s45, 49152
buffer_load_dwordx4 v[192:195], v4, s[20:23], s45 offen offset:0 nt
ds_read_b128 a[152:155], v18 offset:0
v_mfma_f32_16x16x32_bf16 v[96:99], a[100:103], a[120:123], v[96:99]
ds_read_b128 a[156:159], v18 offset:2048
v_mfma_f32_16x16x32_bf16 v[100:103], a[100:103], a[124:127], v[100:103]
ds_read_b128 a[160:163], v18 offset:4096
v_mfma_f32_16x16x32_bf16 v[104:107], a[100:103], a[128:131], v[104:107]
ds_read_b128 a[164:167], v18 offset:12288
v_mfma_f32_16x16x32_bf16 v[108:111], a[100:103], a[132:135], v[108:111]
buffer_load_dwordx4 v[196:199], v5, s[20:23], s45 offen offset:1024 nt
ds_read_b128 a[168:171], v18 offset:14336
v_mfma_f32_16x16x32_bf16 v[112:115], a[104:107], a[112:115], v[112:115]
ds_read_b128 a[172:175], v18 offset:16384
v_mfma_f32_16x16x32_bf16 v[116:119], a[104:107], a[116:119], v[116:119]
v_mfma_f32_16x16x32_bf16 v[120:123], a[104:107], a[120:123], v[120:123]
v_mfma_f32_16x16x32_bf16 v[124:127], a[104:107], a[124:127], v[124:127]
v_mfma_f32_16x16x32_bf16 v[128:131], a[104:107], a[128:131], v[128:131]
buffer_load_dwordx4 v[200:203], v6, s[20:23], s45 offen offset:2048 nt
v_mfma_f32_16x16x32_bf16 v[132:135], a[104:107], a[132:135], v[132:135]
v_mfma_f32_16x16x32_bf16 v[136:139], a[108:111], a[112:115], v[136:139]
v_mfma_f32_16x16x32_bf16 v[140:143], a[108:111], a[116:119], v[140:143]
v_mfma_f32_16x16x32_bf16 v[144:147], a[108:111], a[120:123], v[144:147]
v_mfma_f32_16x16x32_bf16 v[148:151], a[108:111], a[124:127], v[148:151]
v_mfma_f32_16x16x32_bf16 v[152:155], a[108:111], a[128:131], v[152:155]
buffer_load_dwordx4 v[204:207], v7, s[20:23], s45 offen offset:3072 nt
v_mfma_f32_16x16x32_bf16 v[156:159], a[108:111], a[132:135], v[156:159]
s_waitcnt lgkmcnt(0)
s_waitcnt vmcnt(16)
s_barrier
s_mov_b32 s45, 65536
buffer_load_dwordx4 v[208:211], v4, s[20:23], s45 offen offset:0 nt
v_mfma_f32_16x16x32_bf16 v[64:67], a[136:139], a[152:155], v[64:67]
ds_read_b64_tr_b16 a[96:97], v22 offset:0
v_mfma_f32_16x16x32_bf16 v[68:71], a[136:139], a[156:159], v[68:71]
ds_read_b64_tr_b16 a[98:99], v22 offset:1024
v_mfma_f32_16x16x32_bf16 v[72:75], a[136:139], a[160:163], v[72:75]
ds_read_b64_tr_b16 a[100:101], v23 offset:0
buffer_load_dwordx4 v[212:215], v5, s[20:23], s45 offen offset:1024 nt
v_mfma_f32_16x16x32_bf16 v[76:79], a[136:139], a[164:167], v[76:79]
ds_read_b64_tr_b16 a[102:103], v23 offset:1024
v_mfma_f32_16x16x32_bf16 v[80:83], a[136:139], a[168:171], v[80:83]
ds_read_b64_tr_b16 a[104:105], v24 offset:0
v_mfma_f32_16x16x32_bf16 v[84:87], a[136:139], a[172:175], v[84:87]
ds_read_b64_tr_b16 a[106:107], v24 offset:1024
v_mfma_f32_16x16x32_bf16 v[88:91], a[140:143], a[152:155], v[88:91]
ds_read_b64_tr_b16 a[108:109], v25 offset:0
ds_read_b64_tr_b16 a[110:111], v25 offset:1024
buffer_load_dwordx4 v[216:219], v6, s[20:23], s45 offen offset:2048 nt
v_mfma_f32_16x16x32_bf16 v[92:95], a[140:143], a[156:159], v[92:95]
ds_read_b128 a[112:115], v13 offset:0
v_mfma_f32_16x16x32_bf16 v[96:99], a[140:143], a[160:163], v[96:99]
ds_read_b128 a[116:119], v13 offset:2048
v_mfma_f32_16x16x32_bf16 v[100:103], a[140:143], a[164:167], v[100:103]
ds_read_b128 a[120:123], v13 offset:4096
v_mfma_f32_16x16x32_bf16 v[104:107], a[140:143], a[168:171], v[104:107]
ds_read_b128 a[124:127], v13 offset:12288
v_mfma_f32_16x16x32_bf16 v[108:111], a[140:143], a[172:175], v[108:111]
buffer_load_dwordx4 v[220:223], v7, s[20:23], s45 offen offset:3072 nt
ds_read_b128 a[128:131], v13 offset:14336
v_mfma_f32_16x16x32_bf16 v[112:115], a[144:147], a[152:155], v[112:115]
ds_read_b128 a[132:135], v13 offset:16384
v_mfma_f32_16x16x32_bf16 v[116:119], a[144:147], a[156:159], v[116:119]
v_mfma_f32_16x16x32_bf16 v[120:123], a[144:147], a[160:163], v[120:123]
v_mfma_f32_16x16x32_bf16 v[124:127], a[144:147], a[164:167], v[124:127]
v_mfma_f32_16x16x32_bf16 v[128:131], a[144:147], a[168:171], v[128:131]
s_mov_b32 s45, 81920
buffer_load_dwordx4 v[224:227], v4, s[20:23], s45 offen offset:0 nt
v_mfma_f32_16x16x32_bf16 v[132:135], a[144:147], a[172:175], v[132:135]
v_mfma_f32_16x16x32_bf16 v[136:139], a[148:151], a[152:155], v[136:139]
v_mfma_f32_16x16x32_bf16 v[140:143], a[148:151], a[156:159], v[140:143]
v_mfma_f32_16x16x32_bf16 v[144:147], a[148:151], a[160:163], v[144:147]
v_mfma_f32_16x16x32_bf16 v[148:151], a[148:151], a[164:167], v[148:151]
buffer_load_dwordx4 v[228:231], v5, s[20:23], s45 offen offset:1024 nt
v_mfma_f32_16x16x32_bf16 v[152:155], a[148:151], a[168:171], v[152:155]
v_mfma_f32_16x16x32_bf16 v[156:159], a[148:151], a[172:175], v[156:159]
s_waitcnt lgkmcnt(0)
v_mfma_f32_16x16x32_bf16 v[64:67], a[96:99], a[112:115], v[64:67]
buffer_load_dwordx4 v[232:235], v6, s[20:23], s45 offen offset:2048 nt
ds_read_b64_tr_b16 a[136:137], v22 offset:8192
v_mfma_f32_16x16x32_bf16 v[68:71], a[96:99], a[116:119], v[68:71]
ds_read_b64_tr_b16 a[138:139], v22 offset:9216
v_mfma_f32_16x16x32_bf16 v[72:75], a[96:99], a[120:123], v[72:75]
ds_read_b64_tr_b16 a[140:141], v23 offset:8192
v_mfma_f32_16x16x32_bf16 v[76:79], a[96:99], a[124:127], v[76:79]
ds_read_b64_tr_b16 a[142:143], v23 offset:9216
v_mfma_f32_16x16x32_bf16 v[80:83], a[96:99], a[128:131], v[80:83]
buffer_load_dwordx4 v[236:239], v7, s[20:23], s45 offen offset:3072 nt
ds_read_b64_tr_b16 a[144:145], v24 offset:8192
v_mfma_f32_16x16x32_bf16 v[84:87], a[96:99], a[132:135], v[84:87]
ds_read_b64_tr_b16 a[146:147], v24 offset:9216
v_mfma_f32_16x16x32_bf16 v[88:91], a[100:103], a[112:115], v[88:91]
ds_read_b64_tr_b16 a[148:149], v25 offset:8192
ds_read_b64_tr_b16 a[150:151], v25 offset:9216
v_mfma_f32_16x16x32_bf16 v[92:95], a[100:103], a[116:119], v[92:95]
ds_read_b128 a[152:155], v14 offset:0
v_mfma_f32_16x16x32_bf16 v[96:99], a[100:103], a[120:123], v[96:99]
s_mov_b32 s45, 98304
buffer_load_dwordx4 v[240:243], v4, s[20:23], s45 offen offset:0 nt
ds_read_b128 a[156:159], v14 offset:2048
v_mfma_f32_16x16x32_bf16 v[100:103], a[100:103], a[124:127], v[100:103]
ds_read_b128 a[160:163], v14 offset:4096
v_mfma_f32_16x16x32_bf16 v[104:107], a[100:103], a[128:131], v[104:107]
ds_read_b128 a[164:167], v14 offset:12288
v_mfma_f32_16x16x32_bf16 v[108:111], a[100:103], a[132:135], v[108:111]
ds_read_b128 a[168:171], v14 offset:14336
v_mfma_f32_16x16x32_bf16 v[112:115], a[104:107], a[112:115], v[112:115]
buffer_load_dwordx4 v[244:247], v5, s[20:23], s45 offen offset:1024 nt
ds_read_b128 a[172:175], v14 offset:16384
v_mfma_f32_16x16x32_bf16 v[116:119], a[104:107], a[116:119], v[116:119]
v_mfma_f32_16x16x32_bf16 v[120:123], a[104:107], a[120:123], v[120:123]
v_mfma_f32_16x16x32_bf16 v[124:127], a[104:107], a[124:127], v[124:127]
v_mfma_f32_16x16x32_bf16 v[128:131], a[104:107], a[128:131], v[128:131]
v_mfma_f32_16x16x32_bf16 v[132:135], a[104:107], a[132:135], v[132:135]
v_mfma_f32_16x16x32_bf16 v[136:139], a[108:111], a[112:115], v[136:139]
buffer_load_dwordx4 v[248:251], v6, s[20:23], s45 offen offset:2048 nt
v_mfma_f32_16x16x32_bf16 v[140:143], a[108:111], a[116:119], v[140:143]
v_mfma_f32_16x16x32_bf16 v[144:147], a[108:111], a[120:123], v[144:147]
v_mfma_f32_16x16x32_bf16 v[148:151], a[108:111], a[124:127], v[148:151]
v_mfma_f32_16x16x32_bf16 v[152:155], a[108:111], a[128:131], v[152:155]
v_mfma_f32_16x16x32_bf16 v[156:159], a[108:111], a[132:135], v[156:159]
buffer_load_dwordx4 v[252:255], v7, s[20:23], s45 offen offset:3072 nt
s_waitcnt lgkmcnt(0)
v_mfma_f32_16x16x32_bf16 v[64:67], a[136:139], a[152:155], v[64:67]
v_mfma_f32_16x16x32_bf16 v[68:71], a[136:139], a[156:159], v[68:71]
v_mfma_f32_16x16x32_bf16 v[72:75], a[136:139], a[160:163], v[72:75]
v_mfma_f32_16x16x32_bf16 v[76:79], a[136:139], a[164:167], v[76:79]
v_mfma_f32_16x16x32_bf16 v[80:83], a[136:139], a[168:171], v[80:83]
v_mfma_f32_16x16x32_bf16 v[84:87], a[136:139], a[172:175], v[84:87]
v_mfma_f32_16x16x32_bf16 v[88:91], a[140:143], a[152:155], v[88:91]
v_mfma_f32_16x16x32_bf16 v[92:95], a[140:143], a[156:159], v[92:95]
v_mfma_f32_16x16x32_bf16 v[96:99], a[140:143], a[160:163], v[96:99]
v_mfma_f32_16x16x32_bf16 v[100:103], a[140:143], a[164:167], v[100:103]
v_mfma_f32_16x16x32_bf16 v[104:107], a[140:143], a[168:171], v[104:107]
v_mfma_f32_16x16x32_bf16 v[108:111], a[140:143], a[172:175], v[108:111]
v_mfma_f32_16x16x32_bf16 v[112:115], a[144:147], a[152:155], v[112:115]
v_mfma_f32_16x16x32_bf16 v[116:119], a[144:147], a[156:159], v[116:119]
v_mfma_f32_16x16x32_bf16 v[120:123], a[144:147], a[160:163], v[120:123]
v_mfma_f32_16x16x32_bf16 v[124:127], a[144:147], a[164:167], v[124:127]
v_mfma_f32_16x16x32_bf16 v[128:131], a[144:147], a[168:171], v[128:131]
v_mfma_f32_16x16x32_bf16 v[132:135], a[144:147], a[172:175], v[132:135]
v_mfma_f32_16x16x32_bf16 v[136:139], a[148:151], a[152:155], v[136:139]
v_mfma_f32_16x16x32_bf16 v[140:143], a[148:151], a[156:159], v[140:143]
v_mfma_f32_16x16x32_bf16 v[144:147], a[148:151], a[160:163], v[144:147]
v_mfma_f32_16x16x32_bf16 v[148:151], a[148:151], a[164:167], v[148:151]
v_mfma_f32_16x16x32_bf16 v[152:155], a[148:151], a[168:171], v[152:155]
v_mfma_f32_16x16x32_bf16 v[156:159], a[148:151], a[172:175], v[156:159]
L_merge:
s_barrier
s_mul_i32 s43, s37, 48
v_add_u32 v40, s43, v2
v_lshlrev_b32 v40, 8, v40
s_lshl_b32 s43, s38, 3
v_lshrrev_b32 v41, 1, v3
v_add_u32 v41, s43, v41
v_xor_b32 v41, v41, v2
v_lshlrev_b32 v41, 4, v41
v_and_b32 v42, 1, v3
v_lshlrev_b32 v42, 3, v42
v_add3_u32 v40, v40, v41, v42
v_add_u32 v40, 114688, v40
v_xor_b32 v41, 32, v40
v_xor_b32 v42, 64, v40
v_xor_b32 v43, 96, v40
v_cvt_pk_bf16_f32 v44, v64, v65
v_cvt_pk_bf16_f32 v45, v66, v67
ds_write_b64 v40, v[44:45] offset:0
v_cvt_pk_bf16_f32 v46, v68, v69
v_cvt_pk_bf16_f32 v47, v70, v71
ds_write_b64 v40, v[46:47] offset:4096
v_cvt_pk_bf16_f32 v48, v72, v73
v_cvt_pk_bf16_f32 v49, v74, v75
ds_write_b64 v40, v[48:49] offset:8192
v_cvt_pk_bf16_f32 v50, v76, v77
v_cvt_pk_bf16_f32 v51, v78, v79
ds_write_b64 v40, v[50:51] offset:24576
v_cvt_pk_bf16_f32 v44, v80, v81
v_cvt_pk_bf16_f32 v45, v82, v83
ds_write_b64 v40, v[44:45] offset:28672
v_cvt_pk_bf16_f32 v46, v84, v85
v_cvt_pk_bf16_f32 v47, v86, v87
ds_write_b64 v40, v[46:47] offset:32768
v_cvt_pk_bf16_f32 v48, v88, v89
v_cvt_pk_bf16_f32 v49, v90, v91
ds_write_b64 v41, v[48:49] offset:0
v_cvt_pk_bf16_f32 v50, v92, v93
v_cvt_pk_bf16_f32 v51, v94, v95
ds_write_b64 v41, v[50:51] offset:4096
v_cvt_pk_bf16_f32 v44, v96, v97
v_cvt_pk_bf16_f32 v45, v98, v99
ds_write_b64 v41, v[44:45] offset:8192
v_cvt_pk_bf16_f32 v46, v100, v101
v_cvt_pk_bf16_f32 v47, v102, v103
ds_write_b64 v41, v[46:47] offset:24576
v_cvt_pk_bf16_f32 v48, v104, v105
v_cvt_pk_bf16_f32 v49, v106, v107
ds_write_b64 v41, v[48:49] offset:28672
v_cvt_pk_bf16_f32 v50, v108, v109
v_cvt_pk_bf16_f32 v51, v110, v111
ds_write_b64 v41, v[50:51] offset:32768
v_cvt_pk_bf16_f32 v44, v112, v113
v_cvt_pk_bf16_f32 v45, v114, v115
ds_write_b64 v42, v[44:45] offset:0
v_cvt_pk_bf16_f32 v46, v116, v117
v_cvt_pk_bf16_f32 v47, v118, v119
ds_write_b64 v42, v[46:47] offset:4096
v_cvt_pk_bf16_f32 v48, v120, v121
v_cvt_pk_bf16_f32 v49, v122, v123
ds_write_b64 v42, v[48:49] offset:8192
v_cvt_pk_bf16_f32 v50, v124, v125
v_cvt_pk_bf16_f32 v51, v126, v127
ds_write_b64 v42, v[50:51] offset:24576
v_cvt_pk_bf16_f32 v44, v128, v129
v_cvt_pk_bf16_f32 v45, v130, v131
ds_write_b64 v42, v[44:45] offset:28672
v_cvt_pk_bf16_f32 v46, v132, v133
v_cvt_pk_bf16_f32 v47, v134, v135
ds_write_b64 v42, v[46:47] offset:32768
v_cvt_pk_bf16_f32 v48, v136, v137
v_cvt_pk_bf16_f32 v49, v138, v139
ds_write_b64 v43, v[48:49] offset:0
v_cvt_pk_bf16_f32 v50, v140, v141
v_cvt_pk_bf16_f32 v51, v142, v143
ds_write_b64 v43, v[50:51] offset:4096
v_cvt_pk_bf16_f32 v44, v144, v145
v_cvt_pk_bf16_f32 v45, v146, v147
ds_write_b64 v43, v[44:45] offset:8192
v_cvt_pk_bf16_f32 v46, v148, v149
v_cvt_pk_bf16_f32 v47, v150, v151
ds_write_b64 v43, v[46:47] offset:24576
v_cvt_pk_bf16_f32 v48, v152, v153
v_cvt_pk_bf16_f32 v49, v154, v155
ds_write_b64 v43, v[48:49] offset:28672
v_cvt_pk_bf16_f32 v50, v156, v157
v_cvt_pk_bf16_f32 v51, v158, v159
ds_write_b64 v43, v[50:51] offset:32768
s_waitcnt lgkmcnt(0)
s_barrier
s_mul_i32 s43, s37, 48
v_add_u32 v40, s43, v2
v_lshlrev_b32 v40, 8, v40
v_xor_b32 v41, v3, v2
v_lshlrev_b32 v41, 4, v41
v_add_u32 v40, v40, v41
v_add_u32 v40, 114688, v40
v_xor_b32 v41, 64, v40
v_xor_b32 v42, 128, v40
v_xor_b32 v43, 192, v40
ds_read_b128 a[0:3], v40 offset:0
ds_read_b128 a[4:7], v41 offset:0
ds_read_b128 a[8:11], v42 offset:0
ds_read_b128 a[12:15], v43 offset:0
ds_read_b128 a[16:19], v40 offset:4096
ds_read_b128 a[20:23], v41 offset:4096
ds_read_b128 a[24:27], v42 offset:4096
ds_read_b128 a[28:31], v43 offset:4096
ds_read_b128 a[32:35], v40 offset:8192
ds_read_b128 a[36:39], v41 offset:8192
ds_read_b128 a[40:43], v42 offset:8192
ds_read_b128 a[44:47], v43 offset:8192
s_waitcnt lgkmcnt(0)
ds_read_b128 a[48:51], v40 offset:24576
ds_read_b128 a[52:55], v41 offset:24576
ds_read_b128 a[56:59], v42 offset:24576
ds_read_b128 a[60:63], v43 offset:24576
ds_read_b128 a[64:67], v40 offset:28672
ds_read_b128 a[68:71], v41 offset:28672
ds_read_b128 a[72:75], v42 offset:28672
ds_read_b128 a[76:79], v43 offset:28672
ds_read_b128 a[80:83], v40 offset:32768
ds_read_b128 a[84:87], v41 offset:32768
ds_read_b128 a[88:91], v42 offset:32768
ds_read_b128 a[92:95], v43 offset:32768
s_waitcnt lgkmcnt(0)
s_waitcnt vmcnt(24)
s_barrier
v_add_u32 v13, 0, v10
v_xor_b32 v14, 64, v13
v_xor_b32 v15, 128, v13
v_xor_b32 v16, 192, v13
ds_read_b128 a[96:99], v13
ds_read_b128 a[100:103], v14
ds_read_b128 a[104:107], v15
ds_read_b128 a[108:111], v16
s_waitcnt lgkmcnt(0)
v_mfma_f32_16x16x32_bf16 v[64:67], a[96:99], a[0:3], 0
v_add_u32 v13, 4096, v10
v_mfma_f32_16x16x32_bf16 v[72:75], a[96:99], a[16:19], 0
v_xor_b32 v14, 64, v13
v_xor_b32 v15, 128, v13
v_mfma_f32_16x16x32_bf16 v[80:83], a[96:99], a[32:35], 0
v_xor_b32 v16, 192, v13
v_mfma_f32_16x16x32_bf16 v[64:67], a[100:103], a[4:7], v[64:67]
ds_read_b128 a[112:115], v13
v_mfma_f32_16x16x32_bf16 v[72:75], a[100:103], a[20:23], v[72:75]
ds_read_b128 a[116:119], v14
ds_read_b128 a[120:123], v15
v_mfma_f32_16x16x32_bf16 v[80:83], a[100:103], a[36:39], v[80:83]
ds_read_b128 a[124:127], v16
v_mfma_f32_16x16x32_bf16 v[64:67], a[104:107], a[8:11], v[64:67]
v_mfma_f32_16x16x32_bf16 v[72:75], a[104:107], a[24:27], v[72:75]
v_mfma_f32_16x16x32_bf16 v[80:83], a[104:107], a[40:43], v[80:83]
v_mfma_f32_16x16x32_bf16 v[64:67], a[108:111], a[12:15], v[64:67]
v_mfma_f32_16x16x32_bf16 v[72:75], a[108:111], a[28:31], v[72:75]
v_mfma_f32_16x16x32_bf16 v[80:83], a[108:111], a[44:47], v[80:83]
s_waitcnt lgkmcnt(0)
s_waitcnt vmcnt(20)
s_barrier
v_mfma_f32_16x16x32_bf16 v[68:71], a[112:115], a[0:3], 0
v_add_u32 v13, 16384, v10
v_mfma_f32_16x16x32_bf16 v[76:79], a[112:115], a[16:19], 0
v_mfma_f32_16x16x32_bf16 v[84:87], a[112:115], a[32:35], 0
v_xor_b32 v14, 64, v13
v_mfma_f32_16x16x32_bf16 v[68:71], a[116:119], a[4:7], v[68:71]
v_xor_b32 v15, 128, v13
v_mfma_f32_16x16x32_bf16 v[76:79], a[116:119], a[20:23], v[76:79]
v_mfma_f32_16x16x32_bf16 v[84:87], a[116:119], a[36:39], v[84:87]
v_xor_b32 v16, 192, v13
v_mfma_f32_16x16x32_bf16 v[68:71], a[120:123], a[8:11], v[68:71]
ds_read_b128 a[96:99], v13
v_mfma_f32_16x16x32_bf16 v[76:79], a[120:123], a[24:27], v[76:79]
v_mfma_f32_16x16x32_bf16 v[84:87], a[120:123], a[40:43], v[84:87]
ds_read_b128 a[100:103], v14
v_mfma_f32_16x16x32_bf16 v[68:71], a[124:127], a[12:15], v[68:71]
ds_read_b128 a[104:107], v15
v_mfma_f32_16x16x32_bf16 v[76:79], a[124:127], a[28:31], v[76:79]
v_mfma_f32_16x16x32_bf16 v[84:87], a[124:127], a[44:47], v[84:87]
ds_read_b128 a[108:111], v16
s_waitcnt lgkmcnt(0)
s_waitcnt vmcnt(16)
v_mfma_f32_16x16x32_bf16 v[88:91], a[96:99], a[0:3], 0
v_add_u32 v13, 20480, v10
v_xor_b32 v14, 64, v13
v_mfma_f32_16x16x32_bf16 v[96:99], a[96:99], a[16:19], 0
v_xor_b32 v15, 128, v13
v_xor_b32 v16, 192, v13
ds_read_b128 a[112:115], v13
v_mfma_f32_16x16x32_bf16 v[104:107], a[96:99], a[32:35], 0
ds_read_b128 a[116:119], v14
ds_read_b128 a[120:123], v15
v_mfma_f32_16x16x32_bf16 v[88:91], a[100:103], a[4:7], v[88:91]
ds_read_b128 a[124:127], v16
v_add_u32 v18, s39, v12
v_mfma_f32_16x16x32_bf16 v[96:99], a[100:103], a[20:23], v[96:99]
v_add_u32 v18, 32768, v18
ds_write_b128 v18, v[176:179] offset:0
ds_write_b128 v18, v[180:183] offset:1024
v_mfma_f32_16x16x32_bf16 v[104:107], a[100:103], a[36:39], v[104:107]
ds_write_b128 v18, v[184:187] offset:2048
ds_write_b128 v18, v[188:191] offset:3072
v_mfma_f32_16x16x32_bf16 v[88:91], a[104:107], a[8:11], v[88:91]
s_mov_b32 s45, 114688
s_add_u32 m0, s39, 0
s_nop 0
buffer_load_dwordx4 v4, s[20:23], s45 offen offset:0 nt lds
v_mfma_f32_16x16x32_bf16 v[96:99], a[104:107], a[24:27], v[96:99]
v_mfma_f32_16x16x32_bf16 v[104:107], a[104:107], a[40:43], v[104:107]
v_mfma_f32_16x16x32_bf16 v[88:91], a[108:111], a[12:15], v[88:91]
v_mfma_f32_16x16x32_bf16 v[96:99], a[108:111], a[28:31], v[96:99]
v_mfma_f32_16x16x32_bf16 v[104:107], a[108:111], a[44:47], v[104:107]
s_waitcnt lgkmcnt(0)
s_barrier
v_mfma_f32_16x16x32_bf16 v[92:95], a[112:115], a[0:3], 0
v_add_u32 v13, 32768, v10
v_xor_b32 v14, 64, v13
v_mfma_f32_16x16x32_bf16 v[100:103], a[112:115], a[16:19], 0
v_xor_b32 v15, 128, v13
v_mfma_f32_16x16x32_bf16 v[108:111], a[112:115], a[32:35], 0
buffer_load_dwordx4 v5, s[20:23], s45 offen offset:1024 nt lds
v_xor_b32 v16, 192, v13
ds_read_b128 a[96:99], v13
v_mfma_f32_16x16x32_bf16 v[92:95], a[116:119], a[4:7], v[92:95]
ds_read_b128 a[100:103], v14
ds_read_b128 a[104:107], v15
v_mfma_f32_16x16x32_bf16 v[100:103], a[116:119], a[20:23], v[100:103]
ds_read_b128 a[108:111], v16
v_mfma_f32_16x16x32_bf16 v[108:111], a[116:119], a[36:39], v[108:111]
v_max3_f32 v21, v64, v65, v66
v_max3_f32 v22, v72, v73, v74
v_mfma_f32_16x16x32_bf16 v[92:95], a[120:123], a[8:11], v[92:95]
v_max3_f32 v23, v80, v81, v82
v_max3_f32 v21, v21, v67, v68
v_mfma_f32_16x16x32_bf16 v[100:103], a[120:123], a[24:27], v[100:103]
v_max3_f32 v22, v22, v75, v76
v_mfma_f32_16x16x32_bf16 v[108:111], a[120:123], a[40:43], v[108:111]
v_max3_f32 v23, v23, v83, v84
v_max3_f32 v21, v21, v69, v70
v_mfma_f32_16x16x32_bf16 v[92:95], a[124:127], a[12:15], v[92:95]
v_max3_f32 v22, v22, v77, v78
v_max3_f32 v23, v23, v85, v86
v_mfma_f32_16x16x32_bf16 v[100:103], a[124:127], a[28:31], v[100:103]
v_max_f32 v21, v21, v71
v_mfma_f32_16x16x32_bf16 v[108:111], a[124:127], a[44:47], v[108:111]
v_max_f32 v22, v22, v79
v_max_f32 v23, v23, v87
s_waitcnt lgkmcnt(0)
buffer_load_dwordx4 v6, s[20:23], s45 offen offset:2048 nt lds
s_waitcnt vmcnt(15)
v_mfma_f32_16x16x32_bf16 v[112:115], a[96:99], a[0:3], 0
buffer_load_dwordx4 v7, s[20:23], s45 offen offset:3072 nt lds
v_add_u32 v13, 36864, v10
v_xor_b32 v14, 64, v13
v_mfma_f32_16x16x32_bf16 v[120:123], a[96:99], a[16:19], 0
v_xor_b32 v15, 128, v13
v_xor_b32 v16, 192, v13
ds_read_b128 a[112:115], v13
v_mfma_f32_16x16x32_bf16 v[128:131], a[96:99], a[32:35], 0
ds_read_b128 a[116:119], v14
ds_read_b128 a[120:123], v15
v_mfma_f32_16x16x32_bf16 v[112:115], a[100:103], a[4:7], v[112:115]
ds_read_b128 a[124:127], v16
v_add_u32 v18, s39, v12
v_mfma_f32_16x16x32_bf16 v[120:123], a[100:103], a[20:23], v[120:123]
v_add_u32 v18, 49152, v18
ds_write_b128 v18, v[192:195] offset:0
ds_write_b128 v18, v[196:199] offset:1024
v_mfma_f32_16x16x32_bf16 v[128:131], a[100:103], a[36:39], v[128:131]
ds_write_b128 v18, v[200:203] offset:2048
ds_write_b128 v18, v[204:207] offset:3072
s_mov_b32 s45, 0
s_add_u32 m0, s39, 16384
s_nop 0
buffer_load_dwordx4 v8, s[24:27], s45 offen offset:0 nt lds
v_mfma_f32_16x16x32_bf16 v[112:115], a[104:107], a[8:11], v[112:115]
v_mfma_f32_16x16x32_bf16 v[120:123], a[104:107], a[24:27], v[120:123]
v_mfma_f32_16x16x32_bf16 v[128:131], a[104:107], a[40:43], v[128:131]
v_mfma_f32_16x16x32_bf16 v[112:115], a[108:111], a[12:15], v[112:115]
v_mfma_f32_16x16x32_bf16 v[120:123], a[108:111], a[28:31], v[120:123]
v_mfma_f32_16x16x32_bf16 v[128:131], a[108:111], a[44:47], v[128:131]
s_waitcnt lgkmcnt(0)
s_barrier
v_mfma_f32_16x16x32_bf16 v[116:119], a[112:115], a[0:3], 0
v_add_u32 v13, 49152, v10
v_xor_b32 v14, 64, v13
v_mfma_f32_16x16x32_bf16 v[124:127], a[112:115], a[16:19], 0
buffer_load_dwordx4 v9, s[24:27], s45 offen offset:1024 nt lds
v_xor_b32 v15, 128, v13
v_mfma_f32_16x16x32_bf16 v[132:135], a[112:115], a[32:35], 0
v_xor_b32 v16, 192, v13
ds_read_b128 a[96:99], v13
v_mfma_f32_16x16x32_bf16 v[116:119], a[116:119], a[4:7], v[116:119]
ds_read_b128 a[100:103], v14
ds_read_b128 a[104:107], v15
v_mfma_f32_16x16x32_bf16 v[124:127], a[116:119], a[20:23], v[124:127]
ds_read_b128 a[108:111], v16
v_mfma_f32_16x16x32_bf16 v[132:135], a[116:119], a[36:39], v[132:135]
v_max3_f32 v21, v21, v88, v89
v_max3_f32 v22, v22, v96, v97
v_mfma_f32_16x16x32_bf16 v[116:119], a[120:123], a[8:11], v[116:119]
v_max3_f32 v23, v23, v104, v105
v_max3_f32 v21, v21, v90, v91
v_mfma_f32_16x16x32_bf16 v[124:127], a[120:123], a[24:27], v[124:127]
v_max3_f32 v22, v22, v98, v99
v_mfma_f32_16x16x32_bf16 v[132:135], a[120:123], a[40:43], v[132:135]
v_max3_f32 v23, v23, v106, v107
v_max3_f32 v21, v21, v92, v93
v_mfma_f32_16x16x32_bf16 v[116:119], a[124:127], a[12:15], v[116:119]
v_max3_f32 v22, v22, v100, v101
v_max3_f32 v23, v23, v108, v109
v_mfma_f32_16x16x32_bf16 v[124:127], a[124:127], a[28:31], v[124:127]
v_max3_f32 v21, v21, v94, v95
v_mfma_f32_16x16x32_bf16 v[132:135], a[124:127], a[44:47], v[132:135]
v_max3_f32 v22, v22, v102, v103
v_max3_f32 v23, v23, v110, v111
buffer_load_dwordx4 v8, s[24:27], s45 offen offset:2048 nt lds
s_waitcnt lgkmcnt(0)
s_waitcnt vmcnt(15)
v_mfma_f32_16x16x32_bf16 v[136:139], a[96:99], a[0:3], 0
buffer_load_dwordx4 v9, s[24:27], s45 offen offset:3072 nt lds
v_add_u32 v13, 53248, v10
v_xor_b32 v14, 64, v13
v_mfma_f32_16x16x32_bf16 v[144:147], a[96:99], a[16:19], 0
v_xor_b32 v15, 128, v13
v_xor_b32 v16, 192, v13
ds_read_b128 a[112:115], v13
v_mfma_f32_16x16x32_bf16 v[152:155], a[96:99], a[32:35], 0
ds_read_b128 a[116:119], v14
ds_read_b128 a[120:123], v15
v_mfma_f32_16x16x32_bf16 v[136:139], a[100:103], a[4:7], v[136:139]
ds_read_b128 a[124:127], v16
v_add_u32 v18, s39, v12
v_mfma_f32_16x16x32_bf16 v[144:147], a[100:103], a[20:23], v[144:147]
v_add_u32 v18, 65536, v18
ds_write_b128 v18, v[208:211] offset:0
ds_write_b128 v18, v[212:215] offset:1024
v_mfma_f32_16x16x32_bf16 v[152:155], a[100:103], a[36:39], v[152:155]
ds_write_b128 v18, v[216:219] offset:2048
ds_write_b128 v18, v[220:223] offset:3072
s_mov_b32 s45, 16384
s_add_u32 m0, s39, 32768
s_nop 0
buffer_load_dwordx4 v8, s[24:27], s45 offen offset:0 nt lds
v_mfma_f32_16x16x32_bf16 v[136:139], a[104:107], a[8:11], v[136:139]
v_mfma_f32_16x16x32_bf16 v[144:147], a[104:107], a[24:27], v[144:147]
v_mfma_f32_16x16x32_bf16 v[152:155], a[104:107], a[40:43], v[152:155]
v_mfma_f32_16x16x32_bf16 v[136:139], a[108:111], a[12:15], v[136:139]
v_mfma_f32_16x16x32_bf16 v[144:147], a[108:111], a[28:31], v[144:147]
v_mfma_f32_16x16x32_bf16 v[152:155], a[108:111], a[44:47], v[152:155]
s_waitcnt lgkmcnt(0)
s_barrier
v_mfma_f32_16x16x32_bf16 v[140:143], a[112:115], a[0:3], 0
v_add_u32 v13, 65536, v10
v_xor_b32 v14, 64, v13
v_mfma_f32_16x16x32_bf16 v[148:151], a[112:115], a[16:19], 0
buffer_load_dwordx4 v9, s[24:27], s45 offen offset:1024 nt lds
v_xor_b32 v15, 128, v13
v_mfma_f32_16x16x32_bf16 v[156:159], a[112:115], a[32:35], 0
v_xor_b32 v16, 192, v13
ds_read_b128 a[96:99], v13
v_mfma_f32_16x16x32_bf16 v[140:143], a[116:119], a[4:7], v[140:143]
ds_read_b128 a[100:103], v14
ds_read_b128 a[104:107], v15
v_mfma_f32_16x16x32_bf16 v[148:151], a[116:119], a[20:23], v[148:151]
ds_read_b128 a[108:111], v16
v_mfma_f32_16x16x32_bf16 v[156:159], a[116:119], a[36:39], v[156:159]
v_max3_f32 v21, v21, v112, v113
v_max3_f32 v22, v22, v120, v121
v_mfma_f32_16x16x32_bf16 v[140:143], a[120:123], a[8:11], v[140:143]
v_max3_f32 v23, v23, v128, v129
v_max3_f32 v21, v21, v114, v115
v_mfma_f32_16x16x32_bf16 v[148:151], a[120:123], a[24:27], v[148:151]
v_max3_f32 v22, v22, v122, v123
v_mfma_f32_16x16x32_bf16 v[156:159], a[120:123], a[40:43], v[156:159]
v_max3_f32 v23, v23, v130, v131
v_max3_f32 v21, v21, v116, v117
v_mfma_f32_16x16x32_bf16 v[140:143], a[124:127], a[12:15], v[140:143]
v_max3_f32 v22, v22, v124, v125
v_max3_f32 v23, v23, v132, v133
v_mfma_f32_16x16x32_bf16 v[148:151], a[124:127], a[28:31], v[148:151]
v_max3_f32 v21, v21, v118, v119
v_mfma_f32_16x16x32_bf16 v[156:159], a[124:127], a[44:47], v[156:159]
v_max3_f32 v22, v22, v126, v127
v_max3_f32 v23, v23, v134, v135
buffer_load_dwordx4 v8, s[24:27], s45 offen offset:2048 nt lds
s_waitcnt lgkmcnt(0)
s_waitcnt vmcnt(15)
v_mfma_f32_16x16x32_bf16 v[160:163], a[96:99], a[0:3], 0
buffer_load_dwordx4 v9, s[24:27], s45 offen offset:3072 nt lds
v_add_u32 v13, 69632, v10
v_xor_b32 v14, 64, v13
v_mfma_f32_16x16x32_bf16 v[168:171], a[96:99], a[16:19], 0
v_xor_b32 v15, 128, v13
v_xor_b32 v16, 192, v13
ds_read_b128 a[112:115], v13
v_mfma_f32_16x16x32_bf16 v[176:179], a[96:99], a[32:35], 0
ds_read_b128 a[116:119], v14
ds_read_b128 a[120:123], v15
v_mfma_f32_16x16x32_bf16 v[160:163], a[100:103], a[4:7], v[160:163]
ds_read_b128 a[124:127], v16
v_add_u32 v18, s39, v12
v_mfma_f32_16x16x32_bf16 v[168:171], a[100:103], a[20:23], v[168:171]
v_add_u32 v18, 81920, v18
ds_write_b128 v18, v[224:227] offset:0
ds_write_b128 v18, v[228:231] offset:1024
v_mfma_f32_16x16x32_bf16 v[176:179], a[100:103], a[36:39], v[176:179]
ds_write_b128 v18, v[232:235] offset:2048
ds_write_b128 v18, v[236:239] offset:3072
s_mov_b32 s45, 32768
s_add_u32 m0, s39, 49152
s_nop 0
buffer_load_dwordx4 v8, s[24:27], s45 offen offset:0 nt lds
v_mfma_f32_16x16x32_bf16 v[160:163], a[104:107], a[8:11], v[160:163]
v_mfma_f32_16x16x32_bf16 v[168:171], a[104:107], a[24:27], v[168:171]
v_mfma_f32_16x16x32_bf16 v[176:179], a[104:107], a[40:43], v[176:179]
v_mfma_f32_16x16x32_bf16 v[160:163], a[108:111], a[12:15], v[160:163]
v_mfma_f32_16x16x32_bf16 v[168:171], a[108:111], a[28:31], v[168:171]
v_mfma_f32_16x16x32_bf16 v[176:179], a[108:111], a[44:47], v[176:179]
s_waitcnt lgkmcnt(0)
s_barrier
v_mfma_f32_16x16x32_bf16 v[164:167], a[112:115], a[0:3], 0
v_add_u32 v13, 81920, v10
v_xor_b32 v14, 64, v13
v_mfma_f32_16x16x32_bf16 v[172:175], a[112:115], a[16:19], 0
buffer_load_dwordx4 v9, s[24:27], s45 offen offset:1024 nt lds
v_xor_b32 v15, 128, v13
v_mfma_f32_16x16x32_bf16 v[180:183], a[112:115], a[32:35], 0
v_xor_b32 v16, 192, v13
ds_read_b128 a[96:99], v13
v_mfma_f32_16x16x32_bf16 v[164:167], a[116:119], a[4:7], v[164:167]
ds_read_b128 a[100:103], v14
ds_read_b128 a[104:107], v15
v_mfma_f32_16x16x32_bf16 v[172:175], a[116:119], a[20:23], v[172:175]
ds_read_b128 a[108:111], v16
v_mfma_f32_16x16x32_bf16 v[180:183], a[116:119], a[36:39], v[180:183]
v_max3_f32 v21, v21, v136, v137
v_max3_f32 v22, v22, v144, v145
v_mfma_f32_16x16x32_bf16 v[164:167], a[120:123], a[8:11], v[164:167]
v_max3_f32 v23, v23, v152, v153
v_max3_f32 v21, v21, v138, v139
v_mfma_f32_16x16x32_bf16 v[172:175], a[120:123], a[24:27], v[172:175]
v_max3_f32 v22, v22, v146, v147
v_mfma_f32_16x16x32_bf16 v[180:183], a[120:123], a[40:43], v[180:183]
v_max3_f32 v23, v23, v154, v155
v_max3_f32 v21, v21, v140, v141
v_mfma_f32_16x16x32_bf16 v[164:167], a[124:127], a[12:15], v[164:167]
v_max3_f32 v22, v22, v148, v149
v_max3_f32 v23, v23, v156, v157
v_mfma_f32_16x16x32_bf16 v[172:175], a[124:127], a[28:31], v[172:175]
v_max3_f32 v21, v21, v142, v143
v_mfma_f32_16x16x32_bf16 v[180:183], a[124:127], a[44:47], v[180:183]
v_max3_f32 v22, v22, v150, v151
v_max3_f32 v23, v23, v158, v159
buffer_load_dwordx4 v8, s[24:27], s45 offen offset:2048 nt lds
s_waitcnt lgkmcnt(0)
s_waitcnt vmcnt(15)
v_mfma_f32_16x16x32_bf16 v[184:187], a[96:99], a[0:3], 0
buffer_load_dwordx4 v9, s[24:27], s45 offen offset:3072 nt lds
v_add_u32 v13, 86016, v10
v_xor_b32 v14, 64, v13
v_mfma_f32_16x16x32_bf16 v[192:195], a[96:99], a[16:19], 0
v_xor_b32 v15, 128, v13
v_xor_b32 v16, 192, v13
ds_read_b128 a[112:115], v13
v_mfma_f32_16x16x32_bf16 v[200:203], a[96:99], a[32:35], 0
ds_read_b128 a[116:119], v14
ds_read_b128 a[120:123], v15
v_mfma_f32_16x16x32_bf16 v[184:187], a[100:103], a[4:7], v[184:187]
ds_read_b128 a[124:127], v16
v_add_u32 v18, s39, v12
v_mfma_f32_16x16x32_bf16 v[192:195], a[100:103], a[20:23], v[192:195]
v_add_u32 v18, 98304, v18
ds_write_b128 v18, v[240:243] offset:0
ds_write_b128 v18, v[244:247] offset:1024
v_mfma_f32_16x16x32_bf16 v[200:203], a[100:103], a[36:39], v[200:203]
ds_write_b128 v18, v[248:251] offset:2048
ds_write_b128 v18, v[252:255] offset:3072
s_mov_b32 s45, 49152
s_add_u32 m0, s39, 65536
s_nop 0
buffer_load_dwordx4 v8, s[24:27], s45 offen offset:0 nt lds
v_mfma_f32_16x16x32_bf16 v[184:187], a[104:107], a[8:11], v[184:187]
v_mfma_f32_16x16x32_bf16 v[192:195], a[104:107], a[24:27], v[192:195]
v_mfma_f32_16x16x32_bf16 v[200:203], a[104:107], a[40:43], v[200:203]
v_mfma_f32_16x16x32_bf16 v[184:187], a[108:111], a[12:15], v[184:187]
v_mfma_f32_16x16x32_bf16 v[192:195], a[108:111], a[28:31], v[192:195]
v_mfma_f32_16x16x32_bf16 v[200:203], a[108:111], a[44:47], v[200:203]
s_waitcnt lgkmcnt(0)
s_barrier
v_mfma_f32_16x16x32_bf16 v[188:191], a[112:115], a[0:3], 0
v_add_u32 v13, 98304, v10
v_xor_b32 v14, 64, v13
v_mfma_f32_16x16x32_bf16 v[196:199], a[112:115], a[16:19], 0
buffer_load_dwordx4 v9, s[24:27], s45 offen offset:1024 nt lds
v_xor_b32 v15, 128, v13
v_mfma_f32_16x16x32_bf16 v[204:207], a[112:115], a[32:35], 0
v_xor_b32 v16, 192, v13
ds_read_b128 a[96:99], v13
v_mfma_f32_16x16x32_bf16 v[188:191], a[116:119], a[4:7], v[188:191]
ds_read_b128 a[100:103], v14
ds_read_b128 a[104:107], v15
v_mfma_f32_16x16x32_bf16 v[196:199], a[116:119], a[20:23], v[196:199]
ds_read_b128 a[108:111], v16
v_mfma_f32_16x16x32_bf16 v[204:207], a[116:119], a[36:39], v[204:207]
v_max3_f32 v21, v21, v160, v161
v_max3_f32 v22, v22, v168, v169
v_mfma_f32_16x16x32_bf16 v[188:191], a[120:123], a[8:11], v[188:191]
v_max3_f32 v23, v23, v176, v177
v_max3_f32 v21, v21, v162, v163
v_mfma_f32_16x16x32_bf16 v[196:199], a[120:123], a[24:27], v[196:199]
v_max3_f32 v22, v22, v170, v171
v_mfma_f32_16x16x32_bf16 v[204:207], a[120:123], a[40:43], v[204:207]
v_max3_f32 v23, v23, v178, v179
v_max3_f32 v21, v21, v164, v165
v_mfma_f32_16x16x32_bf16 v[188:191], a[124:127], a[12:15], v[188:191]
v_max3_f32 v22, v22, v172, v173
v_max3_f32 v23, v23, v180, v181
v_mfma_f32_16x16x32_bf16 v[196:199], a[124:127], a[28:31], v[196:199]
v_max3_f32 v21, v21, v166, v167
v_mfma_f32_16x16x32_bf16 v[204:207], a[124:127], a[44:47], v[204:207]
v_max3_f32 v22, v22, v174, v175
v_max3_f32 v23, v23, v182, v183
buffer_load_dwordx4 v8, s[24:27], s45 offen offset:2048 nt lds
s_waitcnt lgkmcnt(0)
v_mfma_f32_16x16x32_bf16 v[208:211], a[96:99], a[0:3], 0
v_add_u32 v13, 102400, v10
v_mfma_f32_16x16x32_bf16 v[216:219], a[96:99], a[16:19], 0
v_xor_b32 v14, 64, v13
v_xor_b32 v15, 128, v13
v_mfma_f32_16x16x32_bf16 v[224:227], a[96:99], a[32:35], 0
v_xor_b32 v16, 192, v13
v_mfma_f32_16x16x32_bf16 v[208:211], a[100:103], a[4:7], v[208:211]
ds_read_b128 a[112:115], v13
v_mfma_f32_16x16x32_bf16 v[216:219], a[100:103], a[20:23], v[216:219]
ds_read_b128 a[116:119], v14
ds_read_b128 a[120:123], v15
v_mfma_f32_16x16x32_bf16 v[224:227], a[100:103], a[36:39], v[224:227]
ds_read_b128 a[124:127], v16
v_mfma_f32_16x16x32_bf16 v[208:211], a[104:107], a[8:11], v[208:211]
v_mfma_f32_16x16x32_bf16 v[216:219], a[104:107], a[24:27], v[216:219]
v_mfma_f32_16x16x32_bf16 v[224:227], a[104:107], a[40:43], v[224:227]
v_mfma_f32_16x16x32_bf16 v[208:211], a[108:111], a[12:15], v[208:211]
buffer_load_dwordx4 v9, s[24:27], s45 offen offset:3072 nt lds
v_mfma_f32_16x16x32_bf16 v[216:219], a[108:111], a[28:31], v[216:219]
v_mfma_f32_16x16x32_bf16 v[224:227], a[108:111], a[44:47], v[224:227]
s_waitcnt lgkmcnt(0)
s_waitcnt vmcnt(16)
s_barrier
v_mfma_f32_16x16x32_bf16 v[212:215], a[112:115], a[0:3], 0
v_add_u32 v13, 0, v10
v_xor_b32 v14, 64, v13
v_mfma_f32_16x16x32_bf16 v[220:223], a[112:115], a[16:19], 0
v_xor_b32 v15, 128, v13
v_mfma_f32_16x16x32_bf16 v[228:231], a[112:115], a[32:35], 0
v_xor_b32 v16, 192, v13
ds_read_b128 a[96:99], v13
v_mfma_f32_16x16x32_bf16 v[212:215], a[116:119], a[4:7], v[212:215]
ds_read_b128 a[100:103], v14
ds_read_b128 a[104:107], v15
v_mfma_f32_16x16x32_bf16 v[220:223], a[116:119], a[20:23], v[220:223]
ds_read_b128 a[108:111], v16
s_mov_b32 s45, 65536
s_add_u32 m0, s39, 81920
s_nop 0
buffer_load_dwordx4 v8, s[24:27], s45 offen offset:0 nt lds
v_mfma_f32_16x16x32_bf16 v[228:231], a[116:119], a[36:39], v[228:231]
v_max3_f32 v21, v21, v184, v185
v_max3_f32 v22, v22, v192, v193
v_mfma_f32_16x16x32_bf16 v[212:215], a[120:123], a[8:11], v[212:215]
v_max3_f32 v23, v23, v200, v201
v_max3_f32 v21, v21, v186, v187
v_mfma_f32_16x16x32_bf16 v[220:223], a[120:123], a[24:27], v[220:223]
v_max3_f32 v22, v22, v194, v195
v_mfma_f32_16x16x32_bf16 v[228:231], a[120:123], a[40:43], v[228:231]
v_max3_f32 v23, v23, v202, v203
v_max3_f32 v21, v21, v188, v189
v_mfma_f32_16x16x32_bf16 v[212:215], a[124:127], a[12:15], v[212:215]
v_max3_f32 v22, v22, v196, v197
v_max3_f32 v23, v23, v204, v205
v_mfma_f32_16x16x32_bf16 v[220:223], a[124:127], a[28:31], v[220:223]
v_max3_f32 v21, v21, v190, v191
v_mfma_f32_16x16x32_bf16 v[228:231], a[124:127], a[44:47], v[228:231]
v_max3_f32 v22, v22, v198, v199
v_max3_f32 v23, v23, v206, v207
s_waitcnt lgkmcnt(0)
v_mfma_f32_16x16x32_bf16 v[232:235], a[96:99], a[0:3], 0
v_add_u32 v13, 4096, v10
buffer_load_dwordx4 v9, s[24:27], s45 offen offset:1024 nt lds
v_mfma_f32_16x16x32_bf16 v[240:243], a[96:99], a[16:19], 0
v_xor_b32 v14, 64, v13
v_xor_b32 v15, 128, v13
v_mfma_f32_16x16x32_bf16 v[248:251], a[96:99], a[32:35], 0
v_xor_b32 v16, 192, v13
v_mfma_f32_16x16x32_bf16 v[232:235], a[100:103], a[4:7], v[232:235]
ds_read_b128 a[112:115], v13
v_mfma_f32_16x16x32_bf16 v[240:243], a[100:103], a[20:23], v[240:243]
ds_read_b128 a[116:119], v14
ds_read_b128 a[120:123], v15
v_mfma_f32_16x16x32_bf16 v[248:251], a[100:103], a[36:39], v[248:251]
ds_read_b128 a[124:127], v16
v_mfma_f32_16x16x32_bf16 v[232:235], a[104:107], a[8:11], v[232:235]
v_mfma_f32_16x16x32_bf16 v[240:243], a[104:107], a[24:27], v[240:243]
v_mfma_f32_16x16x32_bf16 v[248:251], a[104:107], a[40:43], v[248:251]
v_mfma_f32_16x16x32_bf16 v[232:235], a[108:111], a[12:15], v[232:235]
v_mfma_f32_16x16x32_bf16 v[240:243], a[108:111], a[28:31], v[240:243]
v_mfma_f32_16x16x32_bf16 v[248:251], a[108:111], a[44:47], v[248:251]
s_waitcnt lgkmcnt(0)
buffer_load_dwordx4 v8, s[24:27], s45 offen offset:2048 nt lds
s_barrier
v_mfma_f32_16x16x32_bf16 v[236:239], a[112:115], a[0:3], 0
v_max3_f32 v21, v21, v208, v209
v_mfma_f32_16x16x32_bf16 v[244:247], a[112:115], a[16:19], 0
v_max3_f32 v22, v22, v216, v217
v_mfma_f32_16x16x32_bf16 v[252:255], a[112:115], a[32:35], 0
v_max3_f32 v23, v23, v224, v225
v_mfma_f32_16x16x32_bf16 v[236:239], a[116:119], a[4:7], v[236:239]
v_max3_f32 v21, v21, v210, v211
v_mfma_f32_16x16x32_bf16 v[244:247], a[116:119], a[20:23], v[244:247]
v_max3_f32 v22, v22, v218, v219
v_mfma_f32_16x16x32_bf16 v[252:255], a[116:119], a[36:39], v[252:255]
v_max3_f32 v23, v23, v226, v227
v_mfma_f32_16x16x32_bf16 v[236:239], a[120:123], a[8:11], v[236:239]
v_max3_f32 v21, v21, v212, v213
v_mfma_f32_16x16x32_bf16 v[244:247], a[120:123], a[24:27], v[244:247]
v_max3_f32 v22, v22, v220, v221
v_mfma_f32_16x16x32_bf16 v[252:255], a[120:123], a[40:43], v[252:255]
v_max3_f32 v23, v23, v228, v229
buffer_load_dwordx4 v9, s[24:27], s45 offen offset:3072 nt lds
v_mfma_f32_16x16x32_bf16 v[236:239], a[124:127], a[12:15], v[236:239]
v_max3_f32 v21, v21, v214, v215
v_mfma_f32_16x16x32_bf16 v[244:247], a[124:127], a[28:31], v[244:247]
v_max3_f32 v22, v22, v222, v223
v_mfma_f32_16x16x32_bf16 v[252:255], a[124:127], a[44:47], v[252:255]
v_max3_f32 v23, v23, v230, v231
s_nop 7
s_nop 1
v_max3_f32 v21, v21, v232, v233
v_max3_f32 v22, v22, v240, v241
v_max3_f32 v23, v23, v248, v249
v_max3_f32 v21, v21, v234, v235
v_max3_f32 v22, v22, v242, v243
v_max3_f32 v23, v23, v250, v251
v_max3_f32 v21, v21, v236, v237
v_max3_f32 v22, v22, v244, v245
v_max3_f32 v23, v23, v252, v253
v_max3_f32 v21, v21, v238, v239
v_max3_f32 v22, v22, v246, v247
v_max3_f32 v23, v23, v254, v255
v_mov_b32 v40, v21
v_mov_b32 v41, v22
v_mov_b32 v42, v23
s_nop 1
v_permlane32_swap_b32 v21, v40
v_permlane32_swap_b32 v22, v41
v_permlane32_swap_b32 v23, v42
s_nop 1
v_max_f32 v21, v21, v40
v_max_f32 v22, v22, v41
v_max_f32 v23, v23, v42
v_mov_b32 v40, v21
v_mov_b32 v41, v22
v_mov_b32 v42, v23
s_nop 1
v_permlane16_swap_b32 v21, v40
v_permlane16_swap_b32 v22, v41
v_permlane16_swap_b32 v23, v42
s_nop 1
v_max_f32 v21, v21, v40
s_mov_b32 s45, 81920
s_add_u32 m0, s39, 98304
s_nop 0
buffer_load_dwordx4 v8, s[24:27], s45 offen offset:0 nt lds
v_max_f32 v22, v22, v41
v_max_f32 v23, v23, v42
s_mul_i32 s43, s36, 768
v_lshlrev_b32 v43, 2, v1
v_add_u32 v43, 114688, v43
v_add_u32 v44, s43, v43
ds_write_b32 v44, v21 offset:0
ds_write_b32 v44, v22 offset:256
ds_write_b32 v44, v23 offset:512
s_xor_b32 s43, s36, 2
s_mul_i32 s43, s43, 768
v_add_u32 v45, s43, v43
s_waitcnt lgkmcnt(0)
s_barrier
ds_read_b32 v40, v45 offset:0
ds_read_b32 v41, v45 offset:256
ds_read_b32 v42, v45 offset:512
s_waitcnt lgkmcnt(0)
v_max_f32 v21, v21, v40
v_max_f32 v22, v22, v41
v_max_f32 v23, v23, v42
v_mul_f32 v46, s40, v21
v_mul_f32 v48, s40, v22
v_mul_f32 v50, s40, v23
v_pk_fma_f32 v[64:65], v[64:65], s[40:41], v[46:47] op_sel_hi:[1,0,0] neg_lo:[0,0,1] neg_hi:[0,0,1]
buffer_load_dwordx4 v9, s[24:27], s45 offen offset:1024 nt lds
v_pk_fma_f32 v[66:67], v[66:67], s[40:41], v[46:47] op_sel_hi:[1,0,0] neg_lo:[0,0,1] neg_hi:[0,0,1]
v_pk_fma_f32 v[68:69], v[68:69], s[40:41], v[46:47] op_sel_hi:[1,0,0] neg_lo:[0,0,1] neg_hi:[0,0,1]
v_pk_fma_f32 v[70:71], v[70:71], s[40:41], v[46:47] op_sel_hi:[1,0,0] neg_lo:[0,0,1] neg_hi:[0,0,1]
v_exp_f32 v64, v64
v_exp_f32 v65, v65
v_exp_f32 v66, v66
v_exp_f32 v67, v67
v_exp_f32 v68, v68
v_exp_f32 v69, v69
v_exp_f32 v70, v70
v_exp_f32 v71, v71
v_cvt_pk_bf16_f32 v64, v64, v65
v_cvt_pk_bf16_f32 v65, v66, v67
v_cvt_pk_bf16_f32 v66, v68, v69
v_cvt_pk_bf16_f32 v67, v70, v71
v_pk_fma_f32 v[72:73], v[72:73], s[40:41], v[48:49] op_sel_hi:[1,0,0] neg_lo:[0,0,1] neg_hi:[0,0,1]
v_pk_fma_f32 v[74:75], v[74:75], s[40:41], v[48:49] op_sel_hi:[1,0,0] neg_lo:[0,0,1] neg_hi:[0,0,1]
v_pk_fma_f32 v[76:77], v[76:77], s[40:41], v[48:49] op_sel_hi:[1,0,0] neg_lo:[0,0,1] neg_hi:[0,0,1]
v_pk_fma_f32 v[78:79], v[78:79], s[40:41], v[48:49] op_sel_hi:[1,0,0] neg_lo:[0,0,1] neg_hi:[0,0,1]
v_mfma_f32_16x16x32_bf16 v[28:31], a[176:179], v[64:67], 0
v_exp_f32 v72, v72
v_exp_f32 v73, v73
v_exp_f32 v74, v74
v_exp_f32 v75, v75
v_exp_f32 v76, v76
v_exp_f32 v77, v77
v_exp_f32 v78, v78
v_exp_f32 v79, v79
v_cvt_pk_bf16_f32 v72, v72, v73
v_cvt_pk_bf16_f32 v73, v74, v75
v_cvt_pk_bf16_f32 v74, v76, v77
v_cvt_pk_bf16_f32 v75, v78, v79
v_pk_fma_f32 v[80:81], v[80:81], s[40:41], v[50:51] op_sel_hi:[1,0,0] neg_lo:[0,0,1] neg_hi:[0,0,1]
v_pk_fma_f32 v[82:83], v[82:83], s[40:41], v[50:51] op_sel_hi:[1,0,0] neg_lo:[0,0,1] neg_hi:[0,0,1]
v_pk_fma_f32 v[84:85], v[84:85], s[40:41], v[50:51] op_sel_hi:[1,0,0] neg_lo:[0,0,1] neg_hi:[0,0,1]
v_pk_fma_f32 v[86:87], v[86:87], s[40:41], v[50:51] op_sel_hi:[1,0,0] neg_lo:[0,0,1] neg_hi:[0,0,1]
v_mfma_f32_16x16x32_bf16 v[32:35], a[176:179], v[72:75], 0
buffer_load_dwordx4 v8, s[24:27], s45 offen offset:2048 nt lds
v_exp_f32 v80, v80
v_exp_f32 v81, v81
v_exp_f32 v82, v82
v_exp_f32 v83, v83
v_exp_f32 v84, v84
v_exp_f32 v85, v85
v_exp_f32 v86, v86
v_exp_f32 v87, v87
v_cvt_pk_bf16_f32 v80, v80, v81
v_cvt_pk_bf16_f32 v81, v82, v83
v_cvt_pk_bf16_f32 v82, v84, v85
v_cvt_pk_bf16_f32 v83, v86, v87
v_pk_fma_f32 v[88:89], v[88:89], s[40:41], v[46:47] op_sel_hi:[1,0,0] neg_lo:[0,0,1] neg_hi:[0,0,1]
v_pk_fma_f32 v[90:91], v[90:91], s[40:41], v[46:47] op_sel_hi:[1,0,0] neg_lo:[0,0,1] neg_hi:[0,0,1]
v_pk_fma_f32 v[92:93], v[92:93], s[40:41], v[46:47] op_sel_hi:[1,0,0] neg_lo:[0,0,1] neg_hi:[0,0,1]
v_pk_fma_f32 v[94:95], v[94:95], s[40:41], v[46:47] op_sel_hi:[1,0,0] neg_lo:[0,0,1] neg_hi:[0,0,1]
v_mfma_f32_16x16x32_bf16 v[36:39], a[176:179], v[80:83], 0
v_exp_f32 v88, v88
v_exp_f32 v89, v89
v_exp_f32 v90, v90
v_exp_f32 v91, v91
v_exp_f32 v92, v92
v_exp_f32 v93, v93
v_exp_f32 v94, v94
v_exp_f32 v95, v95
v_cvt_pk_bf16_f32 v88, v88, v89
v_cvt_pk_bf16_f32 v89, v90, v91
v_cvt_pk_bf16_f32 v90, v92, v93
v_cvt_pk_bf16_f32 v91, v94, v95
v_pk_fma_f32 v[96:97], v[96:97], s[40:41], v[48:49] op_sel_hi:[1,0,0] neg_lo:[0,0,1] neg_hi:[0,0,1]
v_pk_fma_f32 v[98:99], v[98:99], s[40:41], v[48:49] op_sel_hi:[1,0,0] neg_lo:[0,0,1] neg_hi:[0,0,1]
v_pk_fma_f32 v[100:101], v[100:101], s[40:41], v[48:49] op_sel_hi:[1,0,0] neg_lo:[0,0,1] neg_hi:[0,0,1]
v_pk_fma_f32 v[102:103], v[102:103], s[40:41], v[48:49] op_sel_hi:[1,0,0] neg_lo:[0,0,1] neg_hi:[0,0,1]
v_mfma_f32_16x16x32_bf16 v[28:31], a[176:179], v[88:91], v[28:31]
v_exp_f32 v96, v96
buffer_load_dwordx4 v9, s[24:27], s45 offen offset:3072 nt lds
v_exp_f32 v97, v97
v_exp_f32 v98, v98
v_exp_f32 v99, v99
v_exp_f32 v100, v100
v_exp_f32 v101, v101
v_exp_f32 v102, v102
v_exp_f32 v103, v103
v_cvt_pk_bf16_f32 v96, v96, v97
v_cvt_pk_bf16_f32 v97, v98, v99
v_cvt_pk_bf16_f32 v98, v100, v101
v_cvt_pk_bf16_f32 v99, v102, v103
v_pk_fma_f32 v[104:105], v[104:105], s[40:41], v[50:51] op_sel_hi:[1,0,0] neg_lo:[0,0,1] neg_hi:[0,0,1]
v_pk_fma_f32 v[106:107], v[106:107], s[40:41], v[50:51] op_sel_hi:[1,0,0] neg_lo:[0,0,1] neg_hi:[0,0,1]
v_pk_fma_f32 v[108:109], v[108:109], s[40:41], v[50:51] op_sel_hi:[1,0,0] neg_lo:[0,0,1] neg_hi:[0,0,1]
v_pk_fma_f32 v[110:111], v[110:111], s[40:41], v[50:51] op_sel_hi:[1,0,0] neg_lo:[0,0,1] neg_hi:[0,0,1]
v_mfma_f32_16x16x32_bf16 v[32:35], a[176:179], v[96:99], v[32:35]
v_exp_f32 v104, v104
v_exp_f32 v105, v105
v_exp_f32 v106, v106
v_exp_f32 v107, v107
v_exp_f32 v108, v108
v_exp_f32 v109, v109
v_exp_f32 v110, v110
v_exp_f32 v111, v111
v_cvt_pk_bf16_f32 v104, v104, v105
v_cvt_pk_bf16_f32 v105, v106, v107
v_cvt_pk_bf16_f32 v106, v108, v109
v_cvt_pk_bf16_f32 v107, v110, v111
v_pk_fma_f32 v[112:113], v[112:113], s[40:41], v[46:47] op_sel_hi:[1,0,0] neg_lo:[0,0,1] neg_hi:[0,0,1]
v_pk_fma_f32 v[114:115], v[114:115], s[40:41], v[46:47] op_sel_hi:[1,0,0] neg_lo:[0,0,1] neg_hi:[0,0,1]
v_pk_fma_f32 v[116:117], v[116:117], s[40:41], v[46:47] op_sel_hi:[1,0,0] neg_lo:[0,0,1] neg_hi:[0,0,1]
v_pk_fma_f32 v[118:119], v[118:119], s[40:41], v[46:47] op_sel_hi:[1,0,0] neg_lo:[0,0,1] neg_hi:[0,0,1]
v_mfma_f32_16x16x32_bf16 v[36:39], a[176:179], v[104:107], v[36:39]
v_exp_f32 v112, v112
v_exp_f32 v113, v113
s_mov_b32 s45, 98304
s_add_u32 m0, s39, 0
s_nop 0
buffer_load_dwordx4 v8, s[24:27], s45 offen offset:0 nt lds
v_exp_f32 v114, v114
v_exp_f32 v115, v115
v_exp_f32 v116, v116
v_exp_f32 v117, v117
v_exp_f32 v118, v118
v_exp_f32 v119, v119
v_cvt_pk_bf16_f32 v112, v112, v113
v_cvt_pk_bf16_f32 v113, v114, v115
v_cvt_pk_bf16_f32 v114, v116, v117
v_cvt_pk_bf16_f32 v115, v118, v119
v_pk_fma_f32 v[120:121], v[120:121], s[40:41], v[48:49] op_sel_hi:[1,0,0] neg_lo:[0,0,1] neg_hi:[0,0,1]
v_pk_fma_f32 v[122:123], v[122:123], s[40:41], v[48:49] op_sel_hi:[1,0,0] neg_lo:[0,0,1] neg_hi:[0,0,1]
v_pk_fma_f32 v[124:125], v[124:125], s[40:41], v[48:49] op_sel_hi:[1,0,0] neg_lo:[0,0,1] neg_hi:[0,0,1]
v_pk_fma_f32 v[126:127], v[126:127], s[40:41], v[48:49] op_sel_hi:[1,0,0] neg_lo:[0,0,1] neg_hi:[0,0,1]
v_mfma_f32_16x16x32_bf16 v[28:31], a[176:179], v[112:115], v[28:31]
v_exp_f32 v120, v120
v_exp_f32 v121, v121
v_exp_f32 v122, v122
v_exp_f32 v123, v123
v_exp_f32 v124, v124
v_exp_f32 v125, v125
v_exp_f32 v126, v126
v_exp_f32 v127, v127
v_cvt_pk_bf16_f32 v120, v120, v121
v_cvt_pk_bf16_f32 v121, v122, v123
v_cvt_pk_bf16_f32 v122, v124, v125
v_cvt_pk_bf16_f32 v123, v126, v127
v_pk_fma_f32 v[128:129], v[128:129], s[40:41], v[50:51] op_sel_hi:[1,0,0] neg_lo:[0,0,1] neg_hi:[0,0,1]
v_pk_fma_f32 v[130:131], v[130:131], s[40:41], v[50:51] op_sel_hi:[1,0,0] neg_lo:[0,0,1] neg_hi:[0,0,1]
v_pk_fma_f32 v[132:133], v[132:133], s[40:41], v[50:51] op_sel_hi:[1,0,0] neg_lo:[0,0,1] neg_hi:[0,0,1]
v_pk_fma_f32 v[134:135], v[134:135], s[40:41], v[50:51] op_sel_hi:[1,0,0] neg_lo:[0,0,1] neg_hi:[0,0,1]
v_mfma_f32_16x16x32_bf16 v[32:35], a[176:179], v[120:123], v[32:35]
v_exp_f32 v128, v128
v_exp_f32 v129, v129
buffer_load_dwordx4 v9, s[24:27], s45 offen offset:1024 nt lds
v_exp_f32 v130, v130
v_exp_f32 v131, v131
v_exp_f32 v132, v132
v_exp_f32 v133, v133
v_exp_f32 v134, v134
v_exp_f32 v135, v135
v_cvt_pk_bf16_f32 v128, v128, v129
v_cvt_pk_bf16_f32 v129, v130, v131
v_cvt_pk_bf16_f32 v130, v132, v133
v_cvt_pk_bf16_f32 v131, v134, v135
v_pk_fma_f32 v[136:137], v[136:137], s[40:41], v[46:47] op_sel_hi:[1,0,0] neg_lo:[0,0,1] neg_hi:[0,0,1]
v_pk_fma_f32 v[138:139], v[138:139], s[40:41], v[46:47] op_sel_hi:[1,0,0] neg_lo:[0,0,1] neg_hi:[0,0,1]
v_pk_fma_f32 v[140:141], v[140:141], s[40:41], v[46:47] op_sel_hi:[1,0,0] neg_lo:[0,0,1] neg_hi:[0,0,1]
v_pk_fma_f32 v[142:143], v[142:143], s[40:41], v[46:47] op_sel_hi:[1,0,0] neg_lo:[0,0,1] neg_hi:[0,0,1]
v_mfma_f32_16x16x32_bf16 v[36:39], a[176:179], v[128:131], v[36:39]
v_exp_f32 v136, v136
v_exp_f32 v137, v137
v_exp_f32 v138, v138
v_exp_f32 v139, v139
v_exp_f32 v140, v140
v_exp_f32 v141, v141
v_exp_f32 v142, v142
v_exp_f32 v143, v143
v_cvt_pk_bf16_f32 v136, v136, v137
v_cvt_pk_bf16_f32 v137, v138, v139
v_cvt_pk_bf16_f32 v138, v140, v141
v_cvt_pk_bf16_f32 v139, v142, v143
v_pk_fma_f32 v[144:145], v[144:145], s[40:41], v[48:49] op_sel_hi:[1,0,0] neg_lo:[0,0,1] neg_hi:[0,0,1]
v_pk_fma_f32 v[146:147], v[146:147], s[40:41], v[48:49] op_sel_hi:[1,0,0] neg_lo:[0,0,1] neg_hi:[0,0,1]
v_pk_fma_f32 v[148:149], v[148:149], s[40:41], v[48:49] op_sel_hi:[1,0,0] neg_lo:[0,0,1] neg_hi:[0,0,1]
v_pk_fma_f32 v[150:151], v[150:151], s[40:41], v[48:49] op_sel_hi:[1,0,0] neg_lo:[0,0,1] neg_hi:[0,0,1]
v_mfma_f32_16x16x32_bf16 v[28:31], a[176:179], v[136:139], v[28:31]
v_exp_f32 v144, v144
v_exp_f32 v145, v145
v_exp_f32 v146, v146
buffer_load_dwordx4 v8, s[24:27], s45 offen offset:2048 nt lds
v_exp_f32 v147, v147
v_exp_f32 v148, v148
v_exp_f32 v149, v149
v_exp_f32 v150, v150
v_exp_f32 v151, v151
v_cvt_pk_bf16_f32 v144, v144, v145
v_cvt_pk_bf16_f32 v145, v146, v147
v_cvt_pk_bf16_f32 v146, v148, v149
v_cvt_pk_bf16_f32 v147, v150, v151
v_pk_fma_f32 v[152:153], v[152:153], s[40:41], v[50:51] op_sel_hi:[1,0,0] neg_lo:[0,0,1] neg_hi:[0,0,1]
v_pk_fma_f32 v[154:155], v[154:155], s[40:41], v[50:51] op_sel_hi:[1,0,0] neg_lo:[0,0,1] neg_hi:[0,0,1]
v_pk_fma_f32 v[156:157], v[156:157], s[40:41], v[50:51] op_sel_hi:[1,0,0] neg_lo:[0,0,1] neg_hi:[0,0,1]
v_pk_fma_f32 v[158:159], v[158:159], s[40:41], v[50:51] op_sel_hi:[1,0,0] neg_lo:[0,0,1] neg_hi:[0,0,1]
v_mfma_f32_16x16x32_bf16 v[32:35], a[176:179], v[144:147], v[32:35]
v_exp_f32 v152, v152
v_exp_f32 v153, v153
v_exp_f32 v154, v154
v_exp_f32 v155, v155
v_exp_f32 v156, v156
v_exp_f32 v157, v157
v_exp_f32 v158, v158
v_exp_f32 v159, v159
v_cvt_pk_bf16_f32 v152, v152, v153
v_cvt_pk_bf16_f32 v153, v154, v155
v_cvt_pk_bf16_f32 v154, v156, v157
v_cvt_pk_bf16_f32 v155, v158, v159
v_pk_fma_f32 v[160:161], v[160:161], s[40:41], v[46:47] op_sel_hi:[1,0,0] neg_lo:[0,0,1] neg_hi:[0,0,1]
v_pk_fma_f32 v[162:163], v[162:163], s[40:41], v[46:47] op_sel_hi:[1,0,0] neg_lo:[0,0,1] neg_hi:[0,0,1]
v_pk_fma_f32 v[164:165], v[164:165], s[40:41], v[46:47] op_sel_hi:[1,0,0] neg_lo:[0,0,1] neg_hi:[0,0,1]
v_pk_fma_f32 v[166:167], v[166:167], s[40:41], v[46:47] op_sel_hi:[1,0,0] neg_lo:[0,0,1] neg_hi:[0,0,1]
v_mfma_f32_16x16x32_bf16 v[36:39], a[176:179], v[152:155], v[36:39]
v_exp_f32 v160, v160
v_exp_f32 v161, v161
v_exp_f32 v162, v162
v_exp_f32 v163, v163
v_exp_f32 v164, v164
buffer_load_dwordx4 v9, s[24:27], s45 offen offset:3072 nt lds
v_exp_f32 v165, v165
v_exp_f32 v166, v166
v_exp_f32 v167, v167
v_cvt_pk_bf16_f32 v160, v160, v161
v_cvt_pk_bf16_f32 v161, v162, v163
v_cvt_pk_bf16_f32 v162, v164, v165
v_cvt_pk_bf16_f32 v163, v166, v167
v_pk_fma_f32 v[168:169], v[168:169], s[40:41], v[48:49] op_sel_hi:[1,0,0] neg_lo:[0,0,1] neg_hi:[0,0,1]
v_pk_fma_f32 v[170:171], v[170:171], s[40:41], v[48:49] op_sel_hi:[1,0,0] neg_lo:[0,0,1] neg_hi:[0,0,1]
v_pk_fma_f32 v[172:173], v[172:173], s[40:41], v[48:49] op_sel_hi:[1,0,0] neg_lo:[0,0,1] neg_hi:[0,0,1]
v_pk_fma_f32 v[174:175], v[174:175], s[40:41], v[48:49] op_sel_hi:[1,0,0] neg_lo:[0,0,1] neg_hi:[0,0,1]
v_mfma_f32_16x16x32_bf16 v[28:31], a[176:179], v[160:163], v[28:31]
v_exp_f32 v168, v168
v_exp_f32 v169, v169
v_exp_f32 v170, v170
v_exp_f32 v171, v171
v_exp_f32 v172, v172
v_exp_f32 v173, v173
v_exp_f32 v174, v174
v_exp_f32 v175, v175
v_cvt_pk_bf16_f32 v168, v168, v169
v_cvt_pk_bf16_f32 v169, v170, v171
v_cvt_pk_bf16_f32 v170, v172, v173
v_cvt_pk_bf16_f32 v171, v174, v175
v_pk_fma_f32 v[176:177], v[176:177], s[40:41], v[50:51] op_sel_hi:[1,0,0] neg_lo:[0,0,1] neg_hi:[0,0,1]
v_pk_fma_f32 v[178:179], v[178:179], s[40:41], v[50:51] op_sel_hi:[1,0,0] neg_lo:[0,0,1] neg_hi:[0,0,1]
v_pk_fma_f32 v[180:181], v[180:181], s[40:41], v[50:51] op_sel_hi:[1,0,0] neg_lo:[0,0,1] neg_hi:[0,0,1]
v_pk_fma_f32 v[182:183], v[182:183], s[40:41], v[50:51] op_sel_hi:[1,0,0] neg_lo:[0,0,1] neg_hi:[0,0,1]
v_mfma_f32_16x16x32_bf16 v[32:35], a[176:179], v[168:171], v[32:35]
v_exp_f32 v176, v176
v_exp_f32 v177, v177
v_exp_f32 v178, v178
v_exp_f32 v179, v179
v_exp_f32 v180, v180
v_exp_f32 v181, v181
v_exp_f32 v182, v182
v_exp_f32 v183, v183
v_cvt_pk_bf16_f32 v176, v176, v177
v_cvt_pk_bf16_f32 v177, v178, v179
v_cvt_pk_bf16_f32 v178, v180, v181
v_cvt_pk_bf16_f32 v179, v182, v183
v_pk_fma_f32 v[184:185], v[184:185], s[40:41], v[46:47] op_sel_hi:[1,0,0] neg_lo:[0,0,1] neg_hi:[0,0,1]
v_pk_fma_f32 v[186:187], v[186:187], s[40:41], v[46:47] op_sel_hi:[1,0,0] neg_lo:[0,0,1] neg_hi:[0,0,1]
v_pk_fma_f32 v[188:189], v[188:189], s[40:41], v[46:47] op_sel_hi:[1,0,0] neg_lo:[0,0,1] neg_hi:[0,0,1]
v_pk_fma_f32 v[190:191], v[190:191], s[40:41], v[46:47] op_sel_hi:[1,0,0] neg_lo:[0,0,1] neg_hi:[0,0,1]
v_mfma_f32_16x16x32_bf16 v[36:39], a[176:179], v[176:179], v[36:39]
v_exp_f32 v184, v184
v_exp_f32 v185, v185
v_exp_f32 v186, v186
v_exp_f32 v187, v187
v_exp_f32 v188, v188
v_exp_f32 v189, v189
v_exp_f32 v190, v190
v_exp_f32 v191, v191
v_cvt_pk_bf16_f32 v184, v184, v185
v_cvt_pk_bf16_f32 v185, v186, v187
v_cvt_pk_bf16_f32 v186, v188, v189
v_cvt_pk_bf16_f32 v187, v190, v191
v_pk_fma_f32 v[192:193], v[192:193], s[40:41], v[48:49] op_sel_hi:[1,0,0] neg_lo:[0,0,1] neg_hi:[0,0,1]
v_pk_fma_f32 v[194:195], v[194:195], s[40:41], v[48:49] op_sel_hi:[1,0,0] neg_lo:[0,0,1] neg_hi:[0,0,1]
v_pk_fma_f32 v[196:197], v[196:197], s[40:41], v[48:49] op_sel_hi:[1,0,0] neg_lo:[0,0,1] neg_hi:[0,0,1]
v_pk_fma_f32 v[198:199], v[198:199], s[40:41], v[48:49] op_sel_hi:[1,0,0] neg_lo:[0,0,1] neg_hi:[0,0,1]
v_mfma_f32_16x16x32_bf16 v[28:31], a[176:179], v[184:187], v[28:31]
v_exp_f32 v192, v192
v_exp_f32 v193, v193
v_exp_f32 v194, v194
v_exp_f32 v195, v195
v_exp_f32 v196, v196
v_exp_f32 v197, v197
v_exp_f32 v198, v198
v_exp_f32 v199, v199
v_cvt_pk_bf16_f32 v192, v192, v193
v_cvt_pk_bf16_f32 v193, v194, v195
v_cvt_pk_bf16_f32 v194, v196, v197
v_cvt_pk_bf16_f32 v195, v198, v199
v_pk_fma_f32 v[200:201], v[200:201], s[40:41], v[50:51] op_sel_hi:[1,0,0] neg_lo:[0,0,1] neg_hi:[0,0,1]
v_pk_fma_f32 v[202:203], v[202:203], s[40:41], v[50:51] op_sel_hi:[1,0,0] neg_lo:[0,0,1] neg_hi:[0,0,1]
v_pk_fma_f32 v[204:205], v[204:205], s[40:41], v[50:51] op_sel_hi:[1,0,0] neg_lo:[0,0,1] neg_hi:[0,0,1]
v_pk_fma_f32 v[206:207], v[206:207], s[40:41], v[50:51] op_sel_hi:[1,0,0] neg_lo:[0,0,1] neg_hi:[0,0,1]
v_mfma_f32_16x16x32_bf16 v[32:35], a[176:179], v[192:195], v[32:35]
v_exp_f32 v200, v200
v_exp_f32 v201, v201
v_exp_f32 v202, v202
v_exp_f32 v203, v203
v_exp_f32 v204, v204
v_exp_f32 v205, v205
v_exp_f32 v206, v206
v_exp_f32 v207, v207
v_cvt_pk_bf16_f32 v200, v200, v201
v_cvt_pk_bf16_f32 v201, v202, v203
v_cvt_pk_bf16_f32 v202, v204, v205
v_cvt_pk_bf16_f32 v203, v206, v207
v_pk_fma_f32 v[208:209], v[208:209], s[40:41], v[46:47] op_sel_hi:[1,0,0] neg_lo:[0,0,1] neg_hi:[0,0,1]
v_pk_fma_f32 v[210:211], v[210:211], s[40:41], v[46:47] op_sel_hi:[1,0,0] neg_lo:[0,0,1] neg_hi:[0,0,1]
v_pk_fma_f32 v[212:213], v[212:213], s[40:41], v[46:47] op_sel_hi:[1,0,0] neg_lo:[0,0,1] neg_hi:[0,0,1]
v_pk_fma_f32 v[214:215], v[214:215], s[40:41], v[46:47] op_sel_hi:[1,0,0] neg_lo:[0,0,1] neg_hi:[0,0,1]
v_mfma_f32_16x16x32_bf16 v[36:39], a[176:179], v[200:203], v[36:39]
v_exp_f32 v208, v208
v_exp_f32 v209, v209
v_exp_f32 v210, v210
v_exp_f32 v211, v211
v_exp_f32 v212, v212
v_exp_f32 v213, v213
v_exp_f32 v214, v214
v_exp_f32 v215, v215
v_cvt_pk_bf16_f32 v208, v208, v209
v_cvt_pk_bf16_f32 v209, v210, v211
v_cvt_pk_bf16_f32 v210, v212, v213
v_cvt_pk_bf16_f32 v211, v214, v215
v_pk_fma_f32 v[216:217], v[216:217], s[40:41], v[48:49] op_sel_hi:[1,0,0] neg_lo:[0,0,1] neg_hi:[0,0,1]
v_pk_fma_f32 v[218:219], v[218:219], s[40:41], v[48:49] op_sel_hi:[1,0,0] neg_lo:[0,0,1] neg_hi:[0,0,1]
v_pk_fma_f32 v[220:221], v[220:221], s[40:41], v[48:49] op_sel_hi:[1,0,0] neg_lo:[0,0,1] neg_hi:[0,0,1]
v_pk_fma_f32 v[222:223], v[222:223], s[40:41], v[48:49] op_sel_hi:[1,0,0] neg_lo:[0,0,1] neg_hi:[0,0,1]
v_mfma_f32_16x16x32_bf16 v[28:31], a[176:179], v[208:211], v[28:31]
v_exp_f32 v216, v216
v_exp_f32 v217, v217
v_exp_f32 v218, v218
v_exp_f32 v219, v219
v_exp_f32 v220, v220
v_exp_f32 v221, v221
v_exp_f32 v222, v222
v_exp_f32 v223, v223
v_cvt_pk_bf16_f32 v216, v216, v217
v_cvt_pk_bf16_f32 v217, v218, v219
v_cvt_pk_bf16_f32 v218, v220, v221
v_cvt_pk_bf16_f32 v219, v222, v223
v_pk_fma_f32 v[224:225], v[224:225], s[40:41], v[50:51] op_sel_hi:[1,0,0] neg_lo:[0,0,1] neg_hi:[0,0,1]
v_pk_fma_f32 v[226:227], v[226:227], s[40:41], v[50:51] op_sel_hi:[1,0,0] neg_lo:[0,0,1] neg_hi:[0,0,1]
v_pk_fma_f32 v[228:229], v[228:229], s[40:41], v[50:51] op_sel_hi:[1,0,0] neg_lo:[0,0,1] neg_hi:[0,0,1]
v_pk_fma_f32 v[230:231], v[230:231], s[40:41], v[50:51] op_sel_hi:[1,0,0] neg_lo:[0,0,1] neg_hi:[0,0,1]
v_mfma_f32_16x16x32_bf16 v[32:35], a[176:179], v[216:219], v[32:35]
v_exp_f32 v224, v224
v_exp_f32 v225, v225
v_exp_f32 v226, v226
v_exp_f32 v227, v227
v_exp_f32 v228, v228
v_exp_f32 v229, v229
v_exp_f32 v230, v230
v_exp_f32 v231, v231
v_cvt_pk_bf16_f32 v224, v224, v225
v_cvt_pk_bf16_f32 v225, v226, v227
v_cvt_pk_bf16_f32 v226, v228, v229
v_cvt_pk_bf16_f32 v227, v230, v231
v_pk_fma_f32 v[232:233], v[232:233], s[40:41], v[46:47] op_sel_hi:[1,0,0] neg_lo:[0,0,1] neg_hi:[0,0,1]
v_pk_fma_f32 v[234:235], v[234:235], s[40:41], v[46:47] op_sel_hi:[1,0,0] neg_lo:[0,0,1] neg_hi:[0,0,1]
v_pk_fma_f32 v[236:237], v[236:237], s[40:41], v[46:47] op_sel_hi:[1,0,0] neg_lo:[0,0,1] neg_hi:[0,0,1]
v_pk_fma_f32 v[238:239], v[238:239], s[40:41], v[46:47] op_sel_hi:[1,0,0] neg_lo:[0,0,1] neg_hi:[0,0,1]
v_mfma_f32_16x16x32_bf16 v[36:39], a[176:179], v[224:227], v[36:39]
v_exp_f32 v232, v232
v_exp_f32 v233, v233
v_exp_f32 v234, v234
v_exp_f32 v235, v235
v_exp_f32 v236, v236
v_exp_f32 v237, v237
v_exp_f32 v238, v238
v_exp_f32 v239, v239
v_cvt_pk_bf16_f32 v232, v232, v233
v_cvt_pk_bf16_f32 v233, v234, v235
v_cvt_pk_bf16_f32 v234, v236, v237
v_cvt_pk_bf16_f32 v235, v238, v239
v_pk_fma_f32 v[240:241], v[240:241], s[40:41], v[48:49] op_sel_hi:[1,0,0] neg_lo:[0,0,1] neg_hi:[0,0,1]
v_pk_fma_f32 v[242:243], v[242:243], s[40:41], v[48:49] op_sel_hi:[1,0,0] neg_lo:[0,0,1] neg_hi:[0,0,1]
v_pk_fma_f32 v[244:245], v[244:245], s[40:41], v[48:49] op_sel_hi:[1,0,0] neg_lo:[0,0,1] neg_hi:[0,0,1]
v_pk_fma_f32 v[246:247], v[246:247], s[40:41], v[48:49] op_sel_hi:[1,0,0] neg_lo:[0,0,1] neg_hi:[0,0,1]
v_mfma_f32_16x16x32_bf16 v[28:31], a[176:179], v[232:235], v[28:31]
v_exp_f32 v240, v240
v_exp_f32 v241, v241
v_exp_f32 v242, v242
v_exp_f32 v243, v243
v_exp_f32 v244, v244
v_exp_f32 v245, v245
v_exp_f32 v246, v246
v_exp_f32 v247, v247
v_cvt_pk_bf16_f32 v240, v240, v241
v_cvt_pk_bf16_f32 v241, v242, v243
v_cvt_pk_bf16_f32 v242, v244, v245
v_cvt_pk_bf16_f32 v243, v246, v247
v_pk_fma_f32 v[248:249], v[248:249], s[40:41], v[50:51] op_sel_hi:[1,0,0] neg_lo:[0,0,1] neg_hi:[0,0,1]
v_pk_fma_f32 v[250:251], v[250:251], s[40:41], v[50:51] op_sel_hi:[1,0,0] neg_lo:[0,0,1] neg_hi:[0,0,1]
v_pk_fma_f32 v[252:253], v[252:253], s[40:41], v[50:51] op_sel_hi:[1,0,0] neg_lo:[0,0,1] neg_hi:[0,0,1]
v_pk_fma_f32 v[254:255], v[254:255], s[40:41], v[50:51] op_sel_hi:[1,0,0] neg_lo:[0,0,1] neg_hi:[0,0,1]
v_mfma_f32_16x16x32_bf16 v[32:35], a[176:179], v[240:243], v[32:35]
v_exp_f32 v248, v248
v_exp_f32 v249, v249
v_exp_f32 v250, v250
v_exp_f32 v251, v251
v_exp_f32 v252, v252
v_exp_f32 v253, v253
v_exp_f32 v254, v254
v_exp_f32 v255, v255
v_cvt_pk_bf16_f32 v248, v248, v249
v_cvt_pk_bf16_f32 v249, v250, v251
v_cvt_pk_bf16_f32 v250, v252, v253
v_cvt_pk_bf16_f32 v251, v254, v255
s_nop 1
v_mfma_f32_16x16x32_bf16 v[36:39], a[176:179], v[248:251], v[36:39]
s_waitcnt vmcnt(24)
s_barrier
v_add_u32 v13, 16384, v11
v_xor_b32 v14, 32, v13
v_xor_b32 v15, 64, v13
v_xor_b32 v16, 96, v13
ds_read_b64_tr_b16 a[96:97], v13
ds_read_b64_tr_b16 a[98:99], v13 offset:4096
ds_read_b64_tr_b16 a[100:101], v14
ds_read_b64_tr_b16 a[102:103], v14 offset:4096
ds_read_b64_tr_b16 a[104:105], v15
ds_read_b64_tr_b16 a[106:107], v15 offset:4096
ds_read_b64_tr_b16 a[108:109], v16
ds_read_b64_tr_b16 a[110:111], v16 offset:4096
s_waitcnt lgkmcnt(0)
v_mfma_f32_16x16x32_bf16 a[128:131], a[96:99], v[64:67], 0
v_add_u32 v13, 16384, v11
v_xor_b32 v13, 128, v13
v_mfma_f32_16x16x32_bf16 a[132:135], a[96:99], v[72:75], 0
v_xor_b32 v14, 32, v13
v_xor_b32 v15, 64, v13
v_mfma_f32_16x16x32_bf16 a[136:139], a[96:99], v[80:83], 0
v_xor_b32 v16, 96, v13
ds_read_b64_tr_b16 a[112:113], v13
v_mfma_f32_16x16x32_bf16 a[140:143], a[100:103], v[64:67], 0
ds_read_b64_tr_b16 a[114:115], v13 offset:4096
ds_read_b64_tr_b16 a[116:117], v14
ds_read_b64_tr_b16 a[118:119], v14 offset:4096
v_mfma_f32_16x16x32_bf16 a[144:147], a[100:103], v[72:75], 0
ds_read_b64_tr_b16 a[120:121], v15
ds_read_b64_tr_b16 a[122:123], v15 offset:4096
v_mfma_f32_16x16x32_bf16 a[148:151], a[100:103], v[80:83], 0
ds_read_b64_tr_b16 a[124:125], v16
ds_read_b64_tr_b16 a[126:127], v16 offset:4096
v_mfma_f32_16x16x32_bf16 a[152:155], a[104:107], v[64:67], 0
v_mfma_f32_16x16x32_bf16 a[156:159], a[104:107], v[72:75], 0
v_mfma_f32_16x16x32_bf16 a[160:163], a[104:107], v[80:83], 0
v_mfma_f32_16x16x32_bf16 a[164:167], a[108:111], v[64:67], 0
v_mfma_f32_16x16x32_bf16 a[168:171], a[108:111], v[72:75], 0
v_mfma_f32_16x16x32_bf16 a[172:175], a[108:111], v[80:83], 0
s_waitcnt lgkmcnt(0)
s_waitcnt vmcnt(20)
s_barrier
s_mov_b32 s45, 114688
s_add_u32 m0, s39, 16384
s_nop 0
buffer_load_dwordx4 v8, s[24:27], s45 offen offset:0 nt lds
buffer_load_dwordx4 v9, s[24:27], s45 offen offset:1024 nt lds
buffer_load_dwordx4 v8, s[24:27], s45 offen offset:2048 nt lds
buffer_load_dwordx4 v9, s[24:27], s45 offen offset:3072 nt lds
v_mfma_f32_16x16x32_bf16 a[208:211], a[112:115], v[64:67], 0
v_add_u32 v13, 32768, v11
v_xor_b32 v14, 32, v13
v_mfma_f32_16x16x32_bf16 a[212:215], a[112:115], v[72:75], 0
v_xor_b32 v15, 64, v13
v_xor_b32 v16, 96, v13
v_mfma_f32_16x16x32_bf16 a[216:219], a[112:115], v[80:83], 0
ds_read_b64_tr_b16 a[96:97], v13
ds_read_b64_tr_b16 a[98:99], v13 offset:4096
v_mfma_f32_16x16x32_bf16 a[220:223], a[116:119], v[64:67], 0
ds_read_b64_tr_b16 a[100:101], v14
ds_read_b64_tr_b16 a[102:103], v14 offset:4096
v_mfma_f32_16x16x32_bf16 a[224:227], a[116:119], v[72:75], 0
ds_read_b64_tr_b16 a[104:105], v15
ds_read_b64_tr_b16 a[106:107], v15 offset:4096
v_mfma_f32_16x16x32_bf16 a[228:231], a[116:119], v[80:83], 0
ds_read_b64_tr_b16 a[108:109], v16
ds_read_b64_tr_b16 a[110:111], v16 offset:4096
v_mfma_f32_16x16x32_bf16 a[232:235], a[120:123], v[64:67], 0
v_mfma_f32_16x16x32_bf16 a[236:239], a[120:123], v[72:75], 0
v_mfma_f32_16x16x32_bf16 a[240:243], a[120:123], v[80:83], 0
v_mfma_f32_16x16x32_bf16 a[244:247], a[124:127], v[64:67], 0
v_mfma_f32_16x16x32_bf16 a[248:251], a[124:127], v[72:75], 0
v_mfma_f32_16x16x32_bf16 a[252:255], a[124:127], v[80:83], 0
s_waitcnt lgkmcnt(0)
v_mfma_f32_16x16x32_bf16 a[128:131], a[96:99], v[88:91], a[128:131]
v_add_u32 v13, 32768, v11
v_xor_b32 v13, 128, v13
v_mfma_f32_16x16x32_bf16 a[132:135], a[96:99], v[96:99], a[132:135]
v_xor_b32 v14, 32, v13
v_xor_b32 v15, 64, v13
v_mfma_f32_16x16x32_bf16 a[136:139], a[96:99], v[104:107], a[136:139]
v_xor_b32 v16, 96, v13
ds_read_b64_tr_b16 a[112:113], v13
v_mfma_f32_16x16x32_bf16 a[140:143], a[100:103], v[88:91], a[140:143]
ds_read_b64_tr_b16 a[114:115], v13 offset:4096
ds_read_b64_tr_b16 a[116:117], v14
ds_read_b64_tr_b16 a[118:119], v14 offset:4096
v_mfma_f32_16x16x32_bf16 a[144:147], a[100:103], v[96:99], a[144:147]
ds_read_b64_tr_b16 a[120:121], v15
ds_read_b64_tr_b16 a[122:123], v15 offset:4096
v_mfma_f32_16x16x32_bf16 a[148:151], a[100:103], v[104:107], a[148:151]
ds_read_b64_tr_b16 a[124:125], v16
ds_read_b64_tr_b16 a[126:127], v16 offset:4096
v_mfma_f32_16x16x32_bf16 a[152:155], a[104:107], v[88:91], a[152:155]
v_mfma_f32_16x16x32_bf16 a[156:159], a[104:107], v[96:99], a[156:159]
v_mfma_f32_16x16x32_bf16 a[160:163], a[104:107], v[104:107], a[160:163]
v_mfma_f32_16x16x32_bf16 a[164:167], a[108:111], v[88:91], a[164:167]
v_mfma_f32_16x16x32_bf16 a[168:171], a[108:111], v[96:99], a[168:171]
v_mfma_f32_16x16x32_bf16 a[172:175], a[108:111], v[104:107], a[172:175]
s_waitcnt lgkmcnt(0)
s_waitcnt vmcnt(20)
s_barrier
s_mov_b32 s45, 4194304
s_add_u32 m0, s39, 32768
s_nop 0
buffer_load_dwordx4 v4, s[20:23], s45 offen offset:0 nt lds
buffer_load_dwordx4 v5, s[20:23], s45 offen offset:1024 nt lds
buffer_load_dwordx4 v6, s[20:23], s45 offen offset:2048 nt lds
buffer_load_dwordx4 v7, s[20:23], s45 offen offset:3072 nt lds
v_mfma_f32_16x16x32_bf16 a[208:211], a[112:115], v[88:91], a[208:211]
v_add_u32 v13, 49152, v11
v_xor_b32 v14, 32, v13
v_mfma_f32_16x16x32_bf16 a[212:215], a[112:115], v[96:99], a[212:215]
v_xor_b32 v15, 64, v13
v_xor_b32 v16, 96, v13
v_mfma_f32_16x16x32_bf16 a[216:219], a[112:115], v[104:107], a[216:219]
ds_read_b64_tr_b16 a[96:97], v13
ds_read_b64_tr_b16 a[98:99], v13 offset:4096
v_mfma_f32_16x16x32_bf16 a[220:223], a[116:119], v[88:91], a[220:223]
ds_read_b64_tr_b16 a[100:101], v14
ds_read_b64_tr_b16 a[102:103], v14 offset:4096
v_mfma_f32_16x16x32_bf16 a[224:227], a[116:119], v[96:99], a[224:227]
ds_read_b64_tr_b16 a[104:105], v15
ds_read_b64_tr_b16 a[106:107], v15 offset:4096
v_mfma_f32_16x16x32_bf16 a[228:231], a[116:119], v[104:107], a[228:231]
ds_read_b64_tr_b16 a[108:109], v16
ds_read_b64_tr_b16 a[110:111], v16 offset:4096
v_mfma_f32_16x16x32_bf16 a[232:235], a[120:123], v[88:91], a[232:235]
v_mfma_f32_16x16x32_bf16 a[236:239], a[120:123], v[96:99], a[236:239]
v_mfma_f32_16x16x32_bf16 a[240:243], a[120:123], v[104:107], a[240:243]
v_mfma_f32_16x16x32_bf16 a[244:247], a[124:127], v[88:91], a[244:247]
v_mfma_f32_16x16x32_bf16 a[248:251], a[124:127], v[96:99], a[248:251]
v_mfma_f32_16x16x32_bf16 a[252:255], a[124:127], v[104:107], a[252:255]
s_waitcnt lgkmcnt(0)
v_add_u32 v57, s36, v1
v_cmp_eq_u32 vcc, 0, v57
v_mov_b32 v56, 0x1000
v_mov_b32 v58, 0
v_cndmask_b32 v57, v56, v58, vcc
buffer_load_dword a180, v57, s[80:83], 0 offen sc1
v_mfma_f32_16x16x32_bf16 a[128:131], a[96:99], v[112:115], a[128:131]
v_add_u32 v13, 49152, v11
v_xor_b32 v13, 128, v13
v_mfma_f32_16x16x32_bf16 a[132:135], a[96:99], v[120:123], a[132:135]
v_xor_b32 v14, 32, v13
v_xor_b32 v15, 64, v13
v_mfma_f32_16x16x32_bf16 a[136:139], a[96:99], v[128:131], a[136:139]
v_xor_b32 v16, 96, v13
ds_read_b64_tr_b16 a[112:113], v13
v_mfma_f32_16x16x32_bf16 a[140:143], a[100:103], v[112:115], a[140:143]
ds_read_b64_tr_b16 a[114:115], v13 offset:4096
ds_read_b64_tr_b16 a[116:117], v14
ds_read_b64_tr_b16 a[118:119], v14 offset:4096
v_mfma_f32_16x16x32_bf16 a[144:147], a[100:103], v[120:123], a[144:147]
ds_read_b64_tr_b16 a[120:121], v15
ds_read_b64_tr_b16 a[122:123], v15 offset:4096
v_mfma_f32_16x16x32_bf16 a[148:151], a[100:103], v[128:131], a[148:151]
ds_read_b64_tr_b16 a[124:125], v16
ds_read_b64_tr_b16 a[126:127], v16 offset:4096
v_mfma_f32_16x16x32_bf16 a[152:155], a[104:107], v[112:115], a[152:155]
v_mfma_f32_16x16x32_bf16 a[156:159], a[104:107], v[120:123], a[156:159]
v_mfma_f32_16x16x32_bf16 a[160:163], a[104:107], v[128:131], a[160:163]
v_mfma_f32_16x16x32_bf16 a[164:167], a[108:111], v[112:115], a[164:167]
v_mfma_f32_16x16x32_bf16 a[168:171], a[108:111], v[120:123], a[168:171]
v_mfma_f32_16x16x32_bf16 a[172:175], a[108:111], v[128:131], a[172:175]
s_waitcnt lgkmcnt(0)
s_waitcnt vmcnt(20)
s_barrier
s_mov_b32 s45, 4210688
s_add_u32 m0, s39, 49152
s_nop 0
buffer_load_dwordx4 v4, s[20:23], s45 offen offset:0 nt lds
buffer_load_dwordx4 v5, s[20:23], s45 offen offset:1024 nt lds
buffer_load_dwordx4 v6, s[20:23], s45 offen offset:2048 nt lds
buffer_load_dwordx4 v7, s[20:23], s45 offen offset:3072 nt lds
v_mfma_f32_16x16x32_bf16 a[208:211], a[112:115], v[112:115], a[208:211]
v_add_u32 v13, 65536, v11
v_xor_b32 v14, 32, v13
v_mfma_f32_16x16x32_bf16 a[212:215], a[112:115], v[120:123], a[212:215]
v_xor_b32 v15, 64, v13
v_xor_b32 v16, 96, v13
v_mfma_f32_16x16x32_bf16 a[216:219], a[112:115], v[128:131], a[216:219]
ds_read_b64_tr_b16 a[96:97], v13
ds_read_b64_tr_b16 a[98:99], v13 offset:4096
v_mfma_f32_16x16x32_bf16 a[220:223], a[116:119], v[112:115], a[220:223]
ds_read_b64_tr_b16 a[100:101], v14
ds_read_b64_tr_b16 a[102:103], v14 offset:4096
v_mfma_f32_16x16x32_bf16 a[224:227], a[116:119], v[120:123], a[224:227]
ds_read_b64_tr_b16 a[104:105], v15
ds_read_b64_tr_b16 a[106:107], v15 offset:4096
v_mfma_f32_16x16x32_bf16 a[228:231], a[116:119], v[128:131], a[228:231]
ds_read_b64_tr_b16 a[108:109], v16
ds_read_b64_tr_b16 a[110:111], v16 offset:4096
v_mfma_f32_16x16x32_bf16 a[232:235], a[120:123], v[112:115], a[232:235]
v_mfma_f32_16x16x32_bf16 a[236:239], a[120:123], v[120:123], a[236:239]
v_mfma_f32_16x16x32_bf16 a[240:243], a[120:123], v[128:131], a[240:243]
v_mfma_f32_16x16x32_bf16 a[244:247], a[124:127], v[112:115], a[244:247]
v_mfma_f32_16x16x32_bf16 a[248:251], a[124:127], v[120:123], a[248:251]
v_mfma_f32_16x16x32_bf16 a[252:255], a[124:127], v[128:131], a[252:255]
s_waitcnt lgkmcnt(0)
v_mfma_f32_16x16x32_bf16 a[128:131], a[96:99], v[136:139], a[128:131]
v_add_u32 v13, 65536, v11
v_xor_b32 v13, 128, v13
v_mfma_f32_16x16x32_bf16 a[132:135], a[96:99], v[144:147], a[132:135]
v_xor_b32 v14, 32, v13
v_xor_b32 v15, 64, v13
v_mfma_f32_16x16x32_bf16 a[136:139], a[96:99], v[152:155], a[136:139]
v_xor_b32 v16, 96, v13
ds_read_b64_tr_b16 a[112:113], v13
v_mfma_f32_16x16x32_bf16 a[140:143], a[100:103], v[136:139], a[140:143]
ds_read_b64_tr_b16 a[114:115], v13 offset:4096
ds_read_b64_tr_b16 a[116:117], v14
ds_read_b64_tr_b16 a[118:119], v14 offset:4096
v_mfma_f32_16x16x32_bf16 a[144:147], a[100:103], v[144:147], a[144:147]
ds_read_b64_tr_b16 a[120:121], v15
ds_read_b64_tr_b16 a[122:123], v15 offset:4096
v_mfma_f32_16x16x32_bf16 a[148:151], a[100:103], v[152:155], a[148:151]
ds_read_b64_tr_b16 a[124:125], v16
ds_read_b64_tr_b16 a[126:127], v16 offset:4096
v_mfma_f32_16x16x32_bf16 a[152:155], a[104:107], v[136:139], a[152:155]
v_mfma_f32_16x16x32_bf16 a[156:159], a[104:107], v[144:147], a[156:159]
v_mfma_f32_16x16x32_bf16 a[160:163], a[104:107], v[152:155], a[160:163]
v_mfma_f32_16x16x32_bf16 a[164:167], a[108:111], v[136:139], a[164:167]
v_mfma_f32_16x16x32_bf16 a[168:171], a[108:111], v[144:147], a[168:171]
v_mfma_f32_16x16x32_bf16 a[172:175], a[108:111], v[152:155], a[172:175]
s_waitcnt lgkmcnt(0)
s_waitcnt vmcnt(20)
s_barrier
s_mov_b32 s45, 4227072
s_add_u32 m0, s39, 65536
s_nop 0
buffer_load_dwordx4 v4, s[20:23], s45 offen offset:0 nt lds
buffer_load_dwordx4 v5, s[20:23], s45 offen offset:1024 nt lds
buffer_load_dwordx4 v6, s[20:23], s45 offen offset:2048 nt lds
v_mfma_f32_16x16x32_bf16 a[208:211], a[112:115], v[136:139], a[208:211]
buffer_load_dwordx4 v7, s[20:23], s45 offen offset:3072 nt lds
v_add_u32 v13, 81920, v11
v_xor_b32 v14, 32, v13
v_mfma_f32_16x16x32_bf16 a[212:215], a[112:115], v[144:147], a[212:215]
v_xor_b32 v15, 64, v13
v_xor_b32 v16, 96, v13
v_mfma_f32_16x16x32_bf16 a[216:219], a[112:115], v[152:155], a[216:219]
ds_read_b64_tr_b16 a[96:97], v13
ds_read_b64_tr_b16 a[98:99], v13 offset:4096
v_mfma_f32_16x16x32_bf16 a[220:223], a[116:119], v[136:139], a[220:223]
ds_read_b64_tr_b16 a[100:101], v14
ds_read_b64_tr_b16 a[102:103], v14 offset:4096
v_mfma_f32_16x16x32_bf16 a[224:227], a[116:119], v[144:147], a[224:227]
ds_read_b64_tr_b16 a[104:105], v15
ds_read_b64_tr_b16 a[106:107], v15 offset:4096
v_mfma_f32_16x16x32_bf16 a[228:231], a[116:119], v[152:155], a[228:231]
ds_read_b64_tr_b16 a[108:109], v16
ds_read_b64_tr_b16 a[110:111], v16 offset:4096
v_mfma_f32_16x16x32_bf16 a[232:235], a[120:123], v[136:139], a[232:235]
v_mfma_f32_16x16x32_bf16 a[236:239], a[120:123], v[144:147], a[236:239]
v_mfma_f32_16x16x32_bf16 a[240:243], a[120:123], v[152:155], a[240:243]
v_mfma_f32_16x16x32_bf16 a[244:247], a[124:127], v[136:139], a[244:247]
v_mfma_f32_16x16x32_bf16 a[248:251], a[124:127], v[144:147], a[248:251]
v_mfma_f32_16x16x32_bf16 a[252:255], a[124:127], v[152:155], a[252:255]
s_waitcnt lgkmcnt(0)
v_mfma_f32_16x16x32_bf16 a[128:131], a[96:99], v[160:163], a[128:131]
v_add_u32 v13, 81920, v11
v_xor_b32 v13, 128, v13
v_mfma_f32_16x16x32_bf16 a[132:135], a[96:99], v[168:171], a[132:135]
v_xor_b32 v14, 32, v13
v_xor_b32 v15, 64, v13
v_mfma_f32_16x16x32_bf16 a[136:139], a[96:99], v[176:179], a[136:139]
v_xor_b32 v16, 96, v13
ds_read_b64_tr_b16 a[112:113], v13
v_mfma_f32_16x16x32_bf16 a[140:143], a[100:103], v[160:163], a[140:143]
ds_read_b64_tr_b16 a[114:115], v13 offset:4096
ds_read_b64_tr_b16 a[116:117], v14
ds_read_b64_tr_b16 a[118:119], v14 offset:4096
v_mfma_f32_16x16x32_bf16 a[144:147], a[100:103], v[168:171], a[144:147]
ds_read_b64_tr_b16 a[120:121], v15
ds_read_b64_tr_b16 a[122:123], v15 offset:4096
v_mfma_f32_16x16x32_bf16 a[148:151], a[100:103], v[176:179], a[148:151]
ds_read_b64_tr_b16 a[124:125], v16
ds_read_b64_tr_b16 a[126:127], v16 offset:4096
v_mfma_f32_16x16x32_bf16 a[152:155], a[104:107], v[160:163], a[152:155]
v_mfma_f32_16x16x32_bf16 a[156:159], a[104:107], v[168:171], a[156:159]
v_mfma_f32_16x16x32_bf16 a[160:163], a[104:107], v[176:179], a[160:163]
v_mfma_f32_16x16x32_bf16 a[164:167], a[108:111], v[160:163], a[164:167]
v_mfma_f32_16x16x32_bf16 a[168:171], a[108:111], v[168:171], a[168:171]
v_mfma_f32_16x16x32_bf16 a[172:175], a[108:111], v[176:179], a[172:175]
s_waitcnt lgkmcnt(0)
s_waitcnt vmcnt(20)
s_barrier
s_mov_b32 s45, 4243456
s_add_u32 m0, s39, 81920
s_nop 0
buffer_load_dwordx4 v4, s[20:23], s45 offen offset:0 nt lds
buffer_load_dwordx4 v5, s[20:23], s45 offen offset:1024 nt lds
v_mfma_f32_16x16x32_bf16 a[208:211], a[112:115], v[160:163], a[208:211]
v_add_u32 v13, 98304, v11
v_xor_b32 v14, 32, v13
v_mfma_f32_16x16x32_bf16 a[212:215], a[112:115], v[168:171], a[212:215]
v_xor_b32 v15, 64, v13
v_xor_b32 v16, 96, v13
v_mfma_f32_16x16x32_bf16 a[216:219], a[112:115], v[176:179], a[216:219]
ds_read_b64_tr_b16 a[96:97], v13
ds_read_b64_tr_b16 a[98:99], v13 offset:4096
v_mfma_f32_16x16x32_bf16 a[220:223], a[116:119], v[160:163], a[220:223]
buffer_load_dwordx4 v6, s[20:23], s45 offen offset:2048 nt lds
ds_read_b64_tr_b16 a[100:101], v14
ds_read_b64_tr_b16 a[102:103], v14 offset:4096
v_mfma_f32_16x16x32_bf16 a[224:227], a[116:119], v[168:171], a[224:227]
ds_read_b64_tr_b16 a[104:105], v15
ds_read_b64_tr_b16 a[106:107], v15 offset:4096
v_mfma_f32_16x16x32_bf16 a[228:231], a[116:119], v[176:179], a[228:231]
ds_read_b64_tr_b16 a[108:109], v16
ds_read_b64_tr_b16 a[110:111], v16 offset:4096
v_mfma_f32_16x16x32_bf16 a[232:235], a[120:123], v[160:163], a[232:235]
v_mfma_f32_16x16x32_bf16 a[236:239], a[120:123], v[168:171], a[236:239]
v_mfma_f32_16x16x32_bf16 a[240:243], a[120:123], v[176:179], a[240:243]
v_mfma_f32_16x16x32_bf16 a[244:247], a[124:127], v[160:163], a[244:247]
v_mfma_f32_16x16x32_bf16 a[248:251], a[124:127], v[168:171], a[248:251]
v_mfma_f32_16x16x32_bf16 a[252:255], a[124:127], v[176:179], a[252:255]
s_waitcnt lgkmcnt(0)
v_mfma_f32_16x16x32_bf16 a[128:131], a[96:99], v[184:187], a[128:131]
v_add_u32 v13, 98304, v11
v_xor_b32 v13, 128, v13
buffer_load_dwordx4 v7, s[20:23], s45 offen offset:3072 nt lds
v_mfma_f32_16x16x32_bf16 a[132:135], a[96:99], v[192:195], a[132:135]
v_xor_b32 v14, 32, v13
v_xor_b32 v15, 64, v13
v_mfma_f32_16x16x32_bf16 a[136:139], a[96:99], v[200:203], a[136:139]
v_xor_b32 v16, 96, v13
ds_read_b64_tr_b16 a[112:113], v13
v_mfma_f32_16x16x32_bf16 a[140:143], a[100:103], v[184:187], a[140:143]
ds_read_b64_tr_b16 a[114:115], v13 offset:4096
ds_read_b64_tr_b16 a[116:117], v14
ds_read_b64_tr_b16 a[118:119], v14 offset:4096
v_mfma_f32_16x16x32_bf16 a[144:147], a[100:103], v[192:195], a[144:147]
ds_read_b64_tr_b16 a[120:121], v15
ds_read_b64_tr_b16 a[122:123], v15 offset:4096
v_mfma_f32_16x16x32_bf16 a[148:151], a[100:103], v[200:203], a[148:151]
ds_read_b64_tr_b16 a[124:125], v16
ds_read_b64_tr_b16 a[126:127], v16 offset:4096
v_mfma_f32_16x16x32_bf16 a[152:155], a[104:107], v[184:187], a[152:155]
v_mfma_f32_16x16x32_bf16 a[156:159], a[104:107], v[192:195], a[156:159]
v_mfma_f32_16x16x32_bf16 a[160:163], a[104:107], v[200:203], a[160:163]
v_mfma_f32_16x16x32_bf16 a[164:167], a[108:111], v[184:187], a[164:167]
v_mfma_f32_16x16x32_bf16 a[168:171], a[108:111], v[192:195], a[168:171]
v_mfma_f32_16x16x32_bf16 a[172:175], a[108:111], v[200:203], a[172:175]
s_waitcnt lgkmcnt(0)
s_waitcnt vmcnt(20)
s_barrier
s_mov_b32 s45, 4259840
s_add_u32 m0, s39, 98304
s_nop 0
buffer_load_dwordx4 v4, s[20:23], s45 offen offset:0 nt lds
v_mfma_f32_16x16x32_bf16 a[208:211], a[112:115], v[184:187], a[208:211]
v_add_u32 v13, 0, v11
v_xor_b32 v14, 32, v13
v_mfma_f32_16x16x32_bf16 a[212:215], a[112:115], v[192:195], a[212:215]
v_xor_b32 v15, 64, v13
v_xor_b32 v16, 96, v13
v_mfma_f32_16x16x32_bf16 a[216:219], a[112:115], v[200:203], a[216:219]
ds_read_b64_tr_b16 a[96:97], v13
ds_read_b64_tr_b16 a[98:99], v13 offset:4096
v_mfma_f32_16x16x32_bf16 a[220:223], a[116:119], v[184:187], a[220:223]
ds_read_b64_tr_b16 a[100:101], v14
ds_read_b64_tr_b16 a[102:103], v14 offset:4096
v_mfma_f32_16x16x32_bf16 a[224:227], a[116:119], v[192:195], a[224:227]
ds_read_b64_tr_b16 a[104:105], v15
ds_read_b64_tr_b16 a[106:107], v15 offset:4096
v_mfma_f32_16x16x32_bf16 a[228:231], a[116:119], v[200:203], a[228:231]
buffer_load_dwordx4 v5, s[20:23], s45 offen offset:1024 nt lds
ds_read_b64_tr_b16 a[108:109], v16
ds_read_b64_tr_b16 a[110:111], v16 offset:4096
v_mfma_f32_16x16x32_bf16 a[232:235], a[120:123], v[184:187], a[232:235]
v_mfma_f32_16x16x32_bf16 a[236:239], a[120:123], v[192:195], a[236:239]
v_mfma_f32_16x16x32_bf16 a[240:243], a[120:123], v[200:203], a[240:243]
v_mfma_f32_16x16x32_bf16 a[244:247], a[124:127], v[184:187], a[244:247]
v_mfma_f32_16x16x32_bf16 a[248:251], a[124:127], v[192:195], a[248:251]
v_mfma_f32_16x16x32_bf16 a[252:255], a[124:127], v[200:203], a[252:255]
s_waitcnt lgkmcnt(0)
v_mfma_f32_16x16x32_bf16 a[128:131], a[96:99], v[208:211], a[128:131]
v_add_u32 v13, 0, v11
v_xor_b32 v13, 128, v13
v_mfma_f32_16x16x32_bf16 a[132:135], a[96:99], v[216:219], a[132:135]
v_xor_b32 v14, 32, v13
v_xor_b32 v15, 64, v13
v_mfma_f32_16x16x32_bf16 a[136:139], a[96:99], v[224:227], a[136:139]
v_xor_b32 v16, 96, v13
ds_read_b64_tr_b16 a[112:113], v13
v_mfma_f32_16x16x32_bf16 a[140:143], a[100:103], v[208:211], a[140:143]
buffer_load_dwordx4 v6, s[20:23], s45 offen offset:2048 nt lds
ds_read_b64_tr_b16 a[114:115], v13 offset:4096
ds_read_b64_tr_b16 a[116:117], v14
ds_read_b64_tr_b16 a[118:119], v14 offset:4096
v_mfma_f32_16x16x32_bf16 a[144:147], a[100:103], v[216:219], a[144:147]
ds_read_b64_tr_b16 a[120:121], v15
ds_read_b64_tr_b16 a[122:123], v15 offset:4096
v_mfma_f32_16x16x32_bf16 a[148:151], a[100:103], v[224:227], a[148:151]
ds_read_b64_tr_b16 a[124:125], v16
ds_read_b64_tr_b16 a[126:127], v16 offset:4096
v_mfma_f32_16x16x32_bf16 a[152:155], a[104:107], v[208:211], a[152:155]
v_mfma_f32_16x16x32_bf16 a[156:159], a[104:107], v[216:219], a[156:159]
v_mfma_f32_16x16x32_bf16 a[160:163], a[104:107], v[224:227], a[160:163]
v_mfma_f32_16x16x32_bf16 a[164:167], a[108:111], v[208:211], a[164:167]
v_mfma_f32_16x16x32_bf16 a[168:171], a[108:111], v[216:219], a[168:171]
v_mfma_f32_16x16x32_bf16 a[172:175], a[108:111], v[224:227], a[172:175]
s_waitcnt lgkmcnt(0)
s_waitcnt vmcnt(19)
s_barrier
buffer_load_dwordx4 v7, s[20:23], s45 offen offset:3072 nt lds
v_mfma_f32_16x16x32_bf16 a[208:211], a[112:115], v[208:211], a[208:211]
v_add_u32 v13, 16384, v11
v_xor_b32 v14, 32, v13
v_mfma_f32_16x16x32_bf16 a[212:215], a[112:115], v[216:219], a[212:215]
v_xor_b32 v15, 64, v13
v_xor_b32 v16, 96, v13
v_mfma_f32_16x16x32_bf16 a[216:219], a[112:115], v[224:227], a[216:219]
ds_read_b64_tr_b16 a[96:97], v13
ds_read_b64_tr_b16 a[98:99], v13 offset:4096
v_mfma_f32_16x16x32_bf16 a[220:223], a[116:119], v[208:211], a[220:223]
ds_read_b64_tr_b16 a[100:101], v14
ds_read_b64_tr_b16 a[102:103], v14 offset:4096
v_mfma_f32_16x16x32_bf16 a[224:227], a[116:119], v[216:219], a[224:227]
ds_read_b64_tr_b16 a[104:105], v15
ds_read_b64_tr_b16 a[106:107], v15 offset:4096
v_mfma_f32_16x16x32_bf16 a[228:231], a[116:119], v[224:227], a[228:231]
ds_read_b64_tr_b16 a[108:109], v16
ds_read_b64_tr_b16 a[110:111], v16 offset:4096
v_mfma_f32_16x16x32_bf16 a[232:235], a[120:123], v[208:211], a[232:235]
v_mfma_f32_16x16x32_bf16 a[236:239], a[120:123], v[216:219], a[236:239]
v_mfma_f32_16x16x32_bf16 a[240:243], a[120:123], v[224:227], a[240:243]
v_mfma_f32_16x16x32_bf16 a[244:247], a[124:127], v[208:211], a[244:247]
v_mfma_f32_16x16x32_bf16 a[248:251], a[124:127], v[216:219], a[248:251]
v_mfma_f32_16x16x32_bf16 a[252:255], a[124:127], v[224:227], a[252:255]
s_waitcnt lgkmcnt(0)
v_mfma_f32_16x16x32_bf16 a[128:131], a[96:99], v[232:235], a[128:131]
v_add_u32 v13, 16384, v11
v_xor_b32 v13, 128, v13
v_mfma_f32_16x16x32_bf16 a[132:135], a[96:99], v[240:243], a[132:135]
v_xor_b32 v14, 32, v13
v_xor_b32 v15, 64, v13
v_mfma_f32_16x16x32_bf16 a[136:139], a[96:99], v[248:251], a[136:139]
v_xor_b32 v16, 96, v13
ds_read_b64_tr_b16 a[112:113], v13
v_mfma_f32_16x16x32_bf16 a[140:143], a[100:103], v[232:235], a[140:143]
ds_read_b64_tr_b16 a[114:115], v13 offset:4096
ds_read_b64_tr_b16 a[116:117], v14
ds_read_b64_tr_b16 a[118:119], v14 offset:4096
v_mfma_f32_16x16x32_bf16 a[144:147], a[100:103], v[240:243], a[144:147]
ds_read_b64_tr_b16 a[120:121], v15
ds_read_b64_tr_b16 a[122:123], v15 offset:4096
v_mfma_f32_16x16x32_bf16 a[148:151], a[100:103], v[248:251], a[148:151]
ds_read_b64_tr_b16 a[124:125], v16
ds_read_b64_tr_b16 a[126:127], v16 offset:4096
v_mfma_f32_16x16x32_bf16 a[152:155], a[104:107], v[232:235], a[152:155]
v_mfma_f32_16x16x32_bf16 a[156:159], a[104:107], v[240:243], a[156:159]
v_mfma_f32_16x16x32_bf16 a[160:163], a[104:107], v[248:251], a[160:163]
v_mfma_f32_16x16x32_bf16 a[164:167], a[108:111], v[232:235], a[164:167]
v_mfma_f32_16x16x32_bf16 a[168:171], a[108:111], v[240:243], a[168:171]
v_mfma_f32_16x16x32_bf16 a[172:175], a[108:111], v[248:251], a[172:175]
s_waitcnt lgkmcnt(0)
v_mfma_f32_16x16x32_bf16 a[208:211], a[112:115], v[232:235], a[208:211]
v_mfma_f32_16x16x32_bf16 a[212:215], a[112:115], v[240:243], a[212:215]
v_mfma_f32_16x16x32_bf16 a[216:219], a[112:115], v[248:251], a[216:219]
v_mfma_f32_16x16x32_bf16 a[220:223], a[116:119], v[232:235], a[220:223]
v_mfma_f32_16x16x32_bf16 a[224:227], a[116:119], v[240:243], a[224:227]
v_mfma_f32_16x16x32_bf16 a[228:231], a[116:119], v[248:251], a[228:231]
v_mfma_f32_16x16x32_bf16 a[232:235], a[120:123], v[232:235], a[232:235]
v_mfma_f32_16x16x32_bf16 a[236:239], a[120:123], v[240:243], a[236:239]
v_mfma_f32_16x16x32_bf16 a[240:243], a[120:123], v[248:251], a[240:243]
v_mfma_f32_16x16x32_bf16 a[244:247], a[124:127], v[232:235], a[244:247]
v_mfma_f32_16x16x32_bf16 a[248:251], a[124:127], v[240:243], a[248:251]
v_mfma_f32_16x16x32_bf16 a[252:255], a[124:127], v[248:251], a[252:255]
s_mul_i32 s43, s36, 768
v_lshlrev_b32 v43, 2, v1
v_add_u32 v43, 0, v43
v_add_u32 v47, s43, v43
s_xor_b32 s43, s36, 2
s_mul_i32 s43, s43, 768
v_add_u32 v49, s43, v43
ds_write_b32 v47, v28 offset:0
ds_write_b32 v47, v32 offset:256
ds_write_b32 v47, v36 offset:512
s_mul_i32 s43, s36, 12288
v_add_u32 v43, 114688, v12
v_add_u32 v44, s43, v43
s_xor_b32 s43, s36, 2
s_mul_i32 s43, s43, 12288
v_add_u32 v45, s43, v43
s_nop 4
ds_write_b128 v44, a[208:211] offset:0
ds_write_b128 v44, a[212:215] offset:1024
ds_write_b128 v44, a[216:219] offset:2048
ds_write_b128 v44, a[220:223] offset:3072
ds_write_b128 v44, a[224:227] offset:4096
ds_write_b128 v44, a[228:231] offset:5120
ds_write_b128 v44, a[232:235] offset:6144
ds_write_b128 v44, a[236:239] offset:7168
ds_write_b128 v44, a[240:243] offset:8192
ds_write_b128 v44, a[244:247] offset:9216
ds_write_b128 v44, a[248:251] offset:10240
ds_write_b128 v44, a[252:255] offset:11264
v_accvgpr_read_b32 v68, a128
v_accvgpr_read_b32 v69, a129
v_accvgpr_read_b32 v70, a130
v_accvgpr_read_b32 v71, a131
v_accvgpr_read_b32 v76, a132
v_accvgpr_read_b32 v77, a133
v_accvgpr_read_b32 v78, a134
v_accvgpr_read_b32 v79, a135
v_accvgpr_read_b32 v84, a136
v_accvgpr_read_b32 v85, a137
v_accvgpr_read_b32 v86, a138
v_accvgpr_read_b32 v87, a139
v_accvgpr_read_b32 v92, a140
v_accvgpr_read_b32 v93, a141
v_accvgpr_read_b32 v94, a142
v_accvgpr_read_b32 v95, a143
v_accvgpr_read_b32 v100, a144
v_accvgpr_read_b32 v101, a145
v_accvgpr_read_b32 v102, a146
v_accvgpr_read_b32 v103, a147
v_accvgpr_read_b32 v108, a148
v_accvgpr_read_b32 v109, a149
v_accvgpr_read_b32 v110, a150
v_accvgpr_read_b32 v111, a151
v_accvgpr_read_b32 v116, a152
v_accvgpr_read_b32 v117, a153
v_accvgpr_read_b32 v118, a154
v_accvgpr_read_b32 v119, a155
v_accvgpr_read_b32 v124, a156
v_accvgpr_read_b32 v125, a157
v_accvgpr_read_b32 v126, a158
v_accvgpr_read_b32 v127, a159
v_accvgpr_read_b32 v132, a160
v_accvgpr_read_b32 v133, a161
v_accvgpr_read_b32 v134, a162
v_accvgpr_read_b32 v135, a163
v_accvgpr_read_b32 v140, a164
v_accvgpr_read_b32 v141, a165
v_accvgpr_read_b32 v142, a166
v_accvgpr_read_b32 v143, a167
v_accvgpr_read_b32 v148, a168
v_accvgpr_read_b32 v149, a169
v_accvgpr_read_b32 v150, a170
v_accvgpr_read_b32 v151, a171
v_accvgpr_read_b32 v156, a172
v_accvgpr_read_b32 v157, a173
v_accvgpr_read_b32 v158, a174
v_accvgpr_read_b32 v159, a175
s_waitcnt lgkmcnt(0)
s_barrier
ds_read_b32 v40, v49 offset:0
ds_read_b32 v41, v49 offset:256
ds_read_b32 v42, v49 offset:512
ds_read_b128 v[64:67], v45 offset:0
ds_read_b128 v[72:75], v45 offset:1024
ds_read_b128 v[80:83], v45 offset:2048
ds_read_b128 v[88:91], v45 offset:3072
ds_read_b128 v[96:99], v45 offset:4096
ds_read_b128 v[104:107], v45 offset:5120
ds_read_b128 v[112:115], v45 offset:6144
ds_read_b128 v[120:123], v45 offset:7168
ds_read_b128 v[128:131], v45 offset:8192
ds_read_b128 v[136:139], v45 offset:9216
ds_read_b128 v[144:147], v45 offset:10240
ds_read_b128 v[152:155], v45 offset:11264
s_lshl_b32 s43, s48, 1
s_add_u32 s43, s43, 0
s_mul_i32 s43, s43, 6
s_mul_i32 s51, s37, 3
s_add_u32 s43, s43, s51
s_lshl_b32 s43, s43, 7
s_lshl_b32 s51, s47, 2
s_add_u32 s43, s43, s51
s_lshl_b32 s51, s38, 1
s_add_u32 s43, s43, s51
s_lshl_b32 s43, s43, 10
s_waitcnt lgkmcnt(0)
v_add_f32 v40, v40, v28
v_add_f32 v41, v41, v32
v_add_f32 v42, v42, v36
v_rcp_f32 v52, v40
v_rcp_f32 v54, v41
v_rcp_f32 v56, v42
v_pk_add_f32 v[64:65], v[64:65], v[68:69]
v_pk_add_f32 v[66:67], v[66:67], v[70:71]
v_pk_add_f32 v[72:73], v[72:73], v[76:77]
v_pk_add_f32 v[74:75], v[74:75], v[78:79]
v_pk_add_f32 v[80:81], v[80:81], v[84:85]
v_pk_add_f32 v[82:83], v[82:83], v[86:87]
v_pk_add_f32 v[88:89], v[88:89], v[92:93]
v_pk_add_f32 v[90:91], v[90:91], v[94:95]
v_pk_add_f32 v[96:97], v[96:97], v[100:101]
v_pk_add_f32 v[98:99], v[98:99], v[102:103]
v_pk_add_f32 v[104:105], v[104:105], v[108:109]
v_pk_add_f32 v[106:107], v[106:107], v[110:111]
v_pk_add_f32 v[112:113], v[112:113], v[116:117]
v_pk_add_f32 v[114:115], v[114:115], v[118:119]
v_pk_add_f32 v[120:121], v[120:121], v[124:125]
v_pk_add_f32 v[122:123], v[122:123], v[126:127]
v_pk_add_f32 v[128:129], v[128:129], v[132:133]
v_pk_add_f32 v[130:131], v[130:131], v[134:135]
v_pk_add_f32 v[136:137], v[136:137], v[140:141]
v_pk_add_f32 v[138:139], v[138:139], v[142:143]
v_pk_add_f32 v[144:145], v[144:145], v[148:149]
v_pk_add_f32 v[146:147], v[146:147], v[150:151]
v_pk_add_f32 v[152:153], v[152:153], v[156:157]
v_pk_add_f32 v[154:155], v[154:155], v[158:159]
v_pk_mul_f32 v[64:65], v[64:65], v[52:53] op_sel_hi:[1,0]
v_pk_mul_f32 v[66:67], v[66:67], v[52:53] op_sel_hi:[1,0]
v_pk_mul_f32 v[72:73], v[72:73], v[54:55] op_sel_hi:[1,0]
v_pk_mul_f32 v[74:75], v[74:75], v[54:55] op_sel_hi:[1,0]
v_pk_mul_f32 v[80:81], v[80:81], v[56:57] op_sel_hi:[1,0]
v_pk_mul_f32 v[82:83], v[82:83], v[56:57] op_sel_hi:[1,0]
v_pk_mul_f32 v[88:89], v[88:89], v[52:53] op_sel_hi:[1,0]
v_pk_mul_f32 v[90:91], v[90:91], v[52:53] op_sel_hi:[1,0]
v_pk_mul_f32 v[96:97], v[96:97], v[54:55] op_sel_hi:[1,0]
v_pk_mul_f32 v[98:99], v[98:99], v[54:55] op_sel_hi:[1,0]
v_pk_mul_f32 v[104:105], v[104:105], v[56:57] op_sel_hi:[1,0]
v_pk_mul_f32 v[106:107], v[106:107], v[56:57] op_sel_hi:[1,0]
v_pk_mul_f32 v[112:113], v[112:113], v[52:53] op_sel_hi:[1,0]
v_pk_mul_f32 v[114:115], v[114:115], v[52:53] op_sel_hi:[1,0]
v_pk_mul_f32 v[120:121], v[120:121], v[54:55] op_sel_hi:[1,0]
v_pk_mul_f32 v[122:123], v[122:123], v[54:55] op_sel_hi:[1,0]
v_pk_mul_f32 v[128:129], v[128:129], v[56:57] op_sel_hi:[1,0]
v_pk_mul_f32 v[130:131], v[130:131], v[56:57] op_sel_hi:[1,0]
v_pk_mul_f32 v[136:137], v[136:137], v[52:53] op_sel_hi:[1,0]
v_pk_mul_f32 v[138:139], v[138:139], v[52:53] op_sel_hi:[1,0]
v_pk_mul_f32 v[144:145], v[144:145], v[54:55] op_sel_hi:[1,0]
v_pk_mul_f32 v[146:147], v[146:147], v[54:55] op_sel_hi:[1,0]
v_pk_mul_f32 v[152:153], v[152:153], v[56:57] op_sel_hi:[1,0]
v_pk_mul_f32 v[154:155], v[154:155], v[56:57] op_sel_hi:[1,0]
v_cvt_pk_bf16_f32 v160, v64, v65
v_cvt_pk_bf16_f32 v161, v66, v67
v_cvt_pk_bf16_f32 v162, v88, v89
v_cvt_pk_bf16_f32 v163, v90, v91
v_cvt_pk_bf16_f32 v164, v112, v113
v_cvt_pk_bf16_f32 v165, v114, v115
v_cvt_pk_bf16_f32 v166, v136, v137
v_cvt_pk_bf16_f32 v167, v138, v139
v_cvt_pk_bf16_f32 v168, v72, v73
v_cvt_pk_bf16_f32 v169, v74, v75
v_cvt_pk_bf16_f32 v170, v96, v97
v_cvt_pk_bf16_f32 v171, v98, v99
v_cvt_pk_bf16_f32 v172, v120, v121
v_cvt_pk_bf16_f32 v173, v122, v123
v_cvt_pk_bf16_f32 v174, v144, v145
v_cvt_pk_bf16_f32 v175, v146, v147
v_cvt_pk_bf16_f32 v176, v80, v81
v_cvt_pk_bf16_f32 v177, v82, v83
v_cvt_pk_bf16_f32 v178, v104, v105
v_cvt_pk_bf16_f32 v179, v106, v107
v_cvt_pk_bf16_f32 v180, v128, v129
v_cvt_pk_bf16_f32 v181, v130, v131
v_cvt_pk_bf16_f32 v182, v152, v153
v_cvt_pk_bf16_f32 v183, v154, v155
v_accvgpr_write_b32 a184, v160
v_accvgpr_write_b32 a185, v161
v_accvgpr_write_b32 a186, v162
v_accvgpr_write_b32 a187, v163
v_accvgpr_write_b32 a188, v164
v_accvgpr_write_b32 a189, v165
v_accvgpr_write_b32 a190, v166
v_accvgpr_write_b32 a191, v167
v_accvgpr_write_b32 a192, v168
v_accvgpr_write_b32 a193, v169
v_accvgpr_write_b32 a194, v170
v_accvgpr_write_b32 a195, v171
v_accvgpr_write_b32 a196, v172
v_accvgpr_write_b32 a197, v173
v_accvgpr_write_b32 a198, v174
v_accvgpr_write_b32 a199, v175
v_accvgpr_write_b32 a200, v176
v_accvgpr_write_b32 a201, v177
v_accvgpr_write_b32 a202, v178
v_accvgpr_write_b32 a203, v179
v_accvgpr_write_b32 a204, v180
v_accvgpr_write_b32 a205, v181
v_accvgpr_write_b32 a206, v182
v_accvgpr_write_b32 a207, v183
v_accvgpr_read_b32 v58, a180
s_nop 1
v_readfirstlane_b32 s78, v58
s_nop 3
s_cmp_lg_u32 s36, 0
s_cbranch_scc1 L_nz_done
s_cmp_lg_u32 s78, 0
s_cbranch_scc1 L_nz_done
s_mov_b32 s43, 0
v_mov_b32 v57, 0
L_nz_loop:
buffer_load_dword v58, v57, s[80:83], 0 offen sc1
s_waitcnt vmcnt(0)
v_readfirstlane_b32 s78, v58
s_add_u32 s43, s43, 1
s_cmp_lg_u32 s78, 0
s_cbranch_scc1 L_nz_done
s_cmp_lt_u32 s43, 0x20000
s_cbranch_scc1 L_nz_loop
L_nz_done:
s_waitcnt vmcnt(16)
s_barrier
s_mov_b32 s45, 4276224
s_add_u32 m0, s39, 0
s_nop 0
buffer_load_dwordx4 v4, s[20:23], s45 offen offset:0 nt lds
buffer_load_dwordx4 v5, s[20:23], s45 offen offset:1024 nt lds
buffer_load_dwordx4 v6, s[20:23], s45 offen offset:2048 nt lds
buffer_load_dwordx4 v7, s[20:23], s45 offen offset:3072 nt lds
s_mov_b32 s45, 4292608
s_add_u32 m0, s39, 16384
s_nop 0
buffer_load_dwordx4 v4, s[20:23], s45 offen offset:0 nt lds
buffer_load_dwordx4 v5, s[20:23], s45 offen offset:1024 nt lds
buffer_load_dwordx4 v6, s[20:23], s45 offen offset:2048 nt lds
buffer_load_dwordx4 v7, s[20:23], s45 offen offset:3072 nt lds
v_add_u32 v13, 32768, v10
v_xor_b32 v14, 64, v13
v_xor_b32 v15, 128, v13
v_xor_b32 v16, 192, v13
ds_read_b128 a[96:99], v13
ds_read_b128 a[100:103], v14
ds_read_b128 a[104:107], v15
ds_read_b128 a[108:111], v16
s_waitcnt lgkmcnt(0)
v_mfma_f32_16x16x32_bf16 v[64:67], a[96:99], a[48:51], 0
v_add_u32 v13, 36864, v10
v_mfma_f32_16x16x32_bf16 v[72:75], a[96:99], a[64:67], 0
v_xor_b32 v14, 64, v13
v_xor_b32 v15, 128, v13
v_mfma_f32_16x16x32_bf16 v[80:83], a[96:99], a[80:83], 0
v_xor_b32 v16, 192, v13
v_mfma_f32_16x16x32_bf16 v[64:67], a[100:103], a[52:55], v[64:67]
ds_read_b128 a[112:115], v13
v_mfma_f32_16x16x32_bf16 v[72:75], a[100:103], a[68:71], v[72:75]
ds_read_b128 a[116:119], v14
ds_read_b128 a[120:123], v15
v_mfma_f32_16x16x32_bf16 v[80:83], a[100:103], a[84:87], v[80:83]
ds_read_b128 a[124:127], v16
v_mfma_f32_16x16x32_bf16 v[64:67], a[104:107], a[56:59], v[64:67]
v_mfma_f32_16x16x32_bf16 v[72:75], a[104:107], a[72:75], v[72:75]
v_mfma_f32_16x16x32_bf16 v[80:83], a[104:107], a[88:91], v[80:83]
v_mfma_f32_16x16x32_bf16 v[64:67], a[108:111], a[60:63], v[64:67]
v_mfma_f32_16x16x32_bf16 v[72:75], a[108:111], a[76:79], v[72:75]
v_mfma_f32_16x16x32_bf16 v[80:83], a[108:111], a[92:95], v[80:83]
s_waitcnt lgkmcnt(0)
s_waitcnt vmcnt(20)
s_barrier
s_mov_b32 s45, 4308992
s_add_u32 m0, s39, 32768
s_nop 0
buffer_load_dwordx4 v4, s[20:23], s45 offen offset:0 nt lds
buffer_load_dwordx4 v5, s[20:23], s45 offen offset:1024 nt lds
buffer_load_dwordx4 v6, s[20:23], s45 offen offset:2048 nt lds
v_mfma_f32_16x16x32_bf16 v[68:71], a[112:115], a[48:51], 0
v_add_u32 v13, 49152, v10
v_mfma_f32_16x16x32_bf16 v[76:79], a[112:115], a[64:67], 0
v_mfma_f32_16x16x32_bf16 v[84:87], a[112:115], a[80:83], 0
v_xor_b32 v14, 64, v13
v_mfma_f32_16x16x32_bf16 v[68:71], a[116:119], a[52:55], v[68:71]
v_xor_b32 v15, 128, v13
v_mfma_f32_16x16x32_bf16 v[76:79], a[116:119], a[68:71], v[76:79]
v_mfma_f32_16x16x32_bf16 v[84:87], a[116:119], a[84:87], v[84:87]
v_xor_b32 v16, 192, v13
v_mfma_f32_16x16x32_bf16 v[68:71], a[120:123], a[56:59], v[68:71]
ds_read_b128 a[96:99], v13
v_mfma_f32_16x16x32_bf16 v[76:79], a[120:123], a[72:75], v[76:79]
v_mfma_f32_16x16x32_bf16 v[84:87], a[120:123], a[88:91], v[84:87]
ds_read_b128 a[100:103], v14
v_mfma_f32_16x16x32_bf16 v[68:71], a[124:127], a[60:63], v[68:71]
ds_read_b128 a[104:107], v15
v_mfma_f32_16x16x32_bf16 v[76:79], a[124:127], a[76:79], v[76:79]
v_mfma_f32_16x16x32_bf16 v[84:87], a[124:127], a[92:95], v[84:87]
ds_read_b128 a[108:111], v16
buffer_load_dwordx4 v7, s[20:23], s45 offen offset:3072 nt lds
s_waitcnt lgkmcnt(0)
v_mfma_f32_16x16x32_bf16 v[88:91], a[96:99], a[48:51], 0
v_add_u32 v13, 53248, v10
v_mfma_f32_16x16x32_bf16 v[96:99], a[96:99], a[64:67], 0
v_xor_b32 v14, 64, v13
v_xor_b32 v15, 128, v13
v_mfma_f32_16x16x32_bf16 v[104:107], a[96:99], a[80:83], 0
v_xor_b32 v16, 192, v13
v_mfma_f32_16x16x32_bf16 v[88:91], a[100:103], a[52:55], v[88:91]
ds_read_b128 a[112:115], v13
v_mfma_f32_16x16x32_bf16 v[96:99], a[100:103], a[68:71], v[96:99]
ds_read_b128 a[116:119], v14
ds_read_b128 a[120:123], v15
v_mfma_f32_16x16x32_bf16 v[104:107], a[100:103], a[84:87], v[104:107]
ds_read_b128 a[124:127], v16
v_mfma_f32_16x16x32_bf16 v[88:91], a[104:107], a[56:59], v[88:91]
v_mfma_f32_16x16x32_bf16 v[96:99], a[104:107], a[72:75], v[96:99]
v_mfma_f32_16x16x32_bf16 v[104:107], a[104:107], a[88:91], v[104:107]
v_mfma_f32_16x16x32_bf16 v[88:91], a[108:111], a[60:63], v[88:91]
v_mfma_f32_16x16x32_bf16 v[96:99], a[108:111], a[76:79], v[96:99]
v_mfma_f32_16x16x32_bf16 v[104:107], a[108:111], a[92:95], v[104:107]
s_waitcnt lgkmcnt(0)
s_waitcnt vmcnt(20)
s_barrier
s_mov_b32 s45, 4194304
s_add_u32 m0, s39, 49152
s_nop 0
buffer_load_dwordx4 v8, s[24:27], s45 offen offset:0 nt lds
v_mfma_f32_16x16x32_bf16 v[92:95], a[112:115], a[48:51], 0
v_add_u32 v13, 65536, v10
v_xor_b32 v14, 64, v13
v_mfma_f32_16x16x32_bf16 v[100:103], a[112:115], a[64:67], 0
v_xor_b32 v15, 128, v13
v_mfma_f32_16x16x32_bf16 v[108:111], a[112:115], a[80:83], 0
v_xor_b32 v16, 192, v13
ds_read_b128 a[96:99], v13
v_mfma_f32_16x16x32_bf16 v[92:95], a[116:119], a[52:55], v[92:95]
ds_read_b128 a[100:103], v14
ds_read_b128 a[104:107], v15
v_mfma_f32_16x16x32_bf16 v[100:103], a[116:119], a[68:71], v[100:103]
buffer_load_dwordx4 v9, s[24:27], s45 offen offset:1024 nt lds
ds_read_b128 a[108:111], v16
v_mfma_f32_16x16x32_bf16 v[108:111], a[116:119], a[84:87], v[108:111]
v_max3_f32 v21, v64, v65, v66
v_max3_f32 v22, v72, v73, v74
v_mfma_f32_16x16x32_bf16 v[92:95], a[120:123], a[56:59], v[92:95]
v_max3_f32 v23, v80, v81, v82
v_max3_f32 v21, v21, v67, v68
v_mfma_f32_16x16x32_bf16 v[100:103], a[120:123], a[72:75], v[100:103]
v_max3_f32 v22, v22, v75, v76
v_mfma_f32_16x16x32_bf16 v[108:111], a[120:123], a[88:91], v[108:111]
v_max3_f32 v23, v23, v83, v84
v_max3_f32 v21, v21, v69, v70
v_mfma_f32_16x16x32_bf16 v[92:95], a[124:127], a[60:63], v[92:95]
v_max3_f32 v22, v22, v77, v78
v_max3_f32 v23, v23, v85, v86
v_mfma_f32_16x16x32_bf16 v[100:103], a[124:127], a[76:79], v[100:103]
v_max_f32 v21, v21, v71
v_mfma_f32_16x16x32_bf16 v[108:111], a[124:127], a[92:95], v[108:111]
v_max_f32 v22, v22, v79
v_max_f32 v23, v23, v87
s_waitcnt lgkmcnt(0)
v_mfma_f32_16x16x32_bf16 v[112:115], a[96:99], a[48:51], 0
v_add_u32 v13, 69632, v10
v_mfma_f32_16x16x32_bf16 v[120:123], a[96:99], a[64:67], 0
buffer_load_dwordx4 v8, s[24:27], s45 offen offset:2048 nt lds
v_xor_b32 v14, 64, v13
v_xor_b32 v15, 128, v13
v_mfma_f32_16x16x32_bf16 v[128:131], a[96:99], a[80:83], 0
v_xor_b32 v16, 192, v13
v_mfma_f32_16x16x32_bf16 v[112:115], a[100:103], a[52:55], v[112:115]
ds_read_b128 a[112:115], v13
v_mfma_f32_16x16x32_bf16 v[120:123], a[100:103], a[68:71], v[120:123]
ds_read_b128 a[116:119], v14
ds_read_b128 a[120:123], v15
v_mfma_f32_16x16x32_bf16 v[128:131], a[100:103], a[84:87], v[128:131]
ds_read_b128 a[124:127], v16
v_mfma_f32_16x16x32_bf16 v[112:115], a[104:107], a[56:59], v[112:115]
v_mfma_f32_16x16x32_bf16 v[120:123], a[104:107], a[72:75], v[120:123]
v_mfma_f32_16x16x32_bf16 v[128:131], a[104:107], a[88:91], v[128:131]
v_mfma_f32_16x16x32_bf16 v[112:115], a[108:111], a[60:63], v[112:115]
v_mfma_f32_16x16x32_bf16 v[120:123], a[108:111], a[76:79], v[120:123]
v_mfma_f32_16x16x32_bf16 v[128:131], a[108:111], a[92:95], v[128:131]
s_waitcnt lgkmcnt(0)
buffer_load_dwordx4 v9, s[24:27], s45 offen offset:3072 nt lds
s_waitcnt vmcnt(20)
s_barrier
v_mfma_f32_16x16x32_bf16 v[116:119], a[112:115], a[48:51], 0
v_add_u32 v13, 81920, v10
v_xor_b32 v14, 64, v13
v_mfma_f32_16x16x32_bf16 v[124:127], a[112:115], a[64:67], 0
v_xor_b32 v15, 128, v13
v_mfma_f32_16x16x32_bf16 v[132:135], a[112:115], a[80:83], 0
v_xor_b32 v16, 192, v13
ds_read_b128 a[96:99], v13
v_mfma_f32_16x16x32_bf16 v[116:119], a[116:119], a[52:55], v[116:119]
ds_read_b128 a[100:103], v14
ds_read_b128 a[104:107], v15
v_mfma_f32_16x16x32_bf16 v[124:127], a[116:119], a[68:71], v[124:127]
ds_read_b128 a[108:111], v16
v_mfma_f32_16x16x32_bf16 v[132:135], a[116:119], a[84:87], v[132:135]
v_max3_f32 v21, v21, v88, v89
v_max3_f32 v22, v22, v96, v97
v_mfma_f32_16x16x32_bf16 v[116:119], a[120:123], a[56:59], v[116:119]
v_max3_f32 v23, v23, v104, v105
v_max3_f32 v21, v21, v90, v91
v_mfma_f32_16x16x32_bf16 v[124:127], a[120:123], a[72:75], v[124:127]
s_mov_b32 s45, 4210688
s_add_u32 m0, s39, 65536
s_nop 0
buffer_load_dwordx4 v8, s[24:27], s45 offen offset:0 nt lds
v_max3_f32 v22, v22, v98, v99
v_mfma_f32_16x16x32_bf16 v[132:135], a[120:123], a[88:91], v[132:135]
v_max3_f32 v23, v23, v106, v107
v_max3_f32 v21, v21, v92, v93
v_mfma_f32_16x16x32_bf16 v[116:119], a[124:127], a[60:63], v[116:119]
v_max3_f32 v22, v22, v100, v101
v_max3_f32 v23, v23, v108, v109
v_mfma_f32_16x16x32_bf16 v[124:127], a[124:127], a[76:79], v[124:127]
v_max3_f32 v21, v21, v94, v95
v_mfma_f32_16x16x32_bf16 v[132:135], a[124:127], a[92:95], v[132:135]
v_max3_f32 v22, v22, v102, v103
v_max3_f32 v23, v23, v110, v111
s_waitcnt lgkmcnt(0)
v_mfma_f32_16x16x32_bf16 v[136:139], a[96:99], a[48:51], 0
v_add_u32 v13, 86016, v10
v_mfma_f32_16x16x32_bf16 v[144:147], a[96:99], a[64:67], 0
v_xor_b32 v14, 64, v13
v_xor_b32 v15, 128, v13
v_mfma_f32_16x16x32_bf16 v[152:155], a[96:99], a[80:83], 0
v_xor_b32 v16, 192, v13
v_mfma_f32_16x16x32_bf16 v[136:139], a[100:103], a[52:55], v[136:139]
ds_read_b128 a[112:115], v13
buffer_load_dwordx4 v9, s[24:27], s45 offen offset:1024 nt lds
v_mfma_f32_16x16x32_bf16 v[144:147], a[100:103], a[68:71], v[144:147]
ds_read_b128 a[116:119], v14
ds_read_b128 a[120:123], v15
v_mfma_f32_16x16x32_bf16 v[152:155], a[100:103], a[84:87], v[152:155]
ds_read_b128 a[124:127], v16
v_mfma_f32_16x16x32_bf16 v[136:139], a[104:107], a[56:59], v[136:139]
v_mfma_f32_16x16x32_bf16 v[144:147], a[104:107], a[72:75], v[144:147]
v_mfma_f32_16x16x32_bf16 v[152:155], a[104:107], a[88:91], v[152:155]
v_mfma_f32_16x16x32_bf16 v[136:139], a[108:111], a[60:63], v[136:139]
v_mfma_f32_16x16x32_bf16 v[144:147], a[108:111], a[76:79], v[144:147]
v_mfma_f32_16x16x32_bf16 v[152:155], a[108:111], a[92:95], v[152:155]
s_waitcnt lgkmcnt(0)
s_waitcnt vmcnt(18)
s_barrier
v_mfma_f32_16x16x32_bf16 v[140:143], a[112:115], a[48:51], 0
buffer_load_dwordx4 v8, s[24:27], s45 offen offset:2048 nt lds
v_add_u32 v13, 98304, v10
v_xor_b32 v14, 64, v13
v_mfma_f32_16x16x32_bf16 v[148:151], a[112:115], a[64:67], 0
v_xor_b32 v15, 128, v13
v_mfma_f32_16x16x32_bf16 v[156:159], a[112:115], a[80:83], 0
v_xor_b32 v16, 192, v13
ds_read_b128 a[96:99], v13
v_mfma_f32_16x16x32_bf16 v[140:143], a[116:119], a[52:55], v[140:143]
ds_read_b128 a[100:103], v14
ds_read_b128 a[104:107], v15
v_mfma_f32_16x16x32_bf16 v[148:151], a[116:119], a[68:71], v[148:151]
ds_read_b128 a[108:111], v16
v_mfma_f32_16x16x32_bf16 v[156:159], a[116:119], a[84:87], v[156:159]
v_max3_f32 v21, v21, v112, v113
v_max3_f32 v22, v22, v120, v121
v_mfma_f32_16x16x32_bf16 v[140:143], a[120:123], a[56:59], v[140:143]
v_max3_f32 v23, v23, v128, v129
v_max3_f32 v21, v21, v114, v115
v_mfma_f32_16x16x32_bf16 v[148:151], a[120:123], a[72:75], v[148:151]
v_max3_f32 v22, v22, v122, v123
v_mfma_f32_16x16x32_bf16 v[156:159], a[120:123], a[88:91], v[156:159]
v_max3_f32 v23, v23, v130, v131
v_max3_f32 v21, v21, v116, v117
v_mfma_f32_16x16x32_bf16 v[140:143], a[124:127], a[60:63], v[140:143]
v_max3_f32 v22, v22, v124, v125
v_max3_f32 v23, v23, v132, v133
v_mfma_f32_16x16x32_bf16 v[148:151], a[124:127], a[76:79], v[148:151]
buffer_load_dwordx4 v9, s[24:27], s45 offen offset:3072 nt lds
v_max3_f32 v21, v21, v118, v119
v_mfma_f32_16x16x32_bf16 v[156:159], a[124:127], a[92:95], v[156:159]
v_max3_f32 v22, v22, v126, v127
v_max3_f32 v23, v23, v134, v135
s_waitcnt lgkmcnt(0)
v_mfma_f32_16x16x32_bf16 v[160:163], a[96:99], a[48:51], 0
v_add_u32 v13, 102400, v10
v_mfma_f32_16x16x32_bf16 v[168:171], a[96:99], a[64:67], 0
v_xor_b32 v14, 64, v13
v_xor_b32 v15, 128, v13
v_mfma_f32_16x16x32_bf16 v[176:179], a[96:99], a[80:83], 0
v_xor_b32 v16, 192, v13
v_mfma_f32_16x16x32_bf16 v[160:163], a[100:103], a[52:55], v[160:163]
ds_read_b128 a[112:115], v13
v_mfma_f32_16x16x32_bf16 v[168:171], a[100:103], a[68:71], v[168:171]
ds_read_b128 a[116:119], v14
ds_read_b128 a[120:123], v15
v_mfma_f32_16x16x32_bf16 v[176:179], a[100:103], a[84:87], v[176:179]
ds_read_b128 a[124:127], v16
v_mfma_f32_16x16x32_bf16 v[160:163], a[104:107], a[56:59], v[160:163]
v_mfma_f32_16x16x32_bf16 v[168:171], a[104:107], a[72:75], v[168:171]
s_mov_b32 s45, 4227072
s_add_u32 m0, s39, 81920
s_nop 0
buffer_load_dwordx4 v8, s[24:27], s45 offen offset:0 nt lds
v_mfma_f32_16x16x32_bf16 v[176:179], a[104:107], a[88:91], v[176:179]
v_mfma_f32_16x16x32_bf16 v[160:163], a[108:111], a[60:63], v[160:163]
v_mfma_f32_16x16x32_bf16 v[168:171], a[108:111], a[76:79], v[168:171]
v_mfma_f32_16x16x32_bf16 v[176:179], a[108:111], a[92:95], v[176:179]
s_waitcnt lgkmcnt(0)
s_waitcnt vmcnt(17)
s_barrier
v_mfma_f32_16x16x32_bf16 v[164:167], a[112:115], a[48:51], 0
v_add_u32 v13, 0, v10
v_xor_b32 v14, 64, v13
v_mfma_f32_16x16x32_bf16 v[172:175], a[112:115], a[64:67], 0
v_xor_b32 v15, 128, v13
v_mfma_f32_16x16x32_bf16 v[180:183], a[112:115], a[80:83], 0
v_xor_b32 v16, 192, v13
ds_read_b128 a[96:99], v13
buffer_load_dwordx4 v9, s[24:27], s45 offen offset:1024 nt lds
v_mfma_f32_16x16x32_bf16 v[164:167], a[116:119], a[52:55], v[164:167]
ds_read_b128 a[100:103], v14
ds_read_b128 a[104:107], v15
v_mfma_f32_16x16x32_bf16 v[172:175], a[116:119], a[68:71], v[172:175]
ds_read_b128 a[108:111], v16
v_mfma_f32_16x16x32_bf16 v[180:183], a[116:119], a[84:87], v[180:183]
v_max3_f32 v21, v21, v136, v137
v_max3_f32 v22, v22, v144, v145
v_mfma_f32_16x16x32_bf16 v[164:167], a[120:123], a[56:59], v[164:167]
v_max3_f32 v23, v23, v152, v153
v_max3_f32 v21, v21, v138, v139
v_mfma_f32_16x16x32_bf16 v[172:175], a[120:123], a[72:75], v[172:175]
v_max3_f32 v22, v22, v146, v147
v_mfma_f32_16x16x32_bf16 v[180:183], a[120:123], a[88:91], v[180:183]
v_max3_f32 v23, v23, v154, v155
v_max3_f32 v21, v21, v140, v141
v_mfma_f32_16x16x32_bf16 v[164:167], a[124:127], a[60:63], v[164:167]
v_max3_f32 v22, v22, v148, v149
v_max3_f32 v23, v23, v156, v157
v_mfma_f32_16x16x32_bf16 v[172:175], a[124:127], a[76:79], v[172:175]
v_max3_f32 v21, v21, v142, v143
v_mfma_f32_16x16x32_bf16 v[180:183], a[124:127], a[92:95], v[180:183]
v_max3_f32 v22, v22, v150, v151
v_max3_f32 v23, v23, v158, v159
s_waitcnt lgkmcnt(0)
buffer_load_dwordx4 v8, s[24:27], s45 offen offset:2048 nt lds
v_mfma_f32_16x16x32_bf16 v[184:187], a[96:99], a[48:51], 0
v_add_u32 v13, 4096, v10
v_mfma_f32_16x16x32_bf16 v[192:195], a[96:99], a[64:67], 0
v_xor_b32 v14, 64, v13
v_xor_b32 v15, 128, v13
v_mfma_f32_16x16x32_bf16 v[200:203], a[96:99], a[80:83], 0
v_xor_b32 v16, 192, v13
v_mfma_f32_16x16x32_bf16 v[184:187], a[100:103], a[52:55], v[184:187]
ds_read_b128 a[112:115], v13
v_mfma_f32_16x16x32_bf16 v[192:195], a[100:103], a[68:71], v[192:195]
ds_read_b128 a[116:119], v14
ds_read_b128 a[120:123], v15
v_mfma_f32_16x16x32_bf16 v[200:203], a[100:103], a[84:87], v[200:203]
ds_read_b128 a[124:127], v16
v_mfma_f32_16x16x32_bf16 v[184:187], a[104:107], a[56:59], v[184:187]
v_mfma_f32_16x16x32_bf16 v[192:195], a[104:107], a[72:75], v[192:195]
v_mfma_f32_16x16x32_bf16 v[200:203], a[104:107], a[88:91], v[200:203]
v_mfma_f32_16x16x32_bf16 v[184:187], a[108:111], a[60:63], v[184:187]
v_mfma_f32_16x16x32_bf16 v[192:195], a[108:111], a[76:79], v[192:195]
v_mfma_f32_16x16x32_bf16 v[200:203], a[108:111], a[92:95], v[200:203]
buffer_load_dwordx4 v9, s[24:27], s45 offen offset:3072 nt lds
s_waitcnt lgkmcnt(0)
s_waitcnt vmcnt(16)
s_barrier
v_mfma_f32_16x16x32_bf16 v[188:191], a[112:115], a[48:51], 0
v_add_u32 v13, 16384, v10
v_xor_b32 v14, 64, v13
v_mfma_f32_16x16x32_bf16 v[196:199], a[112:115], a[64:67], 0
v_xor_b32 v15, 128, v13
v_mfma_f32_16x16x32_bf16 v[204:207], a[112:115], a[80:83], 0
v_xor_b32 v16, 192, v13
ds_read_b128 a[96:99], v13
v_mfma_f32_16x16x32_bf16 v[188:191], a[116:119], a[52:55], v[188:191]
ds_read_b128 a[100:103], v14
ds_read_b128 a[104:107], v15
v_mfma_f32_16x16x32_bf16 v[196:199], a[116:119], a[68:71], v[196:199]
ds_read_b128 a[108:111], v16
v_mfma_f32_16x16x32_bf16 v[204:207], a[116:119], a[84:87], v[204:207]
v_max3_f32 v21, v21, v160, v161
v_max3_f32 v22, v22, v168, v169
v_mfma_f32_16x16x32_bf16 v[188:191], a[120:123], a[56:59], v[188:191]
s_mov_b32 s45, 4243456
s_add_u32 m0, s39, 98304
s_nop 0
buffer_load_dwordx4 v8, s[24:27], s45 offen offset:0 nt lds
v_max3_f32 v23, v23, v176, v177
v_max3_f32 v21, v21, v162, v163
v_mfma_f32_16x16x32_bf16 v[196:199], a[120:123], a[72:75], v[196:199]
v_max3_f32 v22, v22, v170, v171
v_mfma_f32_16x16x32_bf16 v[204:207], a[120:123], a[88:91], v[204:207]
v_max3_f32 v23, v23, v178, v179
v_max3_f32 v21, v21, v164, v165
v_mfma_f32_16x16x32_bf16 v[188:191], a[124:127], a[60:63], v[188:191]
v_max3_f32 v22, v22, v172, v173
v_max3_f32 v23, v23, v180, v181
v_mfma_f32_16x16x32_bf16 v[196:199], a[124:127], a[76:79], v[196:199]
v_max3_f32 v21, v21, v166, v167
v_mfma_f32_16x16x32_bf16 v[204:207], a[124:127], a[92:95], v[204:207]
v_max3_f32 v22, v22, v174, v175
v_max3_f32 v23, v23, v182, v183
s_waitcnt lgkmcnt(0)
v_mfma_f32_16x16x32_bf16 v[208:211], a[96:99], a[48:51], 0
v_add_u32 v13, 20480, v10
v_mfma_f32_16x16x32_bf16 v[216:219], a[96:99], a[64:67], 0
v_xor_b32 v14, 64, v13
v_xor_b32 v15, 128, v13
v_mfma_f32_16x16x32_bf16 v[224:227], a[96:99], a[80:83], 0
buffer_load_dwordx4 v9, s[24:27], s45 offen offset:1024 nt lds
v_xor_b32 v16, 192, v13
v_mfma_f32_16x16x32_bf16 v[208:211], a[100:103], a[52:55], v[208:211]
ds_read_b128 a[112:115], v13
v_mfma_f32_16x16x32_bf16 v[216:219], a[100:103], a[68:71], v[216:219]
ds_read_b128 a[116:119], v14
ds_read_b128 a[120:123], v15
v_mfma_f32_16x16x32_bf16 v[224:227], a[100:103], a[84:87], v[224:227]
ds_read_b128 a[124:127], v16
v_mfma_f32_16x16x32_bf16 v[208:211], a[104:107], a[56:59], v[208:211]
v_mfma_f32_16x16x32_bf16 v[216:219], a[104:107], a[72:75], v[216:219]
v_mfma_f32_16x16x32_bf16 v[224:227], a[104:107], a[88:91], v[224:227]
v_mfma_f32_16x16x32_bf16 v[208:211], a[108:111], a[60:63], v[208:211]
v_mfma_f32_16x16x32_bf16 v[216:219], a[108:111], a[76:79], v[216:219]
v_mfma_f32_16x16x32_bf16 v[224:227], a[108:111], a[92:95], v[224:227]
s_waitcnt lgkmcnt(0)
s_waitcnt vmcnt(14)
s_barrier
buffer_load_dwordx4 v8, s[24:27], s45 offen offset:2048 nt lds
buffer_load_dwordx4 v9, s[24:27], s45 offen offset:3072 nt lds
v_mfma_f32_16x16x32_bf16 v[212:215], a[112:115], a[48:51], 0
v_add_u32 v13, 32768, v10
v_xor_b32 v14, 64, v13
v_mfma_f32_16x16x32_bf16 v[220:223], a[112:115], a[64:67], 0
v_xor_b32 v15, 128, v13
v_mfma_f32_16x16x32_bf16 v[228:231], a[112:115], a[80:83], 0
v_xor_b32 v16, 192, v13
ds_read_b128 a[96:99], v13
v_mfma_f32_16x16x32_bf16 v[212:215], a[116:119], a[52:55], v[212:215]
ds_read_b128 a[100:103], v14
ds_read_b128 a[104:107], v15
v_mfma_f32_16x16x32_bf16 v[220:223], a[116:119], a[68:71], v[220:223]
ds_read_b128 a[108:111], v16
v_mfma_f32_16x16x32_bf16 v[228:231], a[116:119], a[84:87], v[228:231]
v_max3_f32 v21, v21, v184, v185
v_max3_f32 v22, v22, v192, v193
v_mfma_f32_16x16x32_bf16 v[212:215], a[120:123], a[56:59], v[212:215]
v_max3_f32 v23, v23, v200, v201
v_max3_f32 v21, v21, v186, v187
v_mfma_f32_16x16x32_bf16 v[220:223], a[120:123], a[72:75], v[220:223]
s_mov_b32 s45, 4259840
s_add_u32 m0, s39, 0
s_nop 0
buffer_load_dwordx4 v8, s[24:27], s45 offen offset:0 nt lds
v_max3_f32 v22, v22, v194, v195
v_mfma_f32_16x16x32_bf16 v[228:231], a[120:123], a[88:91], v[228:231]
v_max3_f32 v23, v23, v202, v203
v_max3_f32 v21, v21, v188, v189
v_mfma_f32_16x16x32_bf16 v[212:215], a[124:127], a[60:63], v[212:215]
v_max3_f32 v22, v22, v196, v197
v_max3_f32 v23, v23, v204, v205
v_mfma_f32_16x16x32_bf16 v[220:223], a[124:127], a[76:79], v[220:223]
v_max3_f32 v21, v21, v190, v191
v_mfma_f32_16x16x32_bf16 v[228:231], a[124:127], a[92:95], v[228:231]
v_max3_f32 v22, v22, v198, v199
v_max3_f32 v23, v23, v206, v207
s_waitcnt lgkmcnt(0)
v_mfma_f32_16x16x32_bf16 v[232:235], a[96:99], a[48:51], 0
v_add_u32 v13, 36864, v10
v_mfma_f32_16x16x32_bf16 v[240:243], a[96:99], a[64:67], 0
v_xor_b32 v14, 64, v13
v_xor_b32 v15, 128, v13
v_mfma_f32_16x16x32_bf16 v[248:251], a[96:99], a[80:83], 0
v_xor_b32 v16, 192, v13
v_mfma_f32_16x16x32_bf16 v[232:235], a[100:103], a[52:55], v[232:235]
buffer_load_dwordx4 v9, s[24:27], s45 offen offset:1024 nt lds
ds_read_b128 a[112:115], v13
v_mfma_f32_16x16x32_bf16 v[240:243], a[100:103], a[68:71], v[240:243]
ds_read_b128 a[116:119], v14
ds_read_b128 a[120:123], v15
v_mfma_f32_16x16x32_bf16 v[248:251], a[100:103], a[84:87], v[248:251]
ds_read_b128 a[124:127], v16
v_mfma_f32_16x16x32_bf16 v[232:235], a[104:107], a[56:59], v[232:235]
v_mfma_f32_16x16x32_bf16 v[240:243], a[104:107], a[72:75], v[240:243]
v_mfma_f32_16x16x32_bf16 v[248:251], a[104:107], a[88:91], v[248:251]
v_mfma_f32_16x16x32_bf16 v[232:235], a[108:111], a[60:63], v[232:235]
v_mfma_f32_16x16x32_bf16 v[240:243], a[108:111], a[76:79], v[240:243]
v_mfma_f32_16x16x32_bf16 v[248:251], a[108:111], a[92:95], v[248:251]
s_waitcnt lgkmcnt(0)
s_barrier
v_mfma_f32_16x16x32_bf16 v[236:239], a[112:115], a[48:51], 0
buffer_load_dwordx4 v8, s[24:27], s45 offen offset:2048 nt lds
v_max3_f32 v21, v21, v208, v209
v_mfma_f32_16x16x32_bf16 v[244:247], a[112:115], a[64:67], 0
v_max3_f32 v22, v22, v216, v217
v_mfma_f32_16x16x32_bf16 v[252:255], a[112:115], a[80:83], 0
v_max3_f32 v23, v23, v224, v225
v_mfma_f32_16x16x32_bf16 v[236:239], a[116:119], a[52:55], v[236:239]
v_max3_f32 v21, v21, v210, v211
v_mfma_f32_16x16x32_bf16 v[244:247], a[116:119], a[68:71], v[244:247]
v_max3_f32 v22, v22, v218, v219
v_mfma_f32_16x16x32_bf16 v[252:255], a[116:119], a[84:87], v[252:255]
v_max3_f32 v23, v23, v226, v227
v_mfma_f32_16x16x32_bf16 v[236:239], a[120:123], a[56:59], v[236:239]
v_max3_f32 v21, v21, v212, v213
v_mfma_f32_16x16x32_bf16 v[244:247], a[120:123], a[72:75], v[244:247]
v_max3_f32 v22, v22, v220, v221
v_mfma_f32_16x16x32_bf16 v[252:255], a[120:123], a[88:91], v[252:255]
v_max3_f32 v23, v23, v228, v229
v_mfma_f32_16x16x32_bf16 v[236:239], a[124:127], a[60:63], v[236:239]
v_max3_f32 v21, v21, v214, v215
v_mfma_f32_16x16x32_bf16 v[244:247], a[124:127], a[76:79], v[244:247]
v_max3_f32 v22, v22, v222, v223
v_mfma_f32_16x16x32_bf16 v[252:255], a[124:127], a[92:95], v[252:255]
v_max3_f32 v23, v23, v230, v231
buffer_load_dwordx4 v9, s[24:27], s45 offen offset:3072 nt lds
s_nop 7
s_nop 1
v_max3_f32 v21, v21, v232, v233
v_max3_f32 v22, v22, v240, v241
v_max3_f32 v23, v23, v248, v249
v_max3_f32 v21, v21, v234, v235
v_max3_f32 v22, v22, v242, v243
v_max3_f32 v23, v23, v250, v251
v_max3_f32 v21, v21, v236, v237
v_max3_f32 v22, v22, v244, v245
v_max3_f32 v23, v23, v252, v253
v_max3_f32 v21, v21, v238, v239
v_max3_f32 v22, v22, v246, v247
v_max3_f32 v23, v23, v254, v255
v_mov_b32 v40, v21
v_mov_b32 v41, v22
v_mov_b32 v42, v23
s_nop 1
v_permlane32_swap_b32 v21, v40
v_permlane32_swap_b32 v22, v41
v_permlane32_swap_b32 v23, v42
s_nop 1
v_max_f32 v21, v21, v40
v_max_f32 v22, v22, v41
v_max_f32 v23, v23, v42
v_mov_b32 v40, v21
v_mov_b32 v41, v22
v_mov_b32 v42, v23
s_nop 1
v_permlane16_swap_b32 v21, v40
v_permlane16_swap_b32 v22, v41
v_permlane16_swap_b32 v23, v42
s_nop 1
v_max_f32 v21, v21, v40
v_max_f32 v22, v22, v41
v_max_f32 v23, v23, v42
s_mul_i32 s43, s36, 768
v_lshlrev_b32 v43, 2, v1
v_add_u32 v43, 114688, v43
v_add_u32 v44, s43, v43
ds_write_b32 v44, v21 offset:0
ds_write_b32 v44, v22 offset:256
ds_write_b32 v44, v23 offset:512
s_xor_b32 s43, s36, 2
s_mul_i32 s43, s43, 768
v_add_u32 v45, s43, v43
s_mov_b32 s45, 4276224
s_add_u32 m0, s39, 16384
s_nop 0
buffer_load_dwordx4 v8, s[24:27], s45 offen offset:0 nt lds
s_waitcnt lgkmcnt(0)
s_barrier
ds_read_b32 v40, v45 offset:0
ds_read_b32 v41, v45 offset:256
ds_read_b32 v42, v45 offset:512
s_waitcnt lgkmcnt(0)
v_max_f32 v21, v21, v40
v_max_f32 v22, v22, v41
v_max_f32 v23, v23, v42
v_mul_f32 v46, s40, v21
v_mul_f32 v48, s40, v22
v_mul_f32 v50, s40, v23
s_lshl_b32 s43, s48, 1
s_mul_i32 s43, s43, 6
s_mul_i32 s51, s37, 3
s_add_u32 s43, s43, s51
s_lshl_b32 s43, s43, 7
s_lshl_b32 s51, s47, 2
s_add_u32 s43, s43, s51
s_lshl_b32 s51, s38, 1
s_add_u32 s43, s43, s51
s_lshl_b32 s98, s43, 10
v_pk_fma_f32 v[64:65], v[64:65], s[40:41], v[46:47] op_sel_hi:[1,0,0] neg_lo:[0,0,1] neg_hi:[0,0,1]
v_pk_fma_f32 v[66:67], v[66:67], s[40:41], v[46:47] op_sel_hi:[1,0,0] neg_lo:[0,0,1] neg_hi:[0,0,1]
v_pk_fma_f32 v[68:69], v[68:69], s[40:41], v[46:47] op_sel_hi:[1,0,0] neg_lo:[0,0,1] neg_hi:[0,0,1]
v_pk_fma_f32 v[70:71], v[70:71], s[40:41], v[46:47] op_sel_hi:[1,0,0] neg_lo:[0,0,1] neg_hi:[0,0,1]
v_exp_f32 v64, v64
buffer_load_dwordx4 v9, s[24:27], s45 offen offset:1024 nt lds
v_exp_f32 v65, v65
v_exp_f32 v66, v66
v_exp_f32 v67, v67
v_exp_f32 v68, v68
v_exp_f32 v69, v69
v_exp_f32 v70, v70
v_exp_f32 v71, v71
v_cvt_pk_bf16_f32 v64, v64, v65
v_cvt_pk_bf16_f32 v65, v66, v67
v_cvt_pk_bf16_f32 v66, v68, v69
v_cvt_pk_bf16_f32 v67, v70, v71
v_pk_fma_f32 v[72:73], v[72:73], s[40:41], v[48:49] op_sel_hi:[1,0,0] neg_lo:[0,0,1] neg_hi:[0,0,1]
v_pk_fma_f32 v[74:75], v[74:75], s[40:41], v[48:49] op_sel_hi:[1,0,0] neg_lo:[0,0,1] neg_hi:[0,0,1]
v_pk_fma_f32 v[76:77], v[76:77], s[40:41], v[48:49] op_sel_hi:[1,0,0] neg_lo:[0,0,1] neg_hi:[0,0,1]
v_pk_fma_f32 v[78:79], v[78:79], s[40:41], v[48:49] op_sel_hi:[1,0,0] neg_lo:[0,0,1] neg_hi:[0,0,1]
v_mfma_f32_16x16x32_bf16 v[28:31], a[176:179], v[64:67], 0
v_exp_f32 v72, v72
s_add_u32 s99, s98, 0
buffer_store_dwordx4 a[184:187], v12, s[32:35], s99 offen sc1
v_exp_f32 v73, v73
v_exp_f32 v74, v74
v_exp_f32 v75, v75
v_exp_f32 v76, v76
v_exp_f32 v77, v77
v_exp_f32 v78, v78
v_exp_f32 v79, v79
v_cvt_pk_bf16_f32 v72, v72, v73
v_cvt_pk_bf16_f32 v73, v74, v75
v_cvt_pk_bf16_f32 v74, v76, v77
v_cvt_pk_bf16_f32 v75, v78, v79
v_pk_fma_f32 v[80:81], v[80:81], s[40:41], v[50:51] op_sel_hi:[1,0,0] neg_lo:[0,0,1] neg_hi:[0,0,1]
v_pk_fma_f32 v[82:83], v[82:83], s[40:41], v[50:51] op_sel_hi:[1,0,0] neg_lo:[0,0,1] neg_hi:[0,0,1]
v_pk_fma_f32 v[84:85], v[84:85], s[40:41], v[50:51] op_sel_hi:[1,0,0] neg_lo:[0,0,1] neg_hi:[0,0,1]
v_pk_fma_f32 v[86:87], v[86:87], s[40:41], v[50:51] op_sel_hi:[1,0,0] neg_lo:[0,0,1] neg_hi:[0,0,1]
v_mfma_f32_16x16x32_bf16 v[32:35], a[176:179], v[72:75], 0
buffer_load_dwordx4 v8, s[24:27], s45 offen offset:2048 nt lds
v_exp_f32 v80, v80
v_exp_f32 v81, v81
v_exp_f32 v82, v82
v_exp_f32 v83, v83
v_exp_f32 v84, v84
v_exp_f32 v85, v85
v_exp_f32 v86, v86
v_exp_f32 v87, v87
v_cvt_pk_bf16_f32 v80, v80, v81
v_cvt_pk_bf16_f32 v81, v82, v83
v_cvt_pk_bf16_f32 v82, v84, v85
v_cvt_pk_bf16_f32 v83, v86, v87
v_pk_fma_f32 v[88:89], v[88:89], s[40:41], v[46:47] op_sel_hi:[1,0,0] neg_lo:[0,0,1] neg_hi:[0,0,1]
v_pk_fma_f32 v[90:91], v[90:91], s[40:41], v[46:47] op_sel_hi:[1,0,0] neg_lo:[0,0,1] neg_hi:[0,0,1]
v_pk_fma_f32 v[92:93], v[92:93], s[40:41], v[46:47] op_sel_hi:[1,0,0] neg_lo:[0,0,1] neg_hi:[0,0,1]
v_pk_fma_f32 v[94:95], v[94:95], s[40:41], v[46:47] op_sel_hi:[1,0,0] neg_lo:[0,0,1] neg_hi:[0,0,1]
v_mfma_f32_16x16x32_bf16 v[36:39], a[176:179], v[80:83], 0
v_exp_f32 v88, v88
v_exp_f32 v89, v89
v_exp_f32 v90, v90
v_exp_f32 v91, v91
v_exp_f32 v92, v92
v_exp_f32 v93, v93
v_exp_f32 v94, v94
v_exp_f32 v95, v95
v_cvt_pk_bf16_f32 v88, v88, v89
v_cvt_pk_bf16_f32 v89, v90, v91
v_cvt_pk_bf16_f32 v90, v92, v93
s_add_u32 s99, s98, 1024
buffer_store_dwordx4 a[188:191], v12, s[32:35], s99 offen sc1
v_cvt_pk_bf16_f32 v91, v94, v95
v_pk_fma_f32 v[96:97], v[96:97], s[40:41], v[48:49] op_sel_hi:[1,0,0] neg_lo:[0,0,1] neg_hi:[0,0,1]
v_pk_fma_f32 v[98:99], v[98:99], s[40:41], v[48:49] op_sel_hi:[1,0,0] neg_lo:[0,0,1] neg_hi:[0,0,1]
v_pk_fma_f32 v[100:101], v[100:101], s[40:41], v[48:49] op_sel_hi:[1,0,0] neg_lo:[0,0,1] neg_hi:[0,0,1]
v_pk_fma_f32 v[102:103], v[102:103], s[40:41], v[48:49] op_sel_hi:[1,0,0] neg_lo:[0,0,1] neg_hi:[0,0,1]
v_mfma_f32_16x16x32_bf16 v[28:31], a[176:179], v[88:91], v[28:31]
buffer_load_dwordx4 v9, s[24:27], s45 offen offset:3072 nt lds
v_exp_f32 v96, v96
v_exp_f32 v97, v97
v_exp_f32 v98, v98
v_exp_f32 v99, v99
v_exp_f32 v100, v100
v_exp_f32 v101, v101
v_exp_f32 v102, v102
v_exp_f32 v103, v103
v_cvt_pk_bf16_f32 v96, v96, v97
v_cvt_pk_bf16_f32 v97, v98, v99
v_cvt_pk_bf16_f32 v98, v100, v101
v_cvt_pk_bf16_f32 v99, v102, v103
v_pk_fma_f32 v[104:105], v[104:105], s[40:41], v[50:51] op_sel_hi:[1,0,0] neg_lo:[0,0,1] neg_hi:[0,0,1]
v_pk_fma_f32 v[106:107], v[106:107], s[40:41], v[50:51] op_sel_hi:[1,0,0] neg_lo:[0,0,1] neg_hi:[0,0,1]
v_pk_fma_f32 v[108:109], v[108:109], s[40:41], v[50:51] op_sel_hi:[1,0,0] neg_lo:[0,0,1] neg_hi:[0,0,1]
v_pk_fma_f32 v[110:111], v[110:111], s[40:41], v[50:51] op_sel_hi:[1,0,0] neg_lo:[0,0,1] neg_hi:[0,0,1]
v_mfma_f32_16x16x32_bf16 v[32:35], a[176:179], v[96:99], v[32:35]
v_exp_f32 v104, v104
v_exp_f32 v105, v105
v_exp_f32 v106, v106
v_exp_f32 v107, v107
v_exp_f32 v108, v108
v_exp_f32 v109, v109
v_exp_f32 v110, v110
v_exp_f32 v111, v111
v_cvt_pk_bf16_f32 v104, v104, v105
v_cvt_pk_bf16_f32 v105, v106, v107
v_cvt_pk_bf16_f32 v106, v108, v109
v_cvt_pk_bf16_f32 v107, v110, v111
v_pk_fma_f32 v[112:113], v[112:113], s[40:41], v[46:47] op_sel_hi:[1,0,0] neg_lo:[0,0,1] neg_hi:[0,0,1]
v_pk_fma_f32 v[114:115], v[114:115], s[40:41], v[46:47] op_sel_hi:[1,0,0] neg_lo:[0,0,1] neg_hi:[0,0,1]
v_pk_fma_f32 v[116:117], v[116:117], s[40:41], v[46:47] op_sel_hi:[1,0,0] neg_lo:[0,0,1] neg_hi:[0,0,1]
v_pk_fma_f32 v[118:119], v[118:119], s[40:41], v[46:47] op_sel_hi:[1,0,0] neg_lo:[0,0,1] neg_hi:[0,0,1]
v_mfma_f32_16x16x32_bf16 v[36:39], a[176:179], v[104:107], v[36:39]
s_mov_b32 s45, 4292608
s_add_u32 m0, s39, 32768
s_nop 0
buffer_load_dwordx4 v8, s[24:27], s45 offen offset:0 nt lds
v_exp_f32 v112, v112
s_add_u32 s99, s98, 131072
buffer_store_dwordx4 a[192:195], v12, s[32:35], s99 offen sc1
v_exp_f32 v113, v113
v_exp_f32 v114, v114
v_exp_f32 v115, v115
v_exp_f32 v116, v116
v_exp_f32 v117, v117
v_exp_f32 v118, v118
v_exp_f32 v119, v119
v_cvt_pk_bf16_f32 v112, v112, v113
v_cvt_pk_bf16_f32 v113, v114, v115
v_cvt_pk_bf16_f32 v114, v116, v117
v_cvt_pk_bf16_f32 v115, v118, v119
v_pk_fma_f32 v[120:121], v[120:121], s[40:41], v[48:49] op_sel_hi:[1,0,0] neg_lo:[0,0,1] neg_hi:[0,0,1]
v_pk_fma_f32 v[122:123], v[122:123], s[40:41], v[48:49] op_sel_hi:[1,0,0] neg_lo:[0,0,1] neg_hi:[0,0,1]
v_pk_fma_f32 v[124:125], v[124:125], s[40:41], v[48:49] op_sel_hi:[1,0,0] neg_lo:[0,0,1] neg_hi:[0,0,1]
v_pk_fma_f32 v[126:127], v[126:127], s[40:41], v[48:49] op_sel_hi:[1,0,0] neg_lo:[0,0,1] neg_hi:[0,0,1]
v_mfma_f32_16x16x32_bf16 v[28:31], a[176:179], v[112:115], v[28:31]
v_exp_f32 v120, v120
v_exp_f32 v121, v121
v_exp_f32 v122, v122
v_exp_f32 v123, v123
v_exp_f32 v124, v124
v_exp_f32 v125, v125
v_exp_f32 v126, v126
v_exp_f32 v127, v127
v_cvt_pk_bf16_f32 v120, v120, v121
v_cvt_pk_bf16_f32 v121, v122, v123
v_cvt_pk_bf16_f32 v122, v124, v125
v_cvt_pk_bf16_f32 v123, v126, v127
v_pk_fma_f32 v[128:129], v[128:129], s[40:41], v[50:51] op_sel_hi:[1,0,0] neg_lo:[0,0,1] neg_hi:[0,0,1]
v_pk_fma_f32 v[130:131], v[130:131], s[40:41], v[50:51] op_sel_hi:[1,0,0] neg_lo:[0,0,1] neg_hi:[0,0,1]
buffer_load_dwordx4 v9, s[24:27], s45 offen offset:1024 nt lds
v_pk_fma_f32 v[132:133], v[132:133], s[40:41], v[50:51] op_sel_hi:[1,0,0] neg_lo:[0,0,1] neg_hi:[0,0,1]
v_pk_fma_f32 v[134:135], v[134:135], s[40:41], v[50:51] op_sel_hi:[1,0,0] neg_lo:[0,0,1] neg_hi:[0,0,1]
v_mfma_f32_16x16x32_bf16 v[32:35], a[176:179], v[120:123], v[32:35]
v_exp_f32 v128, v128
v_exp_f32 v129, v129
v_exp_f32 v130, v130
v_exp_f32 v131, v131
v_exp_f32 v132, v132
v_exp_f32 v133, v133
v_exp_f32 v134, v134
v_exp_f32 v135, v135
v_cvt_pk_bf16_f32 v128, v128, v129
v_cvt_pk_bf16_f32 v129, v130, v131
v_cvt_pk_bf16_f32 v130, v132, v133
s_add_u32 s99, s98, 132096
buffer_store_dwordx4 a[196:199], v12, s[32:35], s99 offen sc1
v_cvt_pk_bf16_f32 v131, v134, v135
v_pk_fma_f32 v[136:137], v[136:137], s[40:41], v[46:47] op_sel_hi:[1,0,0] neg_lo:[0,0,1] neg_hi:[0,0,1]
v_pk_fma_f32 v[138:139], v[138:139], s[40:41], v[46:47] op_sel_hi:[1,0,0] neg_lo:[0,0,1] neg_hi:[0,0,1]
v_pk_fma_f32 v[140:141], v[140:141], s[40:41], v[46:47] op_sel_hi:[1,0,0] neg_lo:[0,0,1] neg_hi:[0,0,1]
v_pk_fma_f32 v[142:143], v[142:143], s[40:41], v[46:47] op_sel_hi:[1,0,0] neg_lo:[0,0,1] neg_hi:[0,0,1]
v_mfma_f32_16x16x32_bf16 v[36:39], a[176:179], v[128:131], v[36:39]
v_exp_f32 v136, v136
v_exp_f32 v137, v137
v_exp_f32 v138, v138
v_exp_f32 v139, v139
v_exp_f32 v140, v140
v_exp_f32 v141, v141
v_exp_f32 v142, v142
v_exp_f32 v143, v143
v_cvt_pk_bf16_f32 v136, v136, v137
v_cvt_pk_bf16_f32 v137, v138, v139
v_cvt_pk_bf16_f32 v138, v140, v141
buffer_load_dwordx4 v8, s[24:27], s45 offen offset:2048 nt lds
v_cvt_pk_bf16_f32 v139, v142, v143
v_pk_fma_f32 v[144:145], v[144:145], s[40:41], v[48:49] op_sel_hi:[1,0,0] neg_lo:[0,0,1] neg_hi:[0,0,1]
v_pk_fma_f32 v[146:147], v[146:147], s[40:41], v[48:49] op_sel_hi:[1,0,0] neg_lo:[0,0,1] neg_hi:[0,0,1]
v_pk_fma_f32 v[148:149], v[148:149], s[40:41], v[48:49] op_sel_hi:[1,0,0] neg_lo:[0,0,1] neg_hi:[0,0,1]
v_pk_fma_f32 v[150:151], v[150:151], s[40:41], v[48:49] op_sel_hi:[1,0,0] neg_lo:[0,0,1] neg_hi:[0,0,1]
v_mfma_f32_16x16x32_bf16 v[28:31], a[176:179], v[136:139], v[28:31]
v_exp_f32 v144, v144
v_exp_f32 v145, v145
v_exp_f32 v146, v146
v_exp_f32 v147, v147
v_exp_f32 v148, v148
v_exp_f32 v149, v149
v_exp_f32 v150, v150
v_exp_f32 v151, v151
v_cvt_pk_bf16_f32 v144, v144, v145
v_cvt_pk_bf16_f32 v145, v146, v147
v_cvt_pk_bf16_f32 v146, v148, v149
v_cvt_pk_bf16_f32 v147, v150, v151
v_pk_fma_f32 v[152:153], v[152:153], s[40:41], v[50:51] op_sel_hi:[1,0,0] neg_lo:[0,0,1] neg_hi:[0,0,1]
v_pk_fma_f32 v[154:155], v[154:155], s[40:41], v[50:51] op_sel_hi:[1,0,0] neg_lo:[0,0,1] neg_hi:[0,0,1]
v_pk_fma_f32 v[156:157], v[156:157], s[40:41], v[50:51] op_sel_hi:[1,0,0] neg_lo:[0,0,1] neg_hi:[0,0,1]
v_pk_fma_f32 v[158:159], v[158:159], s[40:41], v[50:51] op_sel_hi:[1,0,0] neg_lo:[0,0,1] neg_hi:[0,0,1]
v_mfma_f32_16x16x32_bf16 v[32:35], a[176:179], v[144:147], v[32:35]
v_exp_f32 v152, v152
v_exp_f32 v153, v153
v_exp_f32 v154, v154
v_exp_f32 v155, v155
v_exp_f32 v156, v156
s_add_u32 s99, s98, 262144
buffer_store_dwordx4 a[200:203], v12, s[32:35], s99 offen sc1
v_exp_f32 v157, v157
v_exp_f32 v158, v158
v_exp_f32 v159, v159
v_cvt_pk_bf16_f32 v152, v152, v153
buffer_load_dwordx4 v9, s[24:27], s45 offen offset:3072 nt lds
v_cvt_pk_bf16_f32 v153, v154, v155
v_cvt_pk_bf16_f32 v154, v156, v157
v_cvt_pk_bf16_f32 v155, v158, v159
v_pk_fma_f32 v[160:161], v[160:161], s[40:41], v[46:47] op_sel_hi:[1,0,0] neg_lo:[0,0,1] neg_hi:[0,0,1]
v_pk_fma_f32 v[162:163], v[162:163], s[40:41], v[46:47] op_sel_hi:[1,0,0] neg_lo:[0,0,1] neg_hi:[0,0,1]
v_pk_fma_f32 v[164:165], v[164:165], s[40:41], v[46:47] op_sel_hi:[1,0,0] neg_lo:[0,0,1] neg_hi:[0,0,1]
v_pk_fma_f32 v[166:167], v[166:167], s[40:41], v[46:47] op_sel_hi:[1,0,0] neg_lo:[0,0,1] neg_hi:[0,0,1]
v_mfma_f32_16x16x32_bf16 v[36:39], a[176:179], v[152:155], v[36:39]
v_exp_f32 v160, v160
v_exp_f32 v161, v161
v_exp_f32 v162, v162
v_exp_f32 v163, v163
v_exp_f32 v164, v164
v_exp_f32 v165, v165
v_exp_f32 v166, v166
v_exp_f32 v167, v167
v_cvt_pk_bf16_f32 v160, v160, v161
v_cvt_pk_bf16_f32 v161, v162, v163
v_cvt_pk_bf16_f32 v162, v164, v165
v_cvt_pk_bf16_f32 v163, v166, v167
v_pk_fma_f32 v[168:169], v[168:169], s[40:41], v[48:49] op_sel_hi:[1,0,0] neg_lo:[0,0,1] neg_hi:[0,0,1]
v_pk_fma_f32 v[170:171], v[170:171], s[40:41], v[48:49] op_sel_hi:[1,0,0] neg_lo:[0,0,1] neg_hi:[0,0,1]
v_pk_fma_f32 v[172:173], v[172:173], s[40:41], v[48:49] op_sel_hi:[1,0,0] neg_lo:[0,0,1] neg_hi:[0,0,1]
v_pk_fma_f32 v[174:175], v[174:175], s[40:41], v[48:49] op_sel_hi:[1,0,0] neg_lo:[0,0,1] neg_hi:[0,0,1]
v_mfma_f32_16x16x32_bf16 v[28:31], a[176:179], v[160:163], v[28:31]
v_exp_f32 v168, v168
v_exp_f32 v169, v169
v_exp_f32 v170, v170
v_exp_f32 v171, v171
v_exp_f32 v172, v172
v_exp_f32 v173, v173
v_exp_f32 v174, v174
v_exp_f32 v175, v175
v_cvt_pk_bf16_f32 v168, v168, v169
v_cvt_pk_bf16_f32 v169, v170, v171
v_cvt_pk_bf16_f32 v170, v172, v173
v_cvt_pk_bf16_f32 v171, v174, v175
v_pk_fma_f32 v[176:177], v[176:177], s[40:41], v[50:51] op_sel_hi:[1,0,0] neg_lo:[0,0,1] neg_hi:[0,0,1]
v_pk_fma_f32 v[178:179], v[178:179], s[40:41], v[50:51] op_sel_hi:[1,0,0] neg_lo:[0,0,1] neg_hi:[0,0,1]
v_pk_fma_f32 v[180:181], v[180:181], s[40:41], v[50:51] op_sel_hi:[1,0,0] neg_lo:[0,0,1] neg_hi:[0,0,1]
v_pk_fma_f32 v[182:183], v[182:183], s[40:41], v[50:51] op_sel_hi:[1,0,0] neg_lo:[0,0,1] neg_hi:[0,0,1]
v_mfma_f32_16x16x32_bf16 v[32:35], a[176:179], v[168:171], v[32:35]
s_add_u32 s99, s98, 263168
buffer_store_dwordx4 a[204:207], v12, s[32:35], s99 offen sc1
v_exp_f32 v176, v176
v_exp_f32 v177, v177
v_exp_f32 v178, v178
v_exp_f32 v179, v179
v_exp_f32 v180, v180
v_exp_f32 v181, v181
v_exp_f32 v182, v182
v_exp_f32 v183, v183
v_cvt_pk_bf16_f32 v176, v176, v177
v_cvt_pk_bf16_f32 v177, v178, v179
v_cvt_pk_bf16_f32 v178, v180, v181
v_cvt_pk_bf16_f32 v179, v182, v183
v_pk_fma_f32 v[184:185], v[184:185], s[40:41], v[46:47] op_sel_hi:[1,0,0] neg_lo:[0,0,1] neg_hi:[0,0,1]
v_pk_fma_f32 v[186:187], v[186:187], s[40:41], v[46:47] op_sel_hi:[1,0,0] neg_lo:[0,0,1] neg_hi:[0,0,1]
v_pk_fma_f32 v[188:189], v[188:189], s[40:41], v[46:47] op_sel_hi:[1,0,0] neg_lo:[0,0,1] neg_hi:[0,0,1]
v_pk_fma_f32 v[190:191], v[190:191], s[40:41], v[46:47] op_sel_hi:[1,0,0] neg_lo:[0,0,1] neg_hi:[0,0,1]
v_mfma_f32_16x16x32_bf16 v[36:39], a[176:179], v[176:179], v[36:39]
v_exp_f32 v184, v184
v_exp_f32 v185, v185
v_exp_f32 v186, v186
v_exp_f32 v187, v187
v_exp_f32 v188, v188
v_exp_f32 v189, v189
v_exp_f32 v190, v190
v_exp_f32 v191, v191
v_cvt_pk_bf16_f32 v184, v184, v185
v_cvt_pk_bf16_f32 v185, v186, v187
v_cvt_pk_bf16_f32 v186, v188, v189
v_cvt_pk_bf16_f32 v187, v190, v191
v_pk_fma_f32 v[192:193], v[192:193], s[40:41], v[48:49] op_sel_hi:[1,0,0] neg_lo:[0,0,1] neg_hi:[0,0,1]
v_pk_fma_f32 v[194:195], v[194:195], s[40:41], v[48:49] op_sel_hi:[1,0,0] neg_lo:[0,0,1] neg_hi:[0,0,1]
v_pk_fma_f32 v[196:197], v[196:197], s[40:41], v[48:49] op_sel_hi:[1,0,0] neg_lo:[0,0,1] neg_hi:[0,0,1]
v_pk_fma_f32 v[198:199], v[198:199], s[40:41], v[48:49] op_sel_hi:[1,0,0] neg_lo:[0,0,1] neg_hi:[0,0,1]
v_mfma_f32_16x16x32_bf16 v[28:31], a[176:179], v[184:187], v[28:31]
v_exp_f32 v192, v192
v_exp_f32 v193, v193
v_exp_f32 v194, v194
v_exp_f32 v195, v195
v_exp_f32 v196, v196
v_exp_f32 v197, v197
v_exp_f32 v198, v198
v_exp_f32 v199, v199
v_cvt_pk_bf16_f32 v192, v192, v193
v_cvt_pk_bf16_f32 v193, v194, v195
v_cvt_pk_bf16_f32 v194, v196, v197
v_cvt_pk_bf16_f32 v195, v198, v199
v_pk_fma_f32 v[200:201], v[200:201], s[40:41], v[50:51] op_sel_hi:[1,0,0] neg_lo:[0,0,1] neg_hi:[0,0,1]
v_pk_fma_f32 v[202:203], v[202:203], s[40:41], v[50:51] op_sel_hi:[1,0,0] neg_lo:[0,0,1] neg_hi:[0,0,1]
v_pk_fma_f32 v[204:205], v[204:205], s[40:41], v[50:51] op_sel_hi:[1,0,0] neg_lo:[0,0,1] neg_hi:[0,0,1]
v_pk_fma_f32 v[206:207], v[206:207], s[40:41], v[50:51] op_sel_hi:[1,0,0] neg_lo:[0,0,1] neg_hi:[0,0,1]
v_mfma_f32_16x16x32_bf16 v[32:35], a[176:179], v[192:195], v[32:35]
v_exp_f32 v200, v200
v_exp_f32 v201, v201
v_exp_f32 v202, v202
v_exp_f32 v203, v203
v_exp_f32 v204, v204
v_exp_f32 v205, v205
v_exp_f32 v206, v206
v_exp_f32 v207, v207
v_cvt_pk_bf16_f32 v200, v200, v201
v_cvt_pk_bf16_f32 v201, v202, v203
v_cvt_pk_bf16_f32 v202, v204, v205
v_cvt_pk_bf16_f32 v203, v206, v207
v_pk_fma_f32 v[208:209], v[208:209], s[40:41], v[46:47] op_sel_hi:[1,0,0] neg_lo:[0,0,1] neg_hi:[0,0,1]
v_pk_fma_f32 v[210:211], v[210:211], s[40:41], v[46:47] op_sel_hi:[1,0,0] neg_lo:[0,0,1] neg_hi:[0,0,1]
v_pk_fma_f32 v[212:213], v[212:213], s[40:41], v[46:47] op_sel_hi:[1,0,0] neg_lo:[0,0,1] neg_hi:[0,0,1]
v_pk_fma_f32 v[214:215], v[214:215], s[40:41], v[46:47] op_sel_hi:[1,0,0] neg_lo:[0,0,1] neg_hi:[0,0,1]
v_mfma_f32_16x16x32_bf16 v[36:39], a[176:179], v[200:203], v[36:39]
v_exp_f32 v208, v208
v_exp_f32 v209, v209
v_exp_f32 v210, v210
v_exp_f32 v211, v211
v_exp_f32 v212, v212
v_exp_f32 v213, v213
v_exp_f32 v214, v214
v_exp_f32 v215, v215
v_cvt_pk_bf16_f32 v208, v208, v209
v_cvt_pk_bf16_f32 v209, v210, v211
v_cvt_pk_bf16_f32 v210, v212, v213
v_cvt_pk_bf16_f32 v211, v214, v215
v_pk_fma_f32 v[216:217], v[216:217], s[40:41], v[48:49] op_sel_hi:[1,0,0] neg_lo:[0,0,1] neg_hi:[0,0,1]
v_pk_fma_f32 v[218:219], v[218:219], s[40:41], v[48:49] op_sel_hi:[1,0,0] neg_lo:[0,0,1] neg_hi:[0,0,1]
v_pk_fma_f32 v[220:221], v[220:221], s[40:41], v[48:49] op_sel_hi:[1,0,0] neg_lo:[0,0,1] neg_hi:[0,0,1]
v_pk_fma_f32 v[222:223], v[222:223], s[40:41], v[48:49] op_sel_hi:[1,0,0] neg_lo:[0,0,1] neg_hi:[0,0,1]
v_mfma_f32_16x16x32_bf16 v[28:31], a[176:179], v[208:211], v[28:31]
v_exp_f32 v216, v216
v_exp_f32 v217, v217
v_exp_f32 v218, v218
v_exp_f32 v219, v219
v_exp_f32 v220, v220
v_exp_f32 v221, v221
v_exp_f32 v222, v222
v_exp_f32 v223, v223
v_cvt_pk_bf16_f32 v216, v216, v217
v_cvt_pk_bf16_f32 v217, v218, v219
v_cvt_pk_bf16_f32 v218, v220, v221
v_cvt_pk_bf16_f32 v219, v222, v223
v_pk_fma_f32 v[224:225], v[224:225], s[40:41], v[50:51] op_sel_hi:[1,0,0] neg_lo:[0,0,1] neg_hi:[0,0,1]
v_pk_fma_f32 v[226:227], v[226:227], s[40:41], v[50:51] op_sel_hi:[1,0,0] neg_lo:[0,0,1] neg_hi:[0,0,1]
v_pk_fma_f32 v[228:229], v[228:229], s[40:41], v[50:51] op_sel_hi:[1,0,0] neg_lo:[0,0,1] neg_hi:[0,0,1]
v_pk_fma_f32 v[230:231], v[230:231], s[40:41], v[50:51] op_sel_hi:[1,0,0] neg_lo:[0,0,1] neg_hi:[0,0,1]
v_mfma_f32_16x16x32_bf16 v[32:35], a[176:179], v[216:219], v[32:35]
v_exp_f32 v224, v224
v_exp_f32 v225, v225
v_exp_f32 v226, v226
v_exp_f32 v227, v227
v_exp_f32 v228, v228
v_exp_f32 v229, v229
v_exp_f32 v230, v230
v_exp_f32 v231, v231
v_cvt_pk_bf16_f32 v224, v224, v225
v_cvt_pk_bf16_f32 v225, v226, v227
v_cvt_pk_bf16_f32 v226, v228, v229
v_cvt_pk_bf16_f32 v227, v230, v231
v_pk_fma_f32 v[232:233], v[232:233], s[40:41], v[46:47] op_sel_hi:[1,0,0] neg_lo:[0,0,1] neg_hi:[0,0,1]
v_pk_fma_f32 v[234:235], v[234:235], s[40:41], v[46:47] op_sel_hi:[1,0,0] neg_lo:[0,0,1] neg_hi:[0,0,1]
v_pk_fma_f32 v[236:237], v[236:237], s[40:41], v[46:47] op_sel_hi:[1,0,0] neg_lo:[0,0,1] neg_hi:[0,0,1]
v_pk_fma_f32 v[238:239], v[238:239], s[40:41], v[46:47] op_sel_hi:[1,0,0] neg_lo:[0,0,1] neg_hi:[0,0,1]
v_mfma_f32_16x16x32_bf16 v[36:39], a[176:179], v[224:227], v[36:39]
v_exp_f32 v232, v232
v_exp_f32 v233, v233
v_exp_f32 v234, v234
v_exp_f32 v235, v235
v_exp_f32 v236, v236
v_exp_f32 v237, v237
v_exp_f32 v238, v238
v_exp_f32 v239, v239
v_cvt_pk_bf16_f32 v232, v232, v233
v_cvt_pk_bf16_f32 v233, v234, v235
v_cvt_pk_bf16_f32 v234, v236, v237
v_cvt_pk_bf16_f32 v235, v238, v239
v_pk_fma_f32 v[240:241], v[240:241], s[40:41], v[48:49] op_sel_hi:[1,0,0] neg_lo:[0,0,1] neg_hi:[0,0,1]
v_pk_fma_f32 v[242:243], v[242:243], s[40:41], v[48:49] op_sel_hi:[1,0,0] neg_lo:[0,0,1] neg_hi:[0,0,1]
v_pk_fma_f32 v[244:245], v[244:245], s[40:41], v[48:49] op_sel_hi:[1,0,0] neg_lo:[0,0,1] neg_hi:[0,0,1]
v_pk_fma_f32 v[246:247], v[246:247], s[40:41], v[48:49] op_sel_hi:[1,0,0] neg_lo:[0,0,1] neg_hi:[0,0,1]
v_mfma_f32_16x16x32_bf16 v[28:31], a[176:179], v[232:235], v[28:31]
v_exp_f32 v240, v240
v_exp_f32 v241, v241
v_exp_f32 v242, v242
v_exp_f32 v243, v243
v_exp_f32 v244, v244
v_exp_f32 v245, v245
v_exp_f32 v246, v246
v_exp_f32 v247, v247
v_cvt_pk_bf16_f32 v240, v240, v241
v_cvt_pk_bf16_f32 v241, v242, v243
v_cvt_pk_bf16_f32 v242, v244, v245
v_cvt_pk_bf16_f32 v243, v246, v247
v_pk_fma_f32 v[248:249], v[248:249], s[40:41], v[50:51] op_sel_hi:[1,0,0] neg_lo:[0,0,1] neg_hi:[0,0,1]
v_pk_fma_f32 v[250:251], v[250:251], s[40:41], v[50:51] op_sel_hi:[1,0,0] neg_lo:[0,0,1] neg_hi:[0,0,1]
v_pk_fma_f32 v[252:253], v[252:253], s[40:41], v[50:51] op_sel_hi:[1,0,0] neg_lo:[0,0,1] neg_hi:[0,0,1]
v_pk_fma_f32 v[254:255], v[254:255], s[40:41], v[50:51] op_sel_hi:[1,0,0] neg_lo:[0,0,1] neg_hi:[0,0,1]
v_mfma_f32_16x16x32_bf16 v[32:35], a[176:179], v[240:243], v[32:35]
v_exp_f32 v248, v248
v_exp_f32 v249, v249
v_exp_f32 v250, v250
v_exp_f32 v251, v251
v_exp_f32 v252, v252
v_exp_f32 v253, v253
v_exp_f32 v254, v254
v_exp_f32 v255, v255
v_cvt_pk_bf16_f32 v248, v248, v249
v_cvt_pk_bf16_f32 v249, v250, v251
v_cvt_pk_bf16_f32 v250, v252, v253
v_cvt_pk_bf16_f32 v251, v254, v255
s_nop 1
v_mfma_f32_16x16x32_bf16 v[36:39], a[176:179], v[248:251], v[36:39]
s_waitcnt vmcnt(30)
s_barrier
v_add_u32 v13, 49152, v11
v_xor_b32 v14, 32, v13
v_xor_b32 v15, 64, v13
v_xor_b32 v16, 96, v13
ds_read_b64_tr_b16 a[96:97], v13
ds_read_b64_tr_b16 a[98:99], v13 offset:4096
ds_read_b64_tr_b16 a[100:101], v14
ds_read_b64_tr_b16 a[102:103], v14 offset:4096
ds_read_b64_tr_b16 a[104:105], v15
ds_read_b64_tr_b16 a[106:107], v15 offset:4096
ds_read_b64_tr_b16 a[108:109], v16
ds_read_b64_tr_b16 a[110:111], v16 offset:4096
s_waitcnt lgkmcnt(0)
v_mfma_f32_16x16x32_bf16 a[128:131], a[96:99], v[64:67], 0
v_add_u32 v13, 49152, v11
v_xor_b32 v13, 128, v13
v_mfma_f32_16x16x32_bf16 a[132:135], a[96:99], v[72:75], 0
v_xor_b32 v14, 32, v13
v_xor_b32 v15, 64, v13
v_mfma_f32_16x16x32_bf16 a[136:139], a[96:99], v[80:83], 0
v_xor_b32 v16, 96, v13
ds_read_b64_tr_b16 a[112:113], v13
v_mfma_f32_16x16x32_bf16 a[140:143], a[100:103], v[64:67], 0
ds_read_b64_tr_b16 a[114:115], v13 offset:4096
ds_read_b64_tr_b16 a[116:117], v14
ds_read_b64_tr_b16 a[118:119], v14 offset:4096
v_mfma_f32_16x16x32_bf16 a[144:147], a[100:103], v[72:75], 0
ds_read_b64_tr_b16 a[120:121], v15
ds_read_b64_tr_b16 a[122:123], v15 offset:4096
v_mfma_f32_16x16x32_bf16 a[148:151], a[100:103], v[80:83], 0
ds_read_b64_tr_b16 a[124:125], v16
ds_read_b64_tr_b16 a[126:127], v16 offset:4096
v_mfma_f32_16x16x32_bf16 a[152:155], a[104:107], v[64:67], 0
v_mfma_f32_16x16x32_bf16 a[156:159], a[104:107], v[72:75], 0
v_mfma_f32_16x16x32_bf16 a[160:163], a[104:107], v[80:83], 0
v_mfma_f32_16x16x32_bf16 a[164:167], a[108:111], v[64:67], 0
v_mfma_f32_16x16x32_bf16 a[168:171], a[108:111], v[72:75], 0
v_mfma_f32_16x16x32_bf16 a[172:175], a[108:111], v[80:83], 0
s_waitcnt lgkmcnt(0)
s_waitcnt vmcnt(26)
s_barrier
s_mov_b32 s45, 4308992
s_add_u32 m0, s39, 49152
s_nop 0
buffer_load_dwordx4 v8, s[24:27], s45 offen offset:0 nt lds
buffer_load_dwordx4 v9, s[24:27], s45 offen offset:1024 nt lds
buffer_load_dwordx4 v8, s[24:27], s45 offen offset:2048 nt lds
buffer_load_dwordx4 v9, s[24:27], s45 offen offset:3072 nt lds
v_mfma_f32_16x16x32_bf16 a[208:211], a[112:115], v[64:67], 0
v_add_u32 v13, 65536, v11
v_xor_b32 v14, 32, v13
v_mfma_f32_16x16x32_bf16 a[212:215], a[112:115], v[72:75], 0
v_xor_b32 v15, 64, v13
v_xor_b32 v16, 96, v13
v_mfma_f32_16x16x32_bf16 a[216:219], a[112:115], v[80:83], 0
ds_read_b64_tr_b16 a[96:97], v13
ds_read_b64_tr_b16 a[98:99], v13 offset:4096
v_mfma_f32_16x16x32_bf16 a[220:223], a[116:119], v[64:67], 0
ds_read_b64_tr_b16 a[100:101], v14
ds_read_b64_tr_b16 a[102:103], v14 offset:4096
v_mfma_f32_16x16x32_bf16 a[224:227], a[116:119], v[72:75], 0
ds_read_b64_tr_b16 a[104:105], v15
ds_read_b64_tr_b16 a[106:107], v15 offset:4096
v_mfma_f32_16x16x32_bf16 a[228:231], a[116:119], v[80:83], 0
ds_read_b64_tr_b16 a[108:109], v16
ds_read_b64_tr_b16 a[110:111], v16 offset:4096
v_mfma_f32_16x16x32_bf16 a[232:235], a[120:123], v[64:67], 0
v_mfma_f32_16x16x32_bf16 a[236:239], a[120:123], v[72:75], 0
v_mfma_f32_16x16x32_bf16 a[240:243], a[120:123], v[80:83], 0
v_mfma_f32_16x16x32_bf16 a[244:247], a[124:127], v[64:67], 0
v_mfma_f32_16x16x32_bf16 a[248:251], a[124:127], v[72:75], 0
v_mfma_f32_16x16x32_bf16 a[252:255], a[124:127], v[80:83], 0
s_waitcnt lgkmcnt(0)
v_mfma_f32_16x16x32_bf16 a[128:131], a[96:99], v[88:91], a[128:131]
v_add_u32 v13, 65536, v11
v_xor_b32 v13, 128, v13
v_mfma_f32_16x16x32_bf16 a[132:135], a[96:99], v[96:99], a[132:135]
v_xor_b32 v14, 32, v13
v_xor_b32 v15, 64, v13
v_mfma_f32_16x16x32_bf16 a[136:139], a[96:99], v[104:107], a[136:139]
v_xor_b32 v16, 96, v13
ds_read_b64_tr_b16 a[112:113], v13
v_mfma_f32_16x16x32_bf16 a[140:143], a[100:103], v[88:91], a[140:143]
ds_read_b64_tr_b16 a[114:115], v13 offset:4096
ds_read_b64_tr_b16 a[116:117], v14
ds_read_b64_tr_b16 a[118:119], v14 offset:4096
v_mfma_f32_16x16x32_bf16 a[144:147], a[100:103], v[96:99], a[144:147]
ds_read_b64_tr_b16 a[120:121], v15
ds_read_b64_tr_b16 a[122:123], v15 offset:4096
v_mfma_f32_16x16x32_bf16 a[148:151], a[100:103], v[104:107], a[148:151]
ds_read_b64_tr_b16 a[124:125], v16
ds_read_b64_tr_b16 a[126:127], v16 offset:4096
v_mfma_f32_16x16x32_bf16 a[152:155], a[104:107], v[88:91], a[152:155]
v_mfma_f32_16x16x32_bf16 a[156:159], a[104:107], v[96:99], a[156:159]
v_mfma_f32_16x16x32_bf16 a[160:163], a[104:107], v[104:107], a[160:163]
v_mfma_f32_16x16x32_bf16 a[164:167], a[108:111], v[88:91], a[164:167]
v_mfma_f32_16x16x32_bf16 a[168:171], a[108:111], v[96:99], a[168:171]
v_mfma_f32_16x16x32_bf16 a[172:175], a[108:111], v[104:107], a[172:175]
s_waitcnt lgkmcnt(0)
s_waitcnt vmcnt(26)
s_barrier
v_mfma_f32_16x16x32_bf16 a[208:211], a[112:115], v[88:91], a[208:211]
v_add_u32 v13, 81920, v11
v_xor_b32 v14, 32, v13
v_mfma_f32_16x16x32_bf16 a[212:215], a[112:115], v[96:99], a[212:215]
v_xor_b32 v15, 64, v13
v_xor_b32 v16, 96, v13
v_mfma_f32_16x16x32_bf16 a[216:219], a[112:115], v[104:107], a[216:219]
ds_read_b64_tr_b16 a[96:97], v13
ds_read_b64_tr_b16 a[98:99], v13 offset:4096
v_mfma_f32_16x16x32_bf16 a[220:223], a[116:119], v[88:91], a[220:223]
ds_read_b64_tr_b16 a[100:101], v14
ds_read_b64_tr_b16 a[102:103], v14 offset:4096
v_mfma_f32_16x16x32_bf16 a[224:227], a[116:119], v[96:99], a[224:227]
ds_read_b64_tr_b16 a[104:105], v15
ds_read_b64_tr_b16 a[106:107], v15 offset:4096
v_mfma_f32_16x16x32_bf16 a[228:231], a[116:119], v[104:107], a[228:231]
ds_read_b64_tr_b16 a[108:109], v16
ds_read_b64_tr_b16 a[110:111], v16 offset:4096
v_mfma_f32_16x16x32_bf16 a[232:235], a[120:123], v[88:91], a[232:235]
v_mfma_f32_16x16x32_bf16 a[236:239], a[120:123], v[96:99], a[236:239]
v_mfma_f32_16x16x32_bf16 a[240:243], a[120:123], v[104:107], a[240:243]
v_mfma_f32_16x16x32_bf16 a[244:247], a[124:127], v[88:91], a[244:247]
v_mfma_f32_16x16x32_bf16 a[248:251], a[124:127], v[96:99], a[248:251]
v_mfma_f32_16x16x32_bf16 a[252:255], a[124:127], v[104:107], a[252:255]
s_waitcnt lgkmcnt(0)
v_mfma_f32_16x16x32_bf16 a[128:131], a[96:99], v[112:115], a[128:131]
v_add_u32 v13, 81920, v11
v_xor_b32 v13, 128, v13
v_mfma_f32_16x16x32_bf16 a[132:135], a[96:99], v[120:123], a[132:135]
v_xor_b32 v14, 32, v13
v_xor_b32 v15, 64, v13
v_mfma_f32_16x16x32_bf16 a[136:139], a[96:99], v[128:131], a[136:139]
v_xor_b32 v16, 96, v13
ds_read_b64_tr_b16 a[112:113], v13
v_mfma_f32_16x16x32_bf16 a[140:143], a[100:103], v[112:115], a[140:143]
ds_read_b64_tr_b16 a[114:115], v13 offset:4096
ds_read_b64_tr_b16 a[116:117], v14
ds_read_b64_tr_b16 a[118:119], v14 offset:4096
v_mfma_f32_16x16x32_bf16 a[144:147], a[100:103], v[120:123], a[144:147]
ds_read_b64_tr_b16 a[120:121], v15
ds_read_b64_tr_b16 a[122:123], v15 offset:4096
v_mfma_f32_16x16x32_bf16 a[148:151], a[100:103], v[128:131], a[148:151]
ds_read_b64_tr_b16 a[124:125], v16
ds_read_b64_tr_b16 a[126:127], v16 offset:4096
v_mfma_f32_16x16x32_bf16 a[152:155], a[104:107], v[112:115], a[152:155]
v_mfma_f32_16x16x32_bf16 a[156:159], a[104:107], v[120:123], a[156:159]
v_mfma_f32_16x16x32_bf16 a[160:163], a[104:107], v[128:131], a[160:163]
v_mfma_f32_16x16x32_bf16 a[164:167], a[108:111], v[112:115], a[164:167]
v_mfma_f32_16x16x32_bf16 a[168:171], a[108:111], v[120:123], a[168:171]
v_mfma_f32_16x16x32_bf16 a[172:175], a[108:111], v[128:131], a[172:175]
s_waitcnt lgkmcnt(0)
s_waitcnt vmcnt(22)
s_barrier
v_mfma_f32_16x16x32_bf16 a[208:211], a[112:115], v[112:115], a[208:211]
v_add_u32 v13, 98304, v11
v_xor_b32 v14, 32, v13
v_mfma_f32_16x16x32_bf16 a[212:215], a[112:115], v[120:123], a[212:215]
v_xor_b32 v15, 64, v13
v_xor_b32 v16, 96, v13
v_mfma_f32_16x16x32_bf16 a[216:219], a[112:115], v[128:131], a[216:219]
ds_read_b64_tr_b16 a[96:97], v13
ds_read_b64_tr_b16 a[98:99], v13 offset:4096
v_mfma_f32_16x16x32_bf16 a[220:223], a[116:119], v[112:115], a[220:223]
ds_read_b64_tr_b16 a[100:101], v14
ds_read_b64_tr_b16 a[102:103], v14 offset:4096
v_mfma_f32_16x16x32_bf16 a[224:227], a[116:119], v[120:123], a[224:227]
ds_read_b64_tr_b16 a[104:105], v15
ds_read_b64_tr_b16 a[106:107], v15 offset:4096
v_mfma_f32_16x16x32_bf16 a[228:231], a[116:119], v[128:131], a[228:231]
ds_read_b64_tr_b16 a[108:109], v16
ds_read_b64_tr_b16 a[110:111], v16 offset:4096
v_mfma_f32_16x16x32_bf16 a[232:235], a[120:123], v[112:115], a[232:235]
v_mfma_f32_16x16x32_bf16 a[236:239], a[120:123], v[120:123], a[236:239]
v_mfma_f32_16x16x32_bf16 a[240:243], a[120:123], v[128:131], a[240:243]
v_mfma_f32_16x16x32_bf16 a[244:247], a[124:127], v[112:115], a[244:247]
v_mfma_f32_16x16x32_bf16 a[248:251], a[124:127], v[120:123], a[248:251]
v_mfma_f32_16x16x32_bf16 a[252:255], a[124:127], v[128:131], a[252:255]
s_waitcnt lgkmcnt(0)
s_and_b32 s43, s14, 3
s_mul_i32 s43, s43, 1310720
s_lshl_b32 s3, s15, 2
s_add_u32 s3, s3, s36
s_mul_i32 s3, s3, 10240
s_add_u32 s88, s96, s43
s_addc_u32 s89, s97, 0
s_and_b32 s89, s89, 0xffff
s_mov_b32 s90, 1310720
s_mov_b32 s91, 0x20000
v_lshlrev_b32 v56, 7, v1
buffer_load_dword a182, v56, s[88:91], s3 offen
s_add_u32 s3, s3, 8192
s_mov_b32 exec_lo, 0xffff
s_mov_b32 exec_hi, 0
buffer_load_dword a182, v56, s[88:91], s3 offen
s_mov_b64 exec, -1
v_mfma_f32_16x16x32_bf16 a[128:131], a[96:99], v[136:139], a[128:131]
v_add_u32 v13, 98304, v11
v_xor_b32 v13, 128, v13
v_mfma_f32_16x16x32_bf16 a[132:135], a[96:99], v[144:147], a[132:135]
v_xor_b32 v14, 32, v13
v_xor_b32 v15, 64, v13
v_mfma_f32_16x16x32_bf16 a[136:139], a[96:99], v[152:155], a[136:139]
v_xor_b32 v16, 96, v13
ds_read_b64_tr_b16 a[112:113], v13
v_mfma_f32_16x16x32_bf16 a[140:143], a[100:103], v[136:139], a[140:143]
ds_read_b64_tr_b16 a[114:115], v13 offset:4096
ds_read_b64_tr_b16 a[116:117], v14
ds_read_b64_tr_b16 a[118:119], v14 offset:4096
v_mfma_f32_16x16x32_bf16 a[144:147], a[100:103], v[144:147], a[144:147]
ds_read_b64_tr_b16 a[120:121], v15
ds_read_b64_tr_b16 a[122:123], v15 offset:4096
v_mfma_f32_16x16x32_bf16 a[148:151], a[100:103], v[152:155], a[148:151]
ds_read_b64_tr_b16 a[124:125], v16
ds_read_b64_tr_b16 a[126:127], v16 offset:4096
v_mfma_f32_16x16x32_bf16 a[152:155], a[104:107], v[136:139], a[152:155]
v_mfma_f32_16x16x32_bf16 a[156:159], a[104:107], v[144:147], a[156:159]
v_mfma_f32_16x16x32_bf16 a[160:163], a[104:107], v[152:155], a[160:163]
v_mfma_f32_16x16x32_bf16 a[164:167], a[108:111], v[136:139], a[164:167]
v_mfma_f32_16x16x32_bf16 a[168:171], a[108:111], v[144:147], a[168:171]
v_mfma_f32_16x16x32_bf16 a[172:175], a[108:111], v[152:155], a[172:175]
s_waitcnt lgkmcnt(0)
s_waitcnt vmcnt(20)
s_barrier
v_mfma_f32_16x16x32_bf16 a[208:211], a[112:115], v[136:139], a[208:211]
v_add_u32 v13, 0, v11
v_xor_b32 v14, 32, v13
v_mfma_f32_16x16x32_bf16 a[212:215], a[112:115], v[144:147], a[212:215]
v_xor_b32 v15, 64, v13
v_xor_b32 v16, 96, v13
v_mfma_f32_16x16x32_bf16 a[216:219], a[112:115], v[152:155], a[216:219]
ds_read_b64_tr_b16 a[96:97], v13
ds_read_b64_tr_b16 a[98:99], v13 offset:4096
v_mfma_f32_16x16x32_bf16 a[220:223], a[116:119], v[136:139], a[220:223]
ds_read_b64_tr_b16 a[100:101], v14
ds_read_b64_tr_b16 a[102:103], v14 offset:4096
v_mfma_f32_16x16x32_bf16 a[224:227], a[116:119], v[144:147], a[224:227]
ds_read_b64_tr_b16 a[104:105], v15
ds_read_b64_tr_b16 a[106:107], v15 offset:4096
v_mfma_f32_16x16x32_bf16 a[228:231], a[116:119], v[152:155], a[228:231]
ds_read_b64_tr_b16 a[108:109], v16
ds_read_b64_tr_b16 a[110:111], v16 offset:4096
v_mfma_f32_16x16x32_bf16 a[232:235], a[120:123], v[136:139], a[232:235]
v_mfma_f32_16x16x32_bf16 a[236:239], a[120:123], v[144:147], a[236:239]
v_mfma_f32_16x16x32_bf16 a[240:243], a[120:123], v[152:155], a[240:243]
v_mfma_f32_16x16x32_bf16 a[244:247], a[124:127], v[136:139], a[244:247]
v_mfma_f32_16x16x32_bf16 a[248:251], a[124:127], v[144:147], a[248:251]
v_mfma_f32_16x16x32_bf16 a[252:255], a[124:127], v[152:155], a[252:255]
s_waitcnt lgkmcnt(0)
v_mfma_f32_16x16x32_bf16 a[128:131], a[96:99], v[160:163], a[128:131]
v_add_u32 v13, 0, v11
v_xor_b32 v13, 128, v13
v_mfma_f32_16x16x32_bf16 a[132:135], a[96:99], v[168:171], a[132:135]
v_xor_b32 v14, 32, v13
v_xor_b32 v15, 64, v13
v_mfma_f32_16x16x32_bf16 a[136:139], a[96:99], v[176:179], a[136:139]
v_xor_b32 v16, 96, v13
ds_read_b64_tr_b16 a[112:113], v13
v_mfma_f32_16x16x32_bf16 a[140:143], a[100:103], v[160:163], a[140:143]
ds_read_b64_tr_b16 a[114:115], v13 offset:4096
ds_read_b64_tr_b16 a[116:117], v14
ds_read_b64_tr_b16 a[118:119], v14 offset:4096
v_mfma_f32_16x16x32_bf16 a[144:147], a[100:103], v[168:171], a[144:147]
ds_read_b64_tr_b16 a[120:121], v15
ds_read_b64_tr_b16 a[122:123], v15 offset:4096
v_mfma_f32_16x16x32_bf16 a[148:151], a[100:103], v[176:179], a[148:151]
ds_read_b64_tr_b16 a[124:125], v16
ds_read_b64_tr_b16 a[126:127], v16 offset:4096
v_mfma_f32_16x16x32_bf16 a[152:155], a[104:107], v[160:163], a[152:155]
v_mfma_f32_16x16x32_bf16 a[156:159], a[104:107], v[168:171], a[156:159]
v_mfma_f32_16x16x32_bf16 a[160:163], a[104:107], v[176:179], a[160:163]
v_mfma_f32_16x16x32_bf16 a[164:167], a[108:111], v[160:163], a[164:167]
v_mfma_f32_16x16x32_bf16 a[168:171], a[108:111], v[168:171], a[168:171]
v_mfma_f32_16x16x32_bf16 a[172:175], a[108:111], v[176:179], a[172:175]
s_waitcnt lgkmcnt(0)
s_waitcnt vmcnt(14)
s_barrier
v_mfma_f32_16x16x32_bf16 a[208:211], a[112:115], v[160:163], a[208:211]
v_add_u32 v13, 16384, v11
v_xor_b32 v14, 32, v13
v_mfma_f32_16x16x32_bf16 a[212:215], a[112:115], v[168:171], a[212:215]
v_xor_b32 v15, 64, v13
v_xor_b32 v16, 96, v13
v_mfma_f32_16x16x32_bf16 a[216:219], a[112:115], v[176:179], a[216:219]
ds_read_b64_tr_b16 a[96:97], v13
ds_read_b64_tr_b16 a[98:99], v13 offset:4096
v_mfma_f32_16x16x32_bf16 a[220:223], a[116:119], v[160:163], a[220:223]
ds_read_b64_tr_b16 a[100:101], v14
ds_read_b64_tr_b16 a[102:103], v14 offset:4096
v_mfma_f32_16x16x32_bf16 a[224:227], a[116:119], v[168:171], a[224:227]
ds_read_b64_tr_b16 a[104:105], v15
ds_read_b64_tr_b16 a[106:107], v15 offset:4096
v_mfma_f32_16x16x32_bf16 a[228:231], a[116:119], v[176:179], a[228:231]
ds_read_b64_tr_b16 a[108:109], v16
ds_read_b64_tr_b16 a[110:111], v16 offset:4096
v_mfma_f32_16x16x32_bf16 a[232:235], a[120:123], v[160:163], a[232:235]
v_mfma_f32_16x16x32_bf16 a[236:239], a[120:123], v[168:171], a[236:239]
v_mfma_f32_16x16x32_bf16 a[240:243], a[120:123], v[176:179], a[240:243]
v_mfma_f32_16x16x32_bf16 a[244:247], a[124:127], v[160:163], a[244:247]
v_mfma_f32_16x16x32_bf16 a[248:251], a[124:127], v[168:171], a[248:251]
v_mfma_f32_16x16x32_bf16 a[252:255], a[124:127], v[176:179], a[252:255]
s_waitcnt lgkmcnt(0)
v_mfma_f32_16x16x32_bf16 a[128:131], a[96:99], v[184:187], a[128:131]
v_add_u32 v13, 16384, v11
v_xor_b32 v13, 128, v13
v_mfma_f32_16x16x32_bf16 a[132:135], a[96:99], v[192:195], a[132:135]
v_xor_b32 v14, 32, v13
v_xor_b32 v15, 64, v13
v_mfma_f32_16x16x32_bf16 a[136:139], a[96:99], v[200:203], a[136:139]
v_xor_b32 v16, 96, v13
ds_read_b64_tr_b16 a[112:113], v13
v_mfma_f32_16x16x32_bf16 a[140:143], a[100:103], v[184:187], a[140:143]
ds_read_b64_tr_b16 a[114:115], v13 offset:4096
ds_read_b64_tr_b16 a[116:117], v14
ds_read_b64_tr_b16 a[118:119], v14 offset:4096
v_mfma_f32_16x16x32_bf16 a[144:147], a[100:103], v[192:195], a[144:147]
ds_read_b64_tr_b16 a[120:121], v15
ds_read_b64_tr_b16 a[122:123], v15 offset:4096
v_mfma_f32_16x16x32_bf16 a[148:151], a[100:103], v[200:203], a[148:151]
ds_read_b64_tr_b16 a[124:125], v16
ds_read_b64_tr_b16 a[126:127], v16 offset:4096
v_mfma_f32_16x16x32_bf16 a[152:155], a[104:107], v[184:187], a[152:155]
v_mfma_f32_16x16x32_bf16 a[156:159], a[104:107], v[192:195], a[156:159]
v_mfma_f32_16x16x32_bf16 a[160:163], a[104:107], v[200:203], a[160:163]
v_mfma_f32_16x16x32_bf16 a[164:167], a[108:111], v[184:187], a[164:167]
v_mfma_f32_16x16x32_bf16 a[168:171], a[108:111], v[192:195], a[168:171]
v_mfma_f32_16x16x32_bf16 a[172:175], a[108:111], v[200:203], a[172:175]
s_waitcnt lgkmcnt(0)
s_waitcnt vmcnt(7)
s_barrier
v_mfma_f32_16x16x32_bf16 a[208:211], a[112:115], v[184:187], a[208:211]
v_add_u32 v13, 32768, v11
v_xor_b32 v14, 32, v13
v_mfma_f32_16x16x32_bf16 a[212:215], a[112:115], v[192:195], a[212:215]
v_xor_b32 v15, 64, v13
v_xor_b32 v16, 96, v13
v_mfma_f32_16x16x32_bf16 a[216:219], a[112:115], v[200:203], a[216:219]
ds_read_b64_tr_b16 a[96:97], v13
ds_read_b64_tr_b16 a[98:99], v13 offset:4096
v_mfma_f32_16x16x32_bf16 a[220:223], a[116:119], v[184:187], a[220:223]
ds_read_b64_tr_b16 a[100:101], v14
ds_read_b64_tr_b16 a[102:103], v14 offset:4096
v_mfma_f32_16x16x32_bf16 a[224:227], a[116:119], v[192:195], a[224:227]
ds_read_b64_tr_b16 a[104:105], v15
ds_read_b64_tr_b16 a[106:107], v15 offset:4096
v_mfma_f32_16x16x32_bf16 a[228:231], a[116:119], v[200:203], a[228:231]
ds_read_b64_tr_b16 a[108:109], v16
ds_read_b64_tr_b16 a[110:111], v16 offset:4096
v_mfma_f32_16x16x32_bf16 a[232:235], a[120:123], v[184:187], a[232:235]
v_mfma_f32_16x16x32_bf16 a[236:239], a[120:123], v[192:195], a[236:239]
v_mfma_f32_16x16x32_bf16 a[240:243], a[120:123], v[200:203], a[240:243]
v_mfma_f32_16x16x32_bf16 a[244:247], a[124:127], v[184:187], a[244:247]
v_mfma_f32_16x16x32_bf16 a[248:251], a[124:127], v[192:195], a[248:251]
v_mfma_f32_16x16x32_bf16 a[252:255], a[124:127], v[200:203], a[252:255]
s_waitcnt lgkmcnt(0)
v_mfma_f32_16x16x32_bf16 a[128:131], a[96:99], v[208:211], a[128:131]
v_add_u32 v13, 32768, v11
v_xor_b32 v13, 128, v13
v_mfma_f32_16x16x32_bf16 a[132:135], a[96:99], v[216:219], a[132:135]
v_xor_b32 v14, 32, v13
v_xor_b32 v15, 64, v13
v_mfma_f32_16x16x32_bf16 a[136:139], a[96:99], v[224:227], a[136:139]
v_xor_b32 v16, 96, v13
ds_read_b64_tr_b16 a[112:113], v13
v_mfma_f32_16x16x32_bf16 a[140:143], a[100:103], v[208:211], a[140:143]
ds_read_b64_tr_b16 a[114:115], v13 offset:4096
ds_read_b64_tr_b16 a[116:117], v14
ds_read_b64_tr_b16 a[118:119], v14 offset:4096
v_mfma_f32_16x16x32_bf16 a[144:147], a[100:103], v[216:219], a[144:147]
ds_read_b64_tr_b16 a[120:121], v15
ds_read_b64_tr_b16 a[122:123], v15 offset:4096
v_mfma_f32_16x16x32_bf16 a[148:151], a[100:103], v[224:227], a[148:151]
ds_read_b64_tr_b16 a[124:125], v16
ds_read_b64_tr_b16 a[126:127], v16 offset:4096
v_mfma_f32_16x16x32_bf16 a[152:155], a[104:107], v[208:211], a[152:155]
v_mfma_f32_16x16x32_bf16 a[156:159], a[104:107], v[216:219], a[156:159]
v_mfma_f32_16x16x32_bf16 a[160:163], a[104:107], v[224:227], a[160:163]
v_mfma_f32_16x16x32_bf16 a[164:167], a[108:111], v[208:211], a[164:167]
v_mfma_f32_16x16x32_bf16 a[168:171], a[108:111], v[216:219], a[168:171]
v_mfma_f32_16x16x32_bf16 a[172:175], a[108:111], v[224:227], a[172:175]
s_waitcnt lgkmcnt(0)
s_waitcnt vmcnt(2)
s_barrier
v_mfma_f32_16x16x32_bf16 a[208:211], a[112:115], v[208:211], a[208:211]
v_add_u32 v13, 49152, v11
v_xor_b32 v14, 32, v13
v_mfma_f32_16x16x32_bf16 a[212:215], a[112:115], v[216:219], a[212:215]
v_xor_b32 v15, 64, v13
v_xor_b32 v16, 96, v13
v_mfma_f32_16x16x32_bf16 a[216:219], a[112:115], v[224:227], a[216:219]
ds_read_b64_tr_b16 a[96:97], v13
ds_read_b64_tr_b16 a[98:99], v13 offset:4096
v_mfma_f32_16x16x32_bf16 a[220:223], a[116:119], v[208:211], a[220:223]
ds_read_b64_tr_b16 a[100:101], v14
ds_read_b64_tr_b16 a[102:103], v14 offset:4096
v_mfma_f32_16x16x32_bf16 a[224:227], a[116:119], v[216:219], a[224:227]
ds_read_b64_tr_b16 a[104:105], v15
ds_read_b64_tr_b16 a[106:107], v15 offset:4096
v_mfma_f32_16x16x32_bf16 a[228:231], a[116:119], v[224:227], a[228:231]
ds_read_b64_tr_b16 a[108:109], v16
ds_read_b64_tr_b16 a[110:111], v16 offset:4096
v_mfma_f32_16x16x32_bf16 a[232:235], a[120:123], v[208:211], a[232:235]
v_mfma_f32_16x16x32_bf16 a[236:239], a[120:123], v[216:219], a[236:239]
v_mfma_f32_16x16x32_bf16 a[240:243], a[120:123], v[224:227], a[240:243]
v_mfma_f32_16x16x32_bf16 a[244:247], a[124:127], v[208:211], a[244:247]
v_mfma_f32_16x16x32_bf16 a[248:251], a[124:127], v[216:219], a[248:251]
v_mfma_f32_16x16x32_bf16 a[252:255], a[124:127], v[224:227], a[252:255]
s_waitcnt lgkmcnt(0)
v_mfma_f32_16x16x32_bf16 a[128:131], a[96:99], v[232:235], a[128:131]
v_add_u32 v13, 49152, v11
v_xor_b32 v13, 128, v13
v_mfma_f32_16x16x32_bf16 a[132:135], a[96:99], v[240:243], a[132:135]
v_xor_b32 v14, 32, v13
v_xor_b32 v15, 64, v13
v_mfma_f32_16x16x32_bf16 a[136:139], a[96:99], v[248:251], a[136:139]
v_xor_b32 v16, 96, v13
ds_read_b64_tr_b16 a[112:113], v13
v_mfma_f32_16x16x32_bf16 a[140:143], a[100:103], v[232:235], a[140:143]
ds_read_b64_tr_b16 a[114:115], v13 offset:4096
ds_read_b64_tr_b16 a[116:117], v14
ds_read_b64_tr_b16 a[118:119], v14 offset:4096
v_mfma_f32_16x16x32_bf16 a[144:147], a[100:103], v[240:243], a[144:147]
ds_read_b64_tr_b16 a[120:121], v15
ds_read_b64_tr_b16 a[122:123], v15 offset:4096
v_mfma_f32_16x16x32_bf16 a[148:151], a[100:103], v[248:251], a[148:151]
ds_read_b64_tr_b16 a[124:125], v16
ds_read_b64_tr_b16 a[126:127], v16 offset:4096
v_mfma_f32_16x16x32_bf16 a[152:155], a[104:107], v[232:235], a[152:155]
v_mfma_f32_16x16x32_bf16 a[156:159], a[104:107], v[240:243], a[156:159]
v_mfma_f32_16x16x32_bf16 a[160:163], a[104:107], v[248:251], a[160:163]
v_mfma_f32_16x16x32_bf16 a[164:167], a[108:111], v[232:235], a[164:167]
v_mfma_f32_16x16x32_bf16 a[168:171], a[108:111], v[240:243], a[168:171]
v_mfma_f32_16x16x32_bf16 a[172:175], a[108:111], v[248:251], a[172:175]
s_waitcnt lgkmcnt(0)
v_mfma_f32_16x16x32_bf16 a[208:211], a[112:115], v[232:235], a[208:211]
v_mfma_f32_16x16x32_bf16 a[212:215], a[112:115], v[240:243], a[212:215]
v_mfma_f32_16x16x32_bf16 a[216:219], a[112:115], v[248:251], a[216:219]
v_mfma_f32_16x16x32_bf16 a[220:223], a[116:119], v[232:235], a[220:223]
v_mfma_f32_16x16x32_bf16 a[224:227], a[116:119], v[240:243], a[224:227]
v_mfma_f32_16x16x32_bf16 a[228:231], a[116:119], v[248:251], a[228:231]
v_mfma_f32_16x16x32_bf16 a[232:235], a[120:123], v[232:235], a[232:235]
v_mfma_f32_16x16x32_bf16 a[236:239], a[120:123], v[240:243], a[236:239]
v_mfma_f32_16x16x32_bf16 a[240:243], a[120:123], v[248:251], a[240:243]
v_mfma_f32_16x16x32_bf16 a[244:247], a[124:127], v[232:235], a[244:247]
v_mfma_f32_16x16x32_bf16 a[248:251], a[124:127], v[240:243], a[248:251]
v_mfma_f32_16x16x32_bf16 a[252:255], a[124:127], v[248:251], a[252:255]
s_mul_i32 s43, s36, 768
v_lshlrev_b32 v43, 2, v1
v_add_u32 v43, 32768, v43
v_add_u32 v47, s43, v43
s_xor_b32 s43, s36, 2
s_mul_i32 s43, s43, 768
v_add_u32 v49, s43, v43
ds_write_b32 v47, v28 offset:0
ds_write_b32 v47, v32 offset:256
ds_write_b32 v47, v36 offset:512
s_mul_i32 s43, s36, 12288
v_add_u32 v43, 114688, v12
v_add_u32 v44, s43, v43
s_xor_b32 s43, s36, 2
s_mul_i32 s43, s43, 12288
v_add_u32 v45, s43, v43
s_nop 4
ds_write_b128 v44, a[208:211] offset:0
ds_write_b128 v44, a[212:215] offset:1024
ds_write_b128 v44, a[216:219] offset:2048
ds_write_b128 v44, a[220:223] offset:3072
ds_write_b128 v44, a[224:227] offset:4096
ds_write_b128 v44, a[228:231] offset:5120
ds_write_b128 v44, a[232:235] offset:6144
ds_write_b128 v44, a[236:239] offset:7168
ds_write_b128 v44, a[240:243] offset:8192
ds_write_b128 v44, a[244:247] offset:9216
ds_write_b128 v44, a[248:251] offset:10240
ds_write_b128 v44, a[252:255] offset:11264
v_accvgpr_read_b32 v68, a128
v_accvgpr_read_b32 v69, a129
v_accvgpr_read_b32 v70, a130
v_accvgpr_read_b32 v71, a131
v_accvgpr_read_b32 v76, a132
v_accvgpr_read_b32 v77, a133
v_accvgpr_read_b32 v78, a134
v_accvgpr_read_b32 v79, a135
v_accvgpr_read_b32 v84, a136
v_accvgpr_read_b32 v85, a137
v_accvgpr_read_b32 v86, a138
v_accvgpr_read_b32 v87, a139
v_accvgpr_read_b32 v92, a140
v_accvgpr_read_b32 v93, a141
v_accvgpr_read_b32 v94, a142
v_accvgpr_read_b32 v95, a143
v_accvgpr_read_b32 v100, a144
v_accvgpr_read_b32 v101, a145
v_accvgpr_read_b32 v102, a146
v_accvgpr_read_b32 v103, a147
v_accvgpr_read_b32 v108, a148
v_accvgpr_read_b32 v109, a149
v_accvgpr_read_b32 v110, a150
v_accvgpr_read_b32 v111, a151
v_accvgpr_read_b32 v116, a152
v_accvgpr_read_b32 v117, a153
v_accvgpr_read_b32 v118, a154
v_accvgpr_read_b32 v119, a155
v_accvgpr_read_b32 v124, a156
v_accvgpr_read_b32 v125, a157
v_accvgpr_read_b32 v126, a158
v_accvgpr_read_b32 v127, a159
v_accvgpr_read_b32 v132, a160
v_accvgpr_read_b32 v133, a161
v_accvgpr_read_b32 v134, a162
v_accvgpr_read_b32 v135, a163
v_accvgpr_read_b32 v140, a164
v_accvgpr_read_b32 v141, a165
v_accvgpr_read_b32 v142, a166
v_accvgpr_read_b32 v143, a167
v_accvgpr_read_b32 v148, a168
v_accvgpr_read_b32 v149, a169
v_accvgpr_read_b32 v150, a170
v_accvgpr_read_b32 v151, a171
v_accvgpr_read_b32 v156, a172
v_accvgpr_read_b32 v157, a173
v_accvgpr_read_b32 v158, a174
v_accvgpr_read_b32 v159, a175
s_waitcnt lgkmcnt(0)
s_barrier
ds_read_b32 v40, v49 offset:0
ds_read_b32 v41, v49 offset:256
ds_read_b32 v42, v49 offset:512
ds_read_b128 v[64:67], v45 offset:0
ds_read_b128 v[72:75], v45 offset:1024
ds_read_b128 v[80:83], v45 offset:2048
ds_read_b128 v[88:91], v45 offset:3072
ds_read_b128 v[96:99], v45 offset:4096
ds_read_b128 v[104:107], v45 offset:5120
ds_read_b128 v[112:115], v45 offset:6144
ds_read_b128 v[120:123], v45 offset:7168
ds_read_b128 v[128:131], v45 offset:8192
ds_read_b128 v[136:139], v45 offset:9216
ds_read_b128 v[144:147], v45 offset:10240
ds_read_b128 v[152:155], v45 offset:11264
s_lshl_b32 s43, s48, 1
s_add_u32 s43, s43, 1
s_mul_i32 s43, s43, 6
s_mul_i32 s51, s37, 3
s_add_u32 s43, s43, s51
s_lshl_b32 s43, s43, 7
s_lshl_b32 s51, s47, 2
s_add_u32 s43, s43, s51
s_lshl_b32 s51, s38, 1
s_add_u32 s43, s43, s51
s_lshl_b32 s43, s43, 10
s_waitcnt lgkmcnt(0)
v_add_f32 v40, v40, v28
v_add_f32 v41, v41, v32
v_add_f32 v42, v42, v36
v_rcp_f32 v52, v40
v_rcp_f32 v54, v41
v_rcp_f32 v56, v42
v_pk_add_f32 v[64:65], v[64:65], v[68:69]
v_pk_add_f32 v[66:67], v[66:67], v[70:71]
v_pk_add_f32 v[72:73], v[72:73], v[76:77]
v_pk_add_f32 v[74:75], v[74:75], v[78:79]
v_pk_add_f32 v[80:81], v[80:81], v[84:85]
v_pk_add_f32 v[82:83], v[82:83], v[86:87]
v_pk_add_f32 v[88:89], v[88:89], v[92:93]
v_pk_add_f32 v[90:91], v[90:91], v[94:95]
v_pk_add_f32 v[96:97], v[96:97], v[100:101]
v_pk_add_f32 v[98:99], v[98:99], v[102:103]
v_pk_add_f32 v[104:105], v[104:105], v[108:109]
v_pk_add_f32 v[106:107], v[106:107], v[110:111]
v_pk_add_f32 v[112:113], v[112:113], v[116:117]
v_pk_add_f32 v[114:115], v[114:115], v[118:119]
v_pk_add_f32 v[120:121], v[120:121], v[124:125]
v_pk_add_f32 v[122:123], v[122:123], v[126:127]
v_pk_add_f32 v[128:129], v[128:129], v[132:133]
v_pk_add_f32 v[130:131], v[130:131], v[134:135]
v_pk_add_f32 v[136:137], v[136:137], v[140:141]
v_pk_add_f32 v[138:139], v[138:139], v[142:143]
v_pk_add_f32 v[144:145], v[144:145], v[148:149]
v_pk_add_f32 v[146:147], v[146:147], v[150:151]
v_pk_add_f32 v[152:153], v[152:153], v[156:157]
v_pk_add_f32 v[154:155], v[154:155], v[158:159]
v_pk_mul_f32 v[64:65], v[64:65], v[52:53] op_sel_hi:[1,0]
v_pk_mul_f32 v[66:67], v[66:67], v[52:53] op_sel_hi:[1,0]
v_pk_mul_f32 v[72:73], v[72:73], v[54:55] op_sel_hi:[1,0]
v_pk_mul_f32 v[74:75], v[74:75], v[54:55] op_sel_hi:[1,0]
v_pk_mul_f32 v[80:81], v[80:81], v[56:57] op_sel_hi:[1,0]
v_pk_mul_f32 v[82:83], v[82:83], v[56:57] op_sel_hi:[1,0]
v_pk_mul_f32 v[88:89], v[88:89], v[52:53] op_sel_hi:[1,0]
v_pk_mul_f32 v[90:91], v[90:91], v[52:53] op_sel_hi:[1,0]
v_pk_mul_f32 v[96:97], v[96:97], v[54:55] op_sel_hi:[1,0]
v_pk_mul_f32 v[98:99], v[98:99], v[54:55] op_sel_hi:[1,0]
v_pk_mul_f32 v[104:105], v[104:105], v[56:57] op_sel_hi:[1,0]
v_pk_mul_f32 v[106:107], v[106:107], v[56:57] op_sel_hi:[1,0]
v_pk_mul_f32 v[112:113], v[112:113], v[52:53] op_sel_hi:[1,0]
v_pk_mul_f32 v[114:115], v[114:115], v[52:53] op_sel_hi:[1,0]
v_pk_mul_f32 v[120:121], v[120:121], v[54:55] op_sel_hi:[1,0]
v_pk_mul_f32 v[122:123], v[122:123], v[54:55] op_sel_hi:[1,0]
v_pk_mul_f32 v[128:129], v[128:129], v[56:57] op_sel_hi:[1,0]
v_pk_mul_f32 v[130:131], v[130:131], v[56:57] op_sel_hi:[1,0]
v_pk_mul_f32 v[136:137], v[136:137], v[52:53] op_sel_hi:[1,0]
v_pk_mul_f32 v[138:139], v[138:139], v[52:53] op_sel_hi:[1,0]
v_pk_mul_f32 v[144:145], v[144:145], v[54:55] op_sel_hi:[1,0]
v_pk_mul_f32 v[146:147], v[146:147], v[54:55] op_sel_hi:[1,0]
v_pk_mul_f32 v[152:153], v[152:153], v[56:57] op_sel_hi:[1,0]
v_pk_mul_f32 v[154:155], v[154:155], v[56:57] op_sel_hi:[1,0]
v_cvt_pk_bf16_f32 v160, v64, v65
v_cvt_pk_bf16_f32 v161, v66, v67
v_cvt_pk_bf16_f32 v162, v88, v89
v_cvt_pk_bf16_f32 v163, v90, v91
v_cvt_pk_bf16_f32 v164, v112, v113
v_cvt_pk_bf16_f32 v165, v114, v115
v_cvt_pk_bf16_f32 v166, v136, v137
v_cvt_pk_bf16_f32 v167, v138, v139
v_cvt_pk_bf16_f32 v168, v72, v73
v_cvt_pk_bf16_f32 v169, v74, v75
v_cvt_pk_bf16_f32 v170, v96, v97
v_cvt_pk_bf16_f32 v171, v98, v99
v_cvt_pk_bf16_f32 v172, v120, v121
v_cvt_pk_bf16_f32 v173, v122, v123
v_cvt_pk_bf16_f32 v174, v144, v145
v_cvt_pk_bf16_f32 v175, v146, v147
v_cvt_pk_bf16_f32 v176, v80, v81
v_cvt_pk_bf16_f32 v177, v82, v83
v_cvt_pk_bf16_f32 v178, v104, v105
v_cvt_pk_bf16_f32 v179, v106, v107
v_cvt_pk_bf16_f32 v180, v128, v129
v_cvt_pk_bf16_f32 v181, v130, v131
v_cvt_pk_bf16_f32 v182, v152, v153
v_cvt_pk_bf16_f32 v183, v154, v155
s_add_u32 s49, s43, 0
buffer_store_dwordx4 v[160:163], v12, s[32:35], s49 offen sc1
s_add_u32 s49, s43, 1024
buffer_store_dwordx4 v[164:167], v12, s[32:35], s49 offen sc1
s_add_u32 s49, s43, 131072
buffer_store_dwordx4 v[168:171], v12, s[32:35], s49 offen sc1
s_add_u32 s49, s43, 132096
buffer_store_dwordx4 v[172:175], v12, s[32:35], s49 offen sc1
s_add_u32 s49, s43, 262144
buffer_store_dwordx4 v[176:179], v12, s[32:35], s49 offen sc1
s_add_u32 s49, s43, 263168
buffer_store_dwordx4 v[180:183], v12, s[32:35], s49 offen sc1
s_lshl_b32 s43, s14, 2
s_add_u32 s43, s43, s48
s_lshl_b32 s43, s43, 8
s_and_b32 s3, s15, 7
s_lshl_b32 s3, s3, 2
s_add_u32 s43, s43, s3
v_add_u32 v57, s36, v1
v_cmp_eq_u32 vcc, 0, v57
v_mov_b32 v56, 0x10000
v_mov_b32 v59, s43
v_cndmask_b32 v57, v56, v59, vcc
v_mov_b32 v58, s78
s_cmp_ge_u32 s15, 30
s_cbranch_scc0 L_f_cont
s_waitcnt vmcnt(0)
s_barrier
s_movk_i32 s3, 0x2000
buffer_store_dword v58, v57, s[84:87], s3 offen
buffer_store_dword v58, v57, s[84:87], 0 offen sc1
s_branch L_k1_end
L_f_cont:
s_load_dwordx2 s[6:7], s[0:1], 80
s_and_b32 s45, s14, 3
s_mul_i32 s47, s15, 52
s_lshr_b32 s47, s47, 8
s_mul_i32 s48, s47, 5
s_sub_u32 s48, s15, s48
s_add_u32 s49, s47, s48
s_cmp_ge_u32 s49, 6
s_cselect_b32 s43, 6, 0
s_sub_u32 s49, s49, s43
s_mul_i32 s49, s49, 43
s_lshr_b32 s49, s49, 4
s_and_b32 s37, s36, 1
s_lshr_b32 s38, s36, 1
s_lshl_b32 s43, s36, 18
v_add_u32 v4, s43, v12
v_add_u32 v5, 129024, v4
s_lshl_b32 s43, s36, 4
v_add_u32 v40, s43, v3
v_mul_u32_u24 v40, 1280, v40
v_lshlrev_b32 v41, 1, v3
v_xor_b32 v42, v2, v41
v_xor_b32 v43, 8, v42
v_lshlrev_b32 v42, 4, v42
v_lshlrev_b32 v43, 4, v43
v_add_u32 v6, v40, v42
v_add_u32 v7, 4096, v40
v_add_u32 v7, v7, v43
v_add_u32 v8, 8192, v40
v_add_u32 v8, v8, v42
v_add_u32 v9, 12288, v40
v_add_u32 v9, v9, v43
s_mul_i32 s43, s46, 48
s_lshl_b32 s44, s47, 3
s_add_u32 s43, s43, s44
s_lshl_b32 s43, s43, 7
s_lshl_b32 s44, s45, 5
s_add_u32 s43, s43, s44
s_lshl_b32 s43, s43, 10
s_add_u32 s16, s12, s43
s_addc_u32 s17, s13, 0
s_and_b32 s17, s17, 0xffff
s_mov_b32 s18, 1048576
s_mov_b32 s19, 0x20000
s_mul_i32 s43, s45, 1310720
s_lshl_b32 s44, s48, 8
s_add_u32 s43, s43, s44
s_add_u32 s20, s96, s43
s_addc_u32 s21, s97, 0
s_and_b32 s21, s21, 0xffff
s_sub_u32 s22, 5242880, s43
s_mov_b32 s23, 0x20000
s_add_u32 s43, s49, 0
s_and_b32 s43, s43, 15
s_mul_i32 s51, s43, 81920
s_add_u32 m0, s39, 49152
s_nop 0
buffer_load_dwordx4 v6, s[20:23], s51 offen offset:0 lds
buffer_load_dwordx4 v7, s[20:23], s51 offen offset:1024 lds
buffer_load_dwordx4 v8, s[20:23], s51 offen offset:2048 lds
buffer_load_dwordx4 v9, s[20:23], s51 offen offset:3072 lds
s_add_u32 s43, s49, 1
s_and_b32 s43, s43, 15
s_mul_i32 s51, s43, 81920
s_add_u32 m0, s39, 65536
s_nop 0
buffer_load_dwordx4 v6, s[20:23], s51 offen offset:0 lds
buffer_load_dwordx4 v7, s[20:23], s51 offen offset:1024 lds
buffer_load_dwordx4 v8, s[20:23], s51 offen offset:2048 lds
buffer_load_dwordx4 v9, s[20:23], s51 offen offset:3072 lds
s_add_u32 s43, s49, 2
s_and_b32 s43, s43, 15
s_mul_i32 s51, s43, 81920
s_add_u32 m0, s39, 81920
s_nop 0
buffer_load_dwordx4 v6, s[20:23], s51 offen offset:0 lds
buffer_load_dwordx4 v7, s[20:23], s51 offen offset:1024 lds
buffer_load_dwordx4 v8, s[20:23], s51 offen offset:2048 lds
buffer_load_dwordx4 v9, s[20:23], s51 offen offset:3072 lds
s_add_u32 s43, s49, 3
s_and_b32 s43, s43, 15
s_mul_i32 s51, s43, 81920
s_add_u32 m0, s39, 98304
s_nop 0
buffer_load_dwordx4 v6, s[20:23], s51 offen offset:0 lds
buffer_load_dwordx4 v7, s[20:23], s51 offen offset:1024 lds
buffer_load_dwordx4 v8, s[20:23], s51 offen offset:2048 lds
buffer_load_dwordx4 v9, s[20:23], s51 offen offset:3072 lds
s_xor_b32 s43, s45, 0
s_lshl_b32 s44, s37, 2
s_add_u32 s43, s43, s44
s_lshl_b32 s43, s43, 11
v_add_u32 v14, s43, v12
s_xor_b32 s43, s45, 1
s_lshl_b32 s44, s37, 2
s_add_u32 s43, s43, s44
s_lshl_b32 s43, s43, 11
v_add_u32 v15, s43, v12
s_xor_b32 s43, s45, 2
s_lshl_b32 s44, s37, 2
s_add_u32 s43, s43, s44
s_lshl_b32 s43, s43, 11
v_add_u32 v16, s43, v12
s_xor_b32 s43, s45, 3
s_lshl_b32 s44, s37, 2
s_add_u32 s43, s43, s44
s_lshl_b32 s43, s43, 11
v_add_u32 v17, s43, v12
v_lshrrev_b32 v42, 2, v2
v_and_b32 v43, 3, v2
v_lshlrev_b32 v44, 2, v3
v_add_u32 v44, v44, v42
v_lshlrev_b32 v40, 8, v44
v_and_b32 v45, 7, v44
s_lshl_b32 s43, s38, 2
v_xor_b32 v45, s43, v45
v_lshlrev_b32 v45, 5, v45
v_lshlrev_b32 v46, 3, v43
v_add3_u32 v18, v40, v45, v46
v_add_u32 v18, 49152, v18
v_mov_b32 v28, v18
v_xor_b32 v29, 32, v18
v_xor_b32 v30, 64, v18
v_xor_b32 v31, 96, v18
v_add_u32 v32, 65536, v28
v_add_u32 v33, 65536, v29
v_add_u32 v34, 65536, v30
v_add_u32 v35, 65536, v31
v_add_u32 v36, 65536, v14
v_add_u32 v37, 65536, v15
v_add_u32 v38, 65536, v16
v_add_u32 v39, 65536, v17
s_mul_i32 s44, s46, 30
s_add_u32 s44, s44, s15
s_lshl_b32 s43, s44, 18
s_add_u32 s43, s43, 33554432
s_add_u32 s24, s12, s43
s_addc_u32 s25, s13, 0
s_and_b32 s25, s25, 0xffff
s_mov_b32 s26, 262144
s_mov_b32 s27, 0x20000
s_lshl_b32 s42, s44, 8
s_add_u32 s28, s12, 25165824
s_addc_u32 s29, s13, 0
s_and_b32 s29, s29, 0xffff
s_mov_b32 s30, 65536
s_mov_b32 s31, 0x20000
s_waitcnt lgkmcnt(0)
s_mov_b32 s32, s6
s_and_b32 s33, s7, 0xffff
s_mov_b32 s34, 1966080
s_mov_b32 s35, 0x20000
s_waitcnt vmcnt(16)
s_barrier
s_movk_i32 s3, 0x2000
buffer_store_dword v58, v57, s[84:87], s3 offen
buffer_store_dword v58, v57, s[84:87], 0 offen sc1
s_add_u32 s43, s49, 4
s_and_b32 s43, s43, 15
s_mul_i32 s51, s43, 81920
s_add_u32 m0, s39, 114688
s_nop 0
buffer_load_dwordx4 v6, s[20:23], s51 offen offset:0 lds
buffer_load_dwordx4 v7, s[20:23], s51 offen offset:1024 lds
buffer_load_dwordx4 v8, s[20:23], s51 offen offset:2048 lds
buffer_load_dwordx4 v9, s[20:23], s51 offen offset:3072 lds
s_add_u32 s43, s49, 5
s_and_b32 s43, s43, 15
s_mul_i32 s51, s43, 81920
s_add_u32 m0, s39, 131072
s_nop 0
buffer_load_dwordx4 v6, s[20:23], s51 offen offset:0 lds
buffer_load_dwordx4 v7, s[20:23], s51 offen offset:1024 lds
buffer_load_dwordx4 v8, s[20:23], s51 offen offset:2048 lds
buffer_load_dwordx4 v9, s[20:23], s51 offen offset:3072 lds
s_add_u32 s43, s49, 6
s_and_b32 s43, s43, 15
s_mul_i32 s51, s43, 81920
s_add_u32 m0, s39, 147456
s_nop 0
buffer_load_dwordx4 v6, s[20:23], s51 offen offset:0 lds
buffer_load_dwordx4 v7, s[20:23], s51 offen offset:1024 lds
buffer_load_dwordx4 v8, s[20:23], s51 offen offset:2048 lds
buffer_load_dwordx4 v9, s[20:23], s51 offen offset:3072 lds
s_cmp_lg_u32 s36, 0
s_cbranch_scc1 L_f_join1
s_lshl_b32 s43, s47, 7
s_mul_i32 s44, s43, 683
s_lshr_b32 s44, s44, 16
s_lshr_b32 s44, s44, 1
s_add_u32 s43, s43, 127
s_mul_i32 s43, s43, 683
s_lshr_b32 s43, s43, 16
s_lshr_b32 s43, s43, 1
s_lshl_b32 s3, s14, 2
s_add_u32 s44, s44, s3
s_add_u32 s43, s43, s3
s_lshl_b32 s44, s44, 8
s_lshl_b32 s43, s43, 8
v_and_b32 v40, 7, v1
v_lshlrev_b32 v40, 2, v40
v_mov_b32 v41, s44
v_mov_b32 v42, s43
v_cmp_gt_u32 vcc, 8, v1
s_nop 1
v_cndmask_b32 v41, v42, v41, vcc
v_add_u32 v40, v40, v41
s_mov_b32 s44, 0
s_movk_i32 s3, 0x2000
v_mov_b32 v43, 0
L_f_poll1:
buffer_load_dword v42, v40, s[28:31], s3 offen nt
s_and_b32 s43, s44, 3
s_cmp_eq_u32 s43, 3
s_cbranch_scc0 L_f_p1a
buffer_load_dword v43, v40, s[28:31], 0 offen sc1
L_f_p1a:
s_waitcnt vmcnt(0)
v_cmp_eq_u32 vcc, s78, v42
v_cmp_eq_u32 s[4:5], s78, v43
s_nop 1
s_or_b32 s43, vcc_lo, s4
s_and_b32 s43, s43, 0xffff
s_add_u32 s44, s44, 1
s_cmp_eq_u32 s43, 0xffff
s_cbranch_scc1 L_f_join1
s_cmp_lt_u32 s44, 0x40000
s_cbranch_scc1 L_f_poll1
L_f_join1:
s_barrier
s_add_u32 s43, s49, 0
s_and_b32 s43, s43, 15
s_lshl_b32 s50, s43, 11
s_add_u32 m0, s39, 0
s_nop 0
buffer_load_dwordx4 v4, s[16:19], s50 offen offset:0 lds
buffer_load_dwordx4 v4, s[16:19], s50 offen offset:1024 lds
buffer_load_dwordx4 v5, s[16:19], s50 offen offset:2048 lds
buffer_load_dwordx4 v5, s[16:19], s50 offen offset:3072 lds
s_add_u32 s43, s49, 1
s_and_b32 s43, s43, 15
s_lshl_b32 s50, s43, 11
s_add_u32 m0, s39, 16384
s_nop 0
buffer_load_dwordx4 v4, s[16:19], s50 offen offset:0 lds
buffer_load_dwordx4 v4, s[16:19], s50 offen offset:1024 lds
buffer_load_dwordx4 v5, s[16:19], s50 offen offset:2048 lds
buffer_load_dwordx4 v5, s[16:19], s50 offen offset:3072 lds
s_add_u32 s43, s49, 2
s_and_b32 s43, s43, 15
s_lshl_b32 s50, s43, 11
s_add_u32 m0, s39, 32768
s_nop 0
buffer_load_dwordx4 v4, s[16:19], s50 offen offset:0 lds
buffer_load_dwordx4 v4, s[16:19], s50 offen offset:1024 lds
buffer_load_dwordx4 v5, s[16:19], s50 offen offset:2048 lds
buffer_load_dwordx4 v5, s[16:19], s50 offen offset:3072 lds
s_waitcnt vmcnt(8)
s_barrier
ds_read_b64_tr_b16 v[128:129], v28 offset:0
ds_read_b64_tr_b16 v[130:131], v28 offset:4096
ds_read_b64_tr_b16 v[132:133], v29 offset:0
ds_read_b64_tr_b16 v[134:135], v29 offset:4096
ds_read_b64_tr_b16 v[136:137], v30 offset:0
ds_read_b64_tr_b16 v[138:139], v30 offset:4096
ds_read_b64_tr_b16 v[140:141], v31 offset:0
ds_read_b64_tr_b16 v[142:143], v31 offset:4096
ds_read_b128 v[144:147], v14 offset:0
ds_read_b128 v[148:151], v15 offset:0
ds_read_b128 v[152:155], v16 offset:0
ds_read_b128 v[156:159], v17 offset:0
s_waitcnt lgkmcnt(0)
v_mfma_f32_16x16x32_bf16 v[64:67], v[128:131], v[144:147], 0
ds_read_b64_tr_b16 v[160:161], v28 offset:8192
v_mfma_f32_16x16x32_bf16 v[80:83], v[128:131], v[148:151], 0
ds_read_b64_tr_b16 v[162:163], v28 offset:12288
v_mfma_f32_16x16x32_bf16 v[96:99], v[128:131], v[152:155], 0
ds_read_b64_tr_b16 v[164:165], v29 offset:8192
v_mfma_f32_16x16x32_bf16 v[112:115], v[128:131], v[156:159], 0
ds_read_b64_tr_b16 v[166:167], v29 offset:12288
v_mfma_f32_16x16x32_bf16 v[68:71], v[132:135], v[144:147], 0
ds_read_b64_tr_b16 v[168:169], v30 offset:8192
v_mfma_f32_16x16x32_bf16 v[84:87], v[132:135], v[148:151], 0
ds_read_b64_tr_b16 v[170:171], v30 offset:12288
v_mfma_f32_16x16x32_bf16 v[100:103], v[132:135], v[152:155], 0
ds_read_b64_tr_b16 v[172:173], v31 offset:8192
ds_read_b64_tr_b16 v[174:175], v31 offset:12288
v_mfma_f32_16x16x32_bf16 v[116:119], v[132:135], v[156:159], 0
ds_read_b128 v[176:179], v14 offset:1024
v_mfma_f32_16x16x32_bf16 v[72:75], v[136:139], v[144:147], 0
ds_read_b128 v[180:183], v15 offset:1024
v_mfma_f32_16x16x32_bf16 v[88:91], v[136:139], v[148:151], 0
ds_read_b128 v[184:187], v16 offset:1024
v_mfma_f32_16x16x32_bf16 v[104:107], v[136:139], v[152:155], 0
ds_read_b128 v[188:191], v17 offset:1024
v_mfma_f32_16x16x32_bf16 v[120:123], v[136:139], v[156:159], 0
v_mfma_f32_16x16x32_bf16 v[76:79], v[140:143], v[144:147], 0
v_mfma_f32_16x16x32_bf16 v[92:95], v[140:143], v[148:151], 0
v_mfma_f32_16x16x32_bf16 v[108:111], v[140:143], v[152:155], 0
v_mfma_f32_16x16x32_bf16 v[124:127], v[140:143], v[156:159], 0
s_waitcnt lgkmcnt(0)
s_waitcnt vmcnt(4)
s_barrier
v_mfma_f32_16x16x32_bf16 v[64:67], v[160:163], v[176:179], v[64:67]
ds_read_b64_tr_b16 v[128:129], v28 offset:16384
v_mfma_f32_16x16x32_bf16 v[80:83], v[160:163], v[180:183], v[80:83]
ds_read_b64_tr_b16 v[130:131], v28 offset:20480
v_mfma_f32_16x16x32_bf16 v[96:99], v[160:163], v[184:187], v[96:99]
ds_read_b64_tr_b16 v[132:133], v29 offset:16384
v_mfma_f32_16x16x32_bf16 v[112:115], v[160:163], v[188:191], v[112:115]
ds_read_b64_tr_b16 v[134:135], v29 offset:20480
s_add_u32 s43, s49, 3
s_and_b32 s43, s43, 15
s_lshl_b32 s50, s43, 11
s_add_u32 m0, s39, 0
s_nop 0
buffer_load_dwordx4 v4, s[16:19], s50 offen offset:0 lds
v_mfma_f32_16x16x32_bf16 v[68:71], v[164:167], v[176:179], v[68:71]
ds_read_b64_tr_b16 v[136:137], v30 offset:16384
v_mfma_f32_16x16x32_bf16 v[84:87], v[164:167], v[180:183], v[84:87]
ds_read_b64_tr_b16 v[138:139], v30 offset:20480
v_mfma_f32_16x16x32_bf16 v[100:103], v[164:167], v[184:187], v[100:103]
ds_read_b64_tr_b16 v[140:141], v31 offset:16384
ds_read_b64_tr_b16 v[142:143], v31 offset:20480
v_mfma_f32_16x16x32_bf16 v[116:119], v[164:167], v[188:191], v[116:119]
ds_read_b128 v[144:147], v14 offset:16384
buffer_load_dwordx4 v4, s[16:19], s50 offen offset:1024 lds
v_mfma_f32_16x16x32_bf16 v[72:75], v[168:171], v[176:179], v[72:75]
ds_read_b128 v[148:151], v15 offset:16384
v_mfma_f32_16x16x32_bf16 v[88:91], v[168:171], v[180:183], v[88:91]
ds_read_b128 v[152:155], v16 offset:16384
v_mfma_f32_16x16x32_bf16 v[104:107], v[168:171], v[184:187], v[104:107]
ds_read_b128 v[156:159], v17 offset:16384
v_mfma_f32_16x16x32_bf16 v[120:123], v[168:171], v[188:191], v[120:123]
buffer_load_dwordx4 v5, s[16:19], s50 offen offset:2048 lds
v_mfma_f32_16x16x32_bf16 v[76:79], v[172:175], v[176:179], v[76:79]
v_mfma_f32_16x16x32_bf16 v[92:95], v[172:175], v[180:183], v[92:95]
v_mfma_f32_16x16x32_bf16 v[108:111], v[172:175], v[184:187], v[108:111]
v_mfma_f32_16x16x32_bf16 v[124:127], v[172:175], v[188:191], v[124:127]
buffer_load_dwordx4 v5, s[16:19], s50 offen offset:3072 lds
s_waitcnt lgkmcnt(0)
v_mfma_f32_16x16x32_bf16 v[64:67], v[128:131], v[144:147], v[64:67]
ds_read_b64_tr_b16 v[160:161], v28 offset:24576
v_mfma_f32_16x16x32_bf16 v[80:83], v[128:131], v[148:151], v[80:83]
ds_read_b64_tr_b16 v[162:163], v28 offset:28672
v_mfma_f32_16x16x32_bf16 v[96:99], v[128:131], v[152:155], v[96:99]
ds_read_b64_tr_b16 v[164:165], v29 offset:24576
v_mfma_f32_16x16x32_bf16 v[112:115], v[128:131], v[156:159], v[112:115]
ds_read_b64_tr_b16 v[166:167], v29 offset:28672
s_add_u32 s43, s49, 7
s_and_b32 s43, s43, 15
s_mul_i32 s51, s43, 81920
s_add_u32 m0, s39, 49152
s_nop 0
buffer_load_dwordx4 v6, s[20:23], s51 offen offset:0 lds
v_mfma_f32_16x16x32_bf16 v[68:71], v[132:135], v[144:147], v[68:71]
ds_read_b64_tr_b16 v[168:169], v30 offset:24576
v_mfma_f32_16x16x32_bf16 v[84:87], v[132:135], v[148:151], v[84:87]
ds_read_b64_tr_b16 v[170:171], v30 offset:28672
v_mfma_f32_16x16x32_bf16 v[100:103], v[132:135], v[152:155], v[100:103]
ds_read_b64_tr_b16 v[172:173], v31 offset:24576
ds_read_b64_tr_b16 v[174:175], v31 offset:28672
v_mfma_f32_16x16x32_bf16 v[116:119], v[132:135], v[156:159], v[116:119]
ds_read_b128 v[176:179], v14 offset:17408
buffer_load_dwordx4 v7, s[20:23], s51 offen offset:1024 lds
v_mfma_f32_16x16x32_bf16 v[72:75], v[136:139], v[144:147], v[72:75]
ds_read_b128 v[180:183], v15 offset:17408
v_mfma_f32_16x16x32_bf16 v[88:91], v[136:139], v[148:151], v[88:91]
ds_read_b128 v[184:187], v16 offset:17408
v_mfma_f32_16x16x32_bf16 v[104:107], v[136:139], v[152:155], v[104:107]
ds_read_b128 v[188:191], v17 offset:17408
v_mfma_f32_16x16x32_bf16 v[120:123], v[136:139], v[156:159], v[120:123]
buffer_load_dwordx4 v8, s[20:23], s51 offen offset:2048 lds
v_mfma_f32_16x16x32_bf16 v[76:79], v[140:143], v[144:147], v[76:79]
v_mfma_f32_16x16x32_bf16 v[92:95], v[140:143], v[148:151], v[92:95]
v_mfma_f32_16x16x32_bf16 v[108:111], v[140:143], v[152:155], v[108:111]
v_mfma_f32_16x16x32_bf16 v[124:127], v[140:143], v[156:159], v[124:127]
buffer_load_dwordx4 v9, s[20:23], s51 offen offset:3072 lds
s_waitcnt lgkmcnt(0)
s_waitcnt vmcnt(8)
s_barrier
v_mfma_f32_16x16x32_bf16 v[64:67], v[160:163], v[176:179], v[64:67]
ds_read_b64_tr_b16 v[128:129], v28 offset:32768
v_mfma_f32_16x16x32_bf16 v[80:83], v[160:163], v[180:183], v[80:83]
ds_read_b64_tr_b16 v[130:131], v28 offset:36864
v_mfma_f32_16x16x32_bf16 v[96:99], v[160:163], v[184:187], v[96:99]
ds_read_b64_tr_b16 v[132:133], v29 offset:32768
v_mfma_f32_16x16x32_bf16 v[112:115], v[160:163], v[188:191], v[112:115]
ds_read_b64_tr_b16 v[134:135], v29 offset:36864
s_add_u32 s43, s49, 4
s_and_b32 s43, s43, 15
s_lshl_b32 s50, s43, 11
s_add_u32 m0, s39, 16384
s_nop 0
buffer_load_dwordx4 v4, s[16:19], s50 offen offset:0 lds
v_mfma_f32_16x16x32_bf16 v[68:71], v[164:167], v[176:179], v[68:71]
ds_read_b64_tr_b16 v[136:137], v30 offset:32768
v_mfma_f32_16x16x32_bf16 v[84:87], v[164:167], v[180:183], v[84:87]
ds_read_b64_tr_b16 v[138:139], v30 offset:36864
v_mfma_f32_16x16x32_bf16 v[100:103], v[164:167], v[184:187], v[100:103]
ds_read_b64_tr_b16 v[140:141], v31 offset:32768
ds_read_b64_tr_b16 v[142:143], v31 offset:36864
v_mfma_f32_16x16x32_bf16 v[116:119], v[164:167], v[188:191], v[116:119]
ds_read_b128 v[144:147], v14 offset:32768
buffer_load_dwordx4 v4, s[16:19], s50 offen offset:1024 lds
v_mfma_f32_16x16x32_bf16 v[72:75], v[168:171], v[176:179], v[72:75]
ds_read_b128 v[148:151], v15 offset:32768
v_mfma_f32_16x16x32_bf16 v[88:91], v[168:171], v[180:183], v[88:91]
ds_read_b128 v[152:155], v16 offset:32768
v_mfma_f32_16x16x32_bf16 v[104:107], v[168:171], v[184:187], v[104:107]
ds_read_b128 v[156:159], v17 offset:32768
v_mfma_f32_16x16x32_bf16 v[120:123], v[168:171], v[188:191], v[120:123]
buffer_load_dwordx4 v5, s[16:19], s50 offen offset:2048 lds
v_mfma_f32_16x16x32_bf16 v[76:79], v[172:175], v[176:179], v[76:79]
v_mfma_f32_16x16x32_bf16 v[92:95], v[172:175], v[180:183], v[92:95]
v_mfma_f32_16x16x32_bf16 v[108:111], v[172:175], v[184:187], v[108:111]
v_mfma_f32_16x16x32_bf16 v[124:127], v[172:175], v[188:191], v[124:127]
buffer_load_dwordx4 v5, s[16:19], s50 offen offset:3072 lds
s_waitcnt lgkmcnt(0)
v_mfma_f32_16x16x32_bf16 v[64:67], v[128:131], v[144:147], v[64:67]
ds_read_b64_tr_b16 v[160:161], v28 offset:40960
v_mfma_f32_16x16x32_bf16 v[80:83], v[128:131], v[148:151], v[80:83]
ds_read_b64_tr_b16 v[162:163], v28 offset:45056
v_mfma_f32_16x16x32_bf16 v[96:99], v[128:131], v[152:155], v[96:99]
ds_read_b64_tr_b16 v[164:165], v29 offset:40960
v_mfma_f32_16x16x32_bf16 v[112:115], v[128:131], v[156:159], v[112:115]
ds_read_b64_tr_b16 v[166:167], v29 offset:45056
s_add_u32 s43, s49, 8
s_and_b32 s43, s43, 15
s_mul_i32 s51, s43, 81920
s_add_u32 m0, s39, 65536
s_nop 0
buffer_load_dwordx4 v6, s[20:23], s51 offen offset:0 lds
v_mfma_f32_16x16x32_bf16 v[68:71], v[132:135], v[144:147], v[68:71]
ds_read_b64_tr_b16 v[168:169], v30 offset:40960
v_mfma_f32_16x16x32_bf16 v[84:87], v[132:135], v[148:151], v[84:87]
ds_read_b64_tr_b16 v[170:171], v30 offset:45056
v_mfma_f32_16x16x32_bf16 v[100:103], v[132:135], v[152:155], v[100:103]
ds_read_b64_tr_b16 v[172:173], v31 offset:40960
ds_read_b64_tr_b16 v[174:175], v31 offset:45056
v_mfma_f32_16x16x32_bf16 v[116:119], v[132:135], v[156:159], v[116:119]
ds_read_b128 v[176:179], v14 offset:33792
buffer_load_dwordx4 v7, s[20:23], s51 offen offset:1024 lds
v_mfma_f32_16x16x32_bf16 v[72:75], v[136:139], v[144:147], v[72:75]
ds_read_b128 v[180:183], v15 offset:33792
v_mfma_f32_16x16x32_bf16 v[88:91], v[136:139], v[148:151], v[88:91]
ds_read_b128 v[184:187], v16 offset:33792
v_mfma_f32_16x16x32_bf16 v[104:107], v[136:139], v[152:155], v[104:107]
ds_read_b128 v[188:191], v17 offset:33792
v_mfma_f32_16x16x32_bf16 v[120:123], v[136:139], v[156:159], v[120:123]
buffer_load_dwordx4 v8, s[20:23], s51 offen offset:2048 lds
v_mfma_f32_16x16x32_bf16 v[76:79], v[140:143], v[144:147], v[76:79]
v_mfma_f32_16x16x32_bf16 v[92:95], v[140:143], v[148:151], v[92:95]
v_mfma_f32_16x16x32_bf16 v[108:111], v[140:143], v[152:155], v[108:111]
v_mfma_f32_16x16x32_bf16 v[124:127], v[140:143], v[156:159], v[124:127]
buffer_load_dwordx4 v9, s[20:23], s51 offen offset:3072 lds
s_waitcnt lgkmcnt(0)
s_waitcnt vmcnt(12)
s_barrier
v_mfma_f32_16x16x32_bf16 v[64:67], v[160:163], v[176:179], v[64:67]
ds_read_b64_tr_b16 v[128:129], v28 offset:49152
v_mfma_f32_16x16x32_bf16 v[80:83], v[160:163], v[180:183], v[80:83]
ds_read_b64_tr_b16 v[130:131], v28 offset:53248
v_mfma_f32_16x16x32_bf16 v[96:99], v[160:163], v[184:187], v[96:99]
ds_read_b64_tr_b16 v[132:133], v29 offset:49152
v_mfma_f32_16x16x32_bf16 v[112:115], v[160:163], v[188:191], v[112:115]
ds_read_b64_tr_b16 v[134:135], v29 offset:53248
s_add_u32 s43, s49, 5
s_and_b32 s43, s43, 15
s_lshl_b32 s50, s43, 11
s_add_u32 m0, s39, 32768
s_nop 0
buffer_load_dwordx4 v4, s[16:19], s50 offen offset:0 lds
v_mfma_f32_16x16x32_bf16 v[68:71], v[164:167], v[176:179], v[68:71]
ds_read_b64_tr_b16 v[136:137], v30 offset:49152
v_mfma_f32_16x16x32_bf16 v[84:87], v[164:167], v[180:183], v[84:87]
ds_read_b64_tr_b16 v[138:139], v30 offset:53248
v_mfma_f32_16x16x32_bf16 v[100:103], v[164:167], v[184:187], v[100:103]
ds_read_b64_tr_b16 v[140:141], v31 offset:49152
ds_read_b64_tr_b16 v[142:143], v31 offset:53248
v_mfma_f32_16x16x32_bf16 v[116:119], v[164:167], v[188:191], v[116:119]
ds_read_b128 v[144:147], v14 offset:0
buffer_load_dwordx4 v4, s[16:19], s50 offen offset:1024 lds
v_mfma_f32_16x16x32_bf16 v[72:75], v[168:171], v[176:179], v[72:75]
ds_read_b128 v[148:151], v15 offset:0
v_mfma_f32_16x16x32_bf16 v[88:91], v[168:171], v[180:183], v[88:91]
ds_read_b128 v[152:155], v16 offset:0
v_mfma_f32_16x16x32_bf16 v[104:107], v[168:171], v[184:187], v[104:107]
ds_read_b128 v[156:159], v17 offset:0
v_mfma_f32_16x16x32_bf16 v[120:123], v[168:171], v[188:191], v[120:123]
buffer_load_dwordx4 v5, s[16:19], s50 offen offset:2048 lds
v_mfma_f32_16x16x32_bf16 v[76:79], v[172:175], v[176:179], v[76:79]
v_mfma_f32_16x16x32_bf16 v[92:95], v[172:175], v[180:183], v[92:95]
v_mfma_f32_16x16x32_bf16 v[108:111], v[172:175], v[184:187], v[108:111]
v_mfma_f32_16x16x32_bf16 v[124:127], v[172:175], v[188:191], v[124:127]
buffer_load_dwordx4 v5, s[16:19], s50 offen offset:3072 lds
s_waitcnt lgkmcnt(0)
v_mfma_f32_16x16x32_bf16 v[64:67], v[128:131], v[144:147], v[64:67]
ds_read_b64_tr_b16 v[160:161], v28 offset:57344
v_mfma_f32_16x16x32_bf16 v[80:83], v[128:131], v[148:151], v[80:83]
ds_read_b64_tr_b16 v[162:163], v28 offset:61440
v_mfma_f32_16x16x32_bf16 v[96:99], v[128:131], v[152:155], v[96:99]
ds_read_b64_tr_b16 v[164:165], v29 offset:57344
v_mfma_f32_16x16x32_bf16 v[112:115], v[128:131], v[156:159], v[112:115]
ds_read_b64_tr_b16 v[166:167], v29 offset:61440
s_add_u32 s43, s49, 9
s_and_b32 s43, s43, 15
s_mul_i32 s51, s43, 81920
s_add_u32 m0, s39, 81920
s_nop 0
buffer_load_dwordx4 v6, s[20:23], s51 offen offset:0 lds
v_mfma_f32_16x16x32_bf16 v[68:71], v[132:135], v[144:147], v[68:71]
ds_read_b64_tr_b16 v[168:169], v30 offset:57344
v_mfma_f32_16x16x32_bf16 v[84:87], v[132:135], v[148:151], v[84:87]
ds_read_b64_tr_b16 v[170:171], v30 offset:61440
v_mfma_f32_16x16x32_bf16 v[100:103], v[132:135], v[152:155], v[100:103]
ds_read_b64_tr_b16 v[172:173], v31 offset:57344
ds_read_b64_tr_b16 v[174:175], v31 offset:61440
v_mfma_f32_16x16x32_bf16 v[116:119], v[132:135], v[156:159], v[116:119]
ds_read_b128 v[176:179], v14 offset:1024
buffer_load_dwordx4 v7, s[20:23], s51 offen offset:1024 lds
v_mfma_f32_16x16x32_bf16 v[72:75], v[136:139], v[144:147], v[72:75]
ds_read_b128 v[180:183], v15 offset:1024
v_mfma_f32_16x16x32_bf16 v[88:91], v[136:139], v[148:151], v[88:91]
ds_read_b128 v[184:187], v16 offset:1024
v_mfma_f32_16x16x32_bf16 v[104:107], v[136:139], v[152:155], v[104:107]
ds_read_b128 v[188:191], v17 offset:1024
v_mfma_f32_16x16x32_bf16 v[120:123], v[136:139], v[156:159], v[120:123]
buffer_load_dwordx4 v8, s[20:23], s51 offen offset:2048 lds
v_mfma_f32_16x16x32_bf16 v[76:79], v[140:143], v[144:147], v[76:79]
v_mfma_f32_16x16x32_bf16 v[92:95], v[140:143], v[148:151], v[92:95]
v_mfma_f32_16x16x32_bf16 v[108:111], v[140:143], v[152:155], v[108:111]
v_mfma_f32_16x16x32_bf16 v[124:127], v[140:143], v[156:159], v[124:127]
buffer_load_dwordx4 v9, s[20:23], s51 offen offset:3072 lds
s_waitcnt lgkmcnt(0)
s_waitcnt vmcnt(12)
s_barrier
v_mfma_f32_16x16x32_bf16 v[64:67], v[160:163], v[176:179], v[64:67]
ds_read_b64_tr_b16 v[128:129], v32 offset:0
v_mfma_f32_16x16x32_bf16 v[80:83], v[160:163], v[180:183], v[80:83]
ds_read_b64_tr_b16 v[130:131], v32 offset:4096
v_mfma_f32_16x16x32_bf16 v[96:99], v[160:163], v[184:187], v[96:99]
ds_read_b64_tr_b16 v[132:133], v33 offset:0
v_mfma_f32_16x16x32_bf16 v[112:115], v[160:163], v[188:191], v[112:115]
ds_read_b64_tr_b16 v[134:135], v33 offset:4096
s_add_u32 s43, s49, 6
s_and_b32 s43, s43, 15
s_lshl_b32 s50, s43, 11
s_add_u32 m0, s39, 0
s_nop 0
buffer_load_dwordx4 v4, s[16:19], s50 offen offset:0 lds
v_mfma_f32_16x16x32_bf16 v[68:71], v[164:167], v[176:179], v[68:71]
ds_read_b64_tr_b16 v[136:137], v34 offset:0
v_mfma_f32_16x16x32_bf16 v[84:87], v[164:167], v[180:183], v[84:87]
ds_read_b64_tr_b16 v[138:139], v34 offset:4096
v_mfma_f32_16x16x32_bf16 v[100:103], v[164:167], v[184:187], v[100:103]
ds_read_b64_tr_b16 v[140:141], v35 offset:0
ds_read_b64_tr_b16 v[142:143], v35 offset:4096
v_mfma_f32_16x16x32_bf16 v[116:119], v[164:167], v[188:191], v[116:119]
ds_read_b128 v[144:147], v14 offset:16384
buffer_load_dwordx4 v4, s[16:19], s50 offen offset:1024 lds
v_mfma_f32_16x16x32_bf16 v[72:75], v[168:171], v[176:179], v[72:75]
ds_read_b128 v[148:151], v15 offset:16384
v_mfma_f32_16x16x32_bf16 v[88:91], v[168:171], v[180:183], v[88:91]
ds_read_b128 v[152:155], v16 offset:16384
v_mfma_f32_16x16x32_bf16 v[104:107], v[168:171], v[184:187], v[104:107]
ds_read_b128 v[156:159], v17 offset:16384
v_mfma_f32_16x16x32_bf16 v[120:123], v[168:171], v[188:191], v[120:123]
buffer_load_dwordx4 v5, s[16:19], s50 offen offset:2048 lds
v_mfma_f32_16x16x32_bf16 v[76:79], v[172:175], v[176:179], v[76:79]
v_mfma_f32_16x16x32_bf16 v[92:95], v[172:175], v[180:183], v[92:95]
v_mfma_f32_16x16x32_bf16 v[108:111], v[172:175], v[184:187], v[108:111]
v_mfma_f32_16x16x32_bf16 v[124:127], v[172:175], v[188:191], v[124:127]
buffer_load_dwordx4 v5, s[16:19], s50 offen offset:3072 lds
s_waitcnt lgkmcnt(0)
v_mfma_f32_16x16x32_bf16 v[64:67], v[128:131], v[144:147], v[64:67]
ds_read_b64_tr_b16 v[160:161], v32 offset:8192
v_mfma_f32_16x16x32_bf16 v[80:83], v[128:131], v[148:151], v[80:83]
ds_read_b64_tr_b16 v[162:163], v32 offset:12288
v_mfma_f32_16x16x32_bf16 v[96:99], v[128:131], v[152:155], v[96:99]
ds_read_b64_tr_b16 v[164:165], v33 offset:8192
v_mfma_f32_16x16x32_bf16 v[112:115], v[128:131], v[156:159], v[112:115]
ds_read_b64_tr_b16 v[166:167], v33 offset:12288
s_add_u32 s43, s49, 10
s_and_b32 s43, s43, 15
s_mul_i32 s51, s43, 81920
s_add_u32 m0, s39, 98304
s_nop 0
buffer_load_dwordx4 v6, s[20:23], s51 offen offset:0 lds
v_mfma_f32_16x16x32_bf16 v[68:71], v[132:135], v[144:147], v[68:71]
ds_read_b64_tr_b16 v[168:169], v34 offset:8192
v_mfma_f32_16x16x32_bf16 v[84:87], v[132:135], v[148:151], v[84:87]
ds_read_b64_tr_b16 v[170:171], v34 offset:12288
v_mfma_f32_16x16x32_bf16 v[100:103], v[132:135], v[152:155], v[100:103]
ds_read_b64_tr_b16 v[172:173], v35 offset:8192
ds_read_b64_tr_b16 v[174:175], v35 offset:12288
v_mfma_f32_16x16x32_bf16 v[116:119], v[132:135], v[156:159], v[116:119]
ds_read_b128 v[176:179], v14 offset:17408
buffer_load_dwordx4 v7, s[20:23], s51 offen offset:1024 lds
v_mfma_f32_16x16x32_bf16 v[72:75], v[136:139], v[144:147], v[72:75]
ds_read_b128 v[180:183], v15 offset:17408
v_mfma_f32_16x16x32_bf16 v[88:91], v[136:139], v[148:151], v[88:91]
ds_read_b128 v[184:187], v16 offset:17408
v_mfma_f32_16x16x32_bf16 v[104:107], v[136:139], v[152:155], v[104:107]
ds_read_b128 v[188:191], v17 offset:17408
v_mfma_f32_16x16x32_bf16 v[120:123], v[136:139], v[156:159], v[120:123]
buffer_load_dwordx4 v8, s[20:23], s51 offen offset:2048 lds
v_mfma_f32_16x16x32_bf16 v[76:79], v[140:143], v[144:147], v[76:79]
v_mfma_f32_16x16x32_bf16 v[92:95], v[140:143], v[148:151], v[92:95]
v_mfma_f32_16x16x32_bf16 v[108:111], v[140:143], v[152:155], v[108:111]
v_mfma_f32_16x16x32_bf16 v[124:127], v[140:143], v[156:159], v[124:127]
buffer_load_dwordx4 v9, s[20:23], s51 offen offset:3072 lds
s_waitcnt lgkmcnt(0)
s_waitcnt vmcnt(12)
s_barrier
v_mfma_f32_16x16x32_bf16 v[64:67], v[160:163], v[176:179], v[64:67]
ds_read_b64_tr_b16 v[128:129], v32 offset:16384
v_mfma_f32_16x16x32_bf16 v[80:83], v[160:163], v[180:183], v[80:83]
ds_read_b64_tr_b16 v[130:131], v32 offset:20480
v_mfma_f32_16x16x32_bf16 v[96:99], v[160:163], v[184:187], v[96:99]
ds_read_b64_tr_b16 v[132:133], v33 offset:16384
v_mfma_f32_16x16x32_bf16 v[112:115], v[160:163], v[188:191], v[112:115]
ds_read_b64_tr_b16 v[134:135], v33 offset:20480
s_add_u32 s43, s49, 7
s_and_b32 s43, s43, 15
s_lshl_b32 s50, s43, 11
s_add_u32 m0, s39, 16384
s_nop 0
buffer_load_dwordx4 v4, s[16:19], s50 offen offset:0 lds
v_mfma_f32_16x16x32_bf16 v[68:71], v[164:167], v[176:179], v[68:71]
ds_read_b64_tr_b16 v[136:137], v34 offset:16384
v_mfma_f32_16x16x32_bf16 v[84:87], v[164:167], v[180:183], v[84:87]
ds_read_b64_tr_b16 v[138:139], v34 offset:20480
v_mfma_f32_16x16x32_bf16 v[100:103], v[164:167], v[184:187], v[100:103]
ds_read_b64_tr_b16 v[140:141], v35 offset:16384
ds_read_b64_tr_b16 v[142:143], v35 offset:20480
v_mfma_f32_16x16x32_bf16 v[116:119], v[164:167], v[188:191], v[116:119]
ds_read_b128 v[144:147], v14 offset:32768
buffer_load_dwordx4 v4, s[16:19], s50 offen offset:1024 lds
v_mfma_f32_16x16x32_bf16 v[72:75], v[168:171], v[176:179], v[72:75]
ds_read_b128 v[148:151], v15 offset:32768
v_mfma_f32_16x16x32_bf16 v[88:91], v[168:171], v[180:183], v[88:91]
ds_read_b128 v[152:155], v16 offset:32768
v_mfma_f32_16x16x32_bf16 v[104:107], v[168:171], v[184:187], v[104:107]
ds_read_b128 v[156:159], v17 offset:32768
v_mfma_f32_16x16x32_bf16 v[120:123], v[168:171], v[188:191], v[120:123]
buffer_load_dwordx4 v5, s[16:19], s50 offen offset:2048 lds
v_mfma_f32_16x16x32_bf16 v[76:79], v[172:175], v[176:179], v[76:79]
v_mfma_f32_16x16x32_bf16 v[92:95], v[172:175], v[180:183], v[92:95]
v_mfma_f32_16x16x32_bf16 v[108:111], v[172:175], v[184:187], v[108:111]
v_mfma_f32_16x16x32_bf16 v[124:127], v[172:175], v[188:191], v[124:127]
buffer_load_dwordx4 v5, s[16:19], s50 offen offset:3072 lds
s_waitcnt lgkmcnt(0)
v_mfma_f32_16x16x32_bf16 v[64:67], v[128:131], v[144:147], v[64:67]
ds_read_b64_tr_b16 v[160:161], v32 offset:24576
v_mfma_f32_16x16x32_bf16 v[80:83], v[128:131], v[148:151], v[80:83]
ds_read_b64_tr_b16 v[162:163], v32 offset:28672
v_mfma_f32_16x16x32_bf16 v[96:99], v[128:131], v[152:155], v[96:99]
ds_read_b64_tr_b16 v[164:165], v33 offset:24576
v_mfma_f32_16x16x32_bf16 v[112:115], v[128:131], v[156:159], v[112:115]
ds_read_b64_tr_b16 v[166:167], v33 offset:28672
s_add_u32 s43, s49, 11
s_and_b32 s43, s43, 15
s_mul_i32 s51, s43, 81920
s_add_u32 m0, s39, 114688
s_nop 0
buffer_load_dwordx4 v6, s[20:23], s51 offen offset:0 lds
v_mfma_f32_16x16x32_bf16 v[68:71], v[132:135], v[144:147], v[68:71]
ds_read_b64_tr_b16 v[168:169], v34 offset:24576
v_mfma_f32_16x16x32_bf16 v[84:87], v[132:135], v[148:151], v[84:87]
ds_read_b64_tr_b16 v[170:171], v34 offset:28672
v_mfma_f32_16x16x32_bf16 v[100:103], v[132:135], v[152:155], v[100:103]
ds_read_b64_tr_b16 v[172:173], v35 offset:24576
ds_read_b64_tr_b16 v[174:175], v35 offset:28672
v_mfma_f32_16x16x32_bf16 v[116:119], v[132:135], v[156:159], v[116:119]
ds_read_b128 v[176:179], v14 offset:33792
buffer_load_dwordx4 v7, s[20:23], s51 offen offset:1024 lds
v_mfma_f32_16x16x32_bf16 v[72:75], v[136:139], v[144:147], v[72:75]
ds_read_b128 v[180:183], v15 offset:33792
v_mfma_f32_16x16x32_bf16 v[88:91], v[136:139], v[148:151], v[88:91]
ds_read_b128 v[184:187], v16 offset:33792
v_mfma_f32_16x16x32_bf16 v[104:107], v[136:139], v[152:155], v[104:107]
ds_read_b128 v[188:191], v17 offset:33792
v_mfma_f32_16x16x32_bf16 v[120:123], v[136:139], v[156:159], v[120:123]
buffer_load_dwordx4 v8, s[20:23], s51 offen offset:2048 lds
v_mfma_f32_16x16x32_bf16 v[76:79], v[140:143], v[144:147], v[76:79]
v_mfma_f32_16x16x32_bf16 v[92:95], v[140:143], v[148:151], v[92:95]
v_mfma_f32_16x16x32_bf16 v[108:111], v[140:143], v[152:155], v[108:111]
v_mfma_f32_16x16x32_bf16 v[124:127], v[140:143], v[156:159], v[124:127]
buffer_load_dwordx4 v9, s[20:23], s51 offen offset:3072 lds
s_waitcnt lgkmcnt(0)
s_waitcnt vmcnt(12)
s_barrier
v_mfma_f32_16x16x32_bf16 v[64:67], v[160:163], v[176:179], v[64:67]
ds_read_b64_tr_b16 v[128:129], v32 offset:32768
v_mfma_f32_16x16x32_bf16 v[80:83], v[160:163], v[180:183], v[80:83]
ds_read_b64_tr_b16 v[130:131], v32 offset:36864
v_mfma_f32_16x16x32_bf16 v[96:99], v[160:163], v[184:187], v[96:99]
ds_read_b64_tr_b16 v[132:133], v33 offset:32768
v_mfma_f32_16x16x32_bf16 v[112:115], v[160:163], v[188:191], v[112:115]
ds_read_b64_tr_b16 v[134:135], v33 offset:36864
s_add_u32 s43, s49, 8
s_and_b32 s43, s43, 15
s_lshl_b32 s50, s43, 11
s_add_u32 m0, s39, 32768
s_nop 0
buffer_load_dwordx4 v4, s[16:19], s50 offen offset:0 lds
v_mfma_f32_16x16x32_bf16 v[68:71], v[164:167], v[176:179], v[68:71]
ds_read_b64_tr_b16 v[136:137], v34 offset:32768
v_mfma_f32_16x16x32_bf16 v[84:87], v[164:167], v[180:183], v[84:87]
ds_read_b64_tr_b16 v[138:139], v34 offset:36864
v_mfma_f32_16x16x32_bf16 v[100:103], v[164:167], v[184:187], v[100:103]
ds_read_b64_tr_b16 v[140:141], v35 offset:32768
ds_read_b64_tr_b16 v[142:143], v35 offset:36864
v_mfma_f32_16x16x32_bf16 v[116:119], v[164:167], v[188:191], v[116:119]
ds_read_b128 v[144:147], v14 offset:0
buffer_load_dwordx4 v4, s[16:19], s50 offen offset:1024 lds
v_mfma_f32_16x16x32_bf16 v[72:75], v[168:171], v[176:179], v[72:75]
ds_read_b128 v[148:151], v15 offset:0
v_mfma_f32_16x16x32_bf16 v[88:91], v[168:171], v[180:183], v[88:91]
ds_read_b128 v[152:155], v16 offset:0
v_mfma_f32_16x16x32_bf16 v[104:107], v[168:171], v[184:187], v[104:107]
ds_read_b128 v[156:159], v17 offset:0
v_mfma_f32_16x16x32_bf16 v[120:123], v[168:171], v[188:191], v[120:123]
buffer_load_dwordx4 v5, s[16:19], s50 offen offset:2048 lds
v_mfma_f32_16x16x32_bf16 v[76:79], v[172:175], v[176:179], v[76:79]
v_mfma_f32_16x16x32_bf16 v[92:95], v[172:175], v[180:183], v[92:95]
v_mfma_f32_16x16x32_bf16 v[108:111], v[172:175], v[184:187], v[108:111]
v_mfma_f32_16x16x32_bf16 v[124:127], v[172:175], v[188:191], v[124:127]
buffer_load_dwordx4 v5, s[16:19], s50 offen offset:3072 lds
s_waitcnt lgkmcnt(0)
v_mfma_f32_16x16x32_bf16 v[64:67], v[128:131], v[144:147], v[64:67]
ds_read_b64_tr_b16 v[160:161], v32 offset:40960
v_mfma_f32_16x16x32_bf16 v[80:83], v[128:131], v[148:151], v[80:83]
ds_read_b64_tr_b16 v[162:163], v32 offset:45056
v_mfma_f32_16x16x32_bf16 v[96:99], v[128:131], v[152:155], v[96:99]
ds_read_b64_tr_b16 v[164:165], v33 offset:40960
v_mfma_f32_16x16x32_bf16 v[112:115], v[128:131], v[156:159], v[112:115]
ds_read_b64_tr_b16 v[166:167], v33 offset:45056
s_add_u32 s43, s49, 12
s_and_b32 s43, s43, 15
s_mul_i32 s51, s43, 81920
s_add_u32 m0, s39, 131072
s_nop 0
buffer_load_dwordx4 v6, s[20:23], s51 offen offset:0 lds
v_mfma_f32_16x16x32_bf16 v[68:71], v[132:135], v[144:147], v[68:71]
ds_read_b64_tr_b16 v[168:169], v34 offset:40960
v_mfma_f32_16x16x32_bf16 v[84:87], v[132:135], v[148:151], v[84:87]
ds_read_b64_tr_b16 v[170:171], v34 offset:45056
v_mfma_f32_16x16x32_bf16 v[100:103], v[132:135], v[152:155], v[100:103]
ds_read_b64_tr_b16 v[172:173], v35 offset:40960
ds_read_b64_tr_b16 v[174:175], v35 offset:45056
v_mfma_f32_16x16x32_bf16 v[116:119], v[132:135], v[156:159], v[116:119]
ds_read_b128 v[176:179], v14 offset:1024
buffer_load_dwordx4 v7, s[20:23], s51 offen offset:1024 lds
v_mfma_f32_16x16x32_bf16 v[72:75], v[136:139], v[144:147], v[72:75]
ds_read_b128 v[180:183], v15 offset:1024
v_mfma_f32_16x16x32_bf16 v[88:91], v[136:139], v[148:151], v[88:91]
ds_read_b128 v[184:187], v16 offset:1024
v_mfma_f32_16x16x32_bf16 v[104:107], v[136:139], v[152:155], v[104:107]
ds_read_b128 v[188:191], v17 offset:1024
v_mfma_f32_16x16x32_bf16 v[120:123], v[136:139], v[156:159], v[120:123]
buffer_load_dwordx4 v8, s[20:23], s51 offen offset:2048 lds
v_mfma_f32_16x16x32_bf16 v[76:79], v[140:143], v[144:147], v[76:79]
v_mfma_f32_16x16x32_bf16 v[92:95], v[140:143], v[148:151], v[92:95]
v_mfma_f32_16x16x32_bf16 v[108:111], v[140:143], v[152:155], v[108:111]
v_mfma_f32_16x16x32_bf16 v[124:127], v[140:143], v[156:159], v[124:127]
buffer_load_dwordx4 v9, s[20:23], s51 offen offset:3072 lds
s_waitcnt lgkmcnt(0)
s_waitcnt vmcnt(12)
s_barrier
v_mfma_f32_16x16x32_bf16 v[64:67], v[160:163], v[176:179], v[64:67]
ds_read_b64_tr_b16 v[128:129], v28 offset:0
v_mfma_f32_16x16x32_bf16 v[80:83], v[160:163], v[180:183], v[80:83]
ds_read_b64_tr_b16 v[130:131], v28 offset:4096
v_mfma_f32_16x16x32_bf16 v[96:99], v[160:163], v[184:187], v[96:99]
ds_read_b64_tr_b16 v[132:133], v29 offset:0
v_mfma_f32_16x16x32_bf16 v[112:115], v[160:163], v[188:191], v[112:115]
ds_read_b64_tr_b16 v[134:135], v29 offset:4096
s_add_u32 s43, s49, 9
s_and_b32 s43, s43, 15
s_lshl_b32 s50, s43, 11
s_add_u32 m0, s39, 0
s_nop 0
buffer_load_dwordx4 v4, s[16:19], s50 offen offset:0 lds
v_mfma_f32_16x16x32_bf16 v[68:71], v[164:167], v[176:179], v[68:71]
ds_read_b64_tr_b16 v[136:137], v30 offset:0
v_mfma_f32_16x16x32_bf16 v[84:87], v[164:167], v[180:183], v[84:87]
ds_read_b64_tr_b16 v[138:139], v30 offset:4096
v_mfma_f32_16x16x32_bf16 v[100:103], v[164:167], v[184:187], v[100:103]
ds_read_b64_tr_b16 v[140:141], v31 offset:0
ds_read_b64_tr_b16 v[142:143], v31 offset:4096
v_mfma_f32_16x16x32_bf16 v[116:119], v[164:167], v[188:191], v[116:119]
ds_read_b128 v[144:147], v14 offset:16384
buffer_load_dwordx4 v4, s[16:19], s50 offen offset:1024 lds
v_mfma_f32_16x16x32_bf16 v[72:75], v[168:171], v[176:179], v[72:75]
ds_read_b128 v[148:151], v15 offset:16384
v_mfma_f32_16x16x32_bf16 v[88:91], v[168:171], v[180:183], v[88:91]
ds_read_b128 v[152:155], v16 offset:16384
v_mfma_f32_16x16x32_bf16 v[104:107], v[168:171], v[184:187], v[104:107]
ds_read_b128 v[156:159], v17 offset:16384
v_mfma_f32_16x16x32_bf16 v[120:123], v[168:171], v[188:191], v[120:123]
buffer_load_dwordx4 v5, s[16:19], s50 offen offset:2048 lds
v_mfma_f32_16x16x32_bf16 v[76:79], v[172:175], v[176:179], v[76:79]
v_mfma_f32_16x16x32_bf16 v[92:95], v[172:175], v[180:183], v[92:95]
v_mfma_f32_16x16x32_bf16 v[108:111], v[172:175], v[184:187], v[108:111]
v_mfma_f32_16x16x32_bf16 v[124:127], v[172:175], v[188:191], v[124:127]
buffer_load_dwordx4 v5, s[16:19], s50 offen offset:3072 lds
s_waitcnt lgkmcnt(0)
v_mfma_f32_16x16x32_bf16 v[64:67], v[128:131], v[144:147], v[64:67]
ds_read_b64_tr_b16 v[160:161], v28 offset:8192
v_mfma_f32_16x16x32_bf16 v[80:83], v[128:131], v[148:151], v[80:83]
ds_read_b64_tr_b16 v[162:163], v28 offset:12288
v_mfma_f32_16x16x32_bf16 v[96:99], v[128:131], v[152:155], v[96:99]
ds_read_b64_tr_b16 v[164:165], v29 offset:8192
v_mfma_f32_16x16x32_bf16 v[112:115], v[128:131], v[156:159], v[112:115]
ds_read_b64_tr_b16 v[166:167], v29 offset:12288
s_add_u32 s43, s49, 13
s_and_b32 s43, s43, 15
s_mul_i32 s51, s43, 81920
s_add_u32 m0, s39, 147456
s_nop 0
buffer_load_dwordx4 v6, s[20:23], s51 offen offset:0 lds
v_mfma_f32_16x16x32_bf16 v[68:71], v[132:135], v[144:147], v[68:71]
ds_read_b64_tr_b16 v[168:169], v30 offset:8192
v_mfma_f32_16x16x32_bf16 v[84:87], v[132:135], v[148:151], v[84:87]
ds_read_b64_tr_b16 v[170:171], v30 offset:12288
v_mfma_f32_16x16x32_bf16 v[100:103], v[132:135], v[152:155], v[100:103]
ds_read_b64_tr_b16 v[172:173], v31 offset:8192
ds_read_b64_tr_b16 v[174:175], v31 offset:12288
v_mfma_f32_16x16x32_bf16 v[116:119], v[132:135], v[156:159], v[116:119]
ds_read_b128 v[176:179], v14 offset:17408
buffer_load_dwordx4 v7, s[20:23], s51 offen offset:1024 lds
v_mfma_f32_16x16x32_bf16 v[72:75], v[136:139], v[144:147], v[72:75]
ds_read_b128 v[180:183], v15 offset:17408
v_mfma_f32_16x16x32_bf16 v[88:91], v[136:139], v[148:151], v[88:91]
ds_read_b128 v[184:187], v16 offset:17408
v_mfma_f32_16x16x32_bf16 v[104:107], v[136:139], v[152:155], v[104:107]
ds_read_b128 v[188:191], v17 offset:17408
v_mfma_f32_16x16x32_bf16 v[120:123], v[136:139], v[156:159], v[120:123]
buffer_load_dwordx4 v8, s[20:23], s51 offen offset:2048 lds
v_mfma_f32_16x16x32_bf16 v[76:79], v[140:143], v[144:147], v[76:79]
v_mfma_f32_16x16x32_bf16 v[92:95], v[140:143], v[148:151], v[92:95]
v_mfma_f32_16x16x32_bf16 v[108:111], v[140:143], v[152:155], v[108:111]
v_mfma_f32_16x16x32_bf16 v[124:127], v[140:143], v[156:159], v[124:127]
buffer_load_dwordx4 v9, s[20:23], s51 offen offset:3072 lds
s_waitcnt lgkmcnt(0)
s_waitcnt vmcnt(12)
s_barrier
v_mfma_f32_16x16x32_bf16 v[64:67], v[160:163], v[176:179], v[64:67]
ds_read_b64_tr_b16 v[128:129], v28 offset:16384
v_mfma_f32_16x16x32_bf16 v[80:83], v[160:163], v[180:183], v[80:83]
ds_read_b64_tr_b16 v[130:131], v28 offset:20480
v_mfma_f32_16x16x32_bf16 v[96:99], v[160:163], v[184:187], v[96:99]
ds_read_b64_tr_b16 v[132:133], v29 offset:16384
v_mfma_f32_16x16x32_bf16 v[112:115], v[160:163], v[188:191], v[112:115]
ds_read_b64_tr_b16 v[134:135], v29 offset:20480
s_add_u32 s43, s49, 10
s_and_b32 s43, s43, 15
s_lshl_b32 s50, s43, 11
s_add_u32 m0, s39, 16384
s_nop 0
buffer_load_dwordx4 v4, s[16:19], s50 offen offset:0 lds
v_mfma_f32_16x16x32_bf16 v[68:71], v[164:167], v[176:179], v[68:71]
ds_read_b64_tr_b16 v[136:137], v30 offset:16384
v_mfma_f32_16x16x32_bf16 v[84:87], v[164:167], v[180:183], v[84:87]
ds_read_b64_tr_b16 v[138:139], v30 offset:20480
v_mfma_f32_16x16x32_bf16 v[100:103], v[164:167], v[184:187], v[100:103]
ds_read_b64_tr_b16 v[140:141], v31 offset:16384
ds_read_b64_tr_b16 v[142:143], v31 offset:20480
v_mfma_f32_16x16x32_bf16 v[116:119], v[164:167], v[188:191], v[116:119]
ds_read_b128 v[144:147], v14 offset:32768
buffer_load_dwordx4 v4, s[16:19], s50 offen offset:1024 lds
v_mfma_f32_16x16x32_bf16 v[72:75], v[168:171], v[176:179], v[72:75]
ds_read_b128 v[148:151], v15 offset:32768
v_mfma_f32_16x16x32_bf16 v[88:91], v[168:171], v[180:183], v[88:91]
ds_read_b128 v[152:155], v16 offset:32768
v_mfma_f32_16x16x32_bf16 v[104:107], v[168:171], v[184:187], v[104:107]
ds_read_b128 v[156:159], v17 offset:32768
v_mfma_f32_16x16x32_bf16 v[120:123], v[168:171], v[188:191], v[120:123]
buffer_load_dwordx4 v5, s[16:19], s50 offen offset:2048 lds
v_mfma_f32_16x16x32_bf16 v[76:79], v[172:175], v[176:179], v[76:79]
v_mfma_f32_16x16x32_bf16 v[92:95], v[172:175], v[180:183], v[92:95]
v_mfma_f32_16x16x32_bf16 v[108:111], v[172:175], v[184:187], v[108:111]
v_mfma_f32_16x16x32_bf16 v[124:127], v[172:175], v[188:191], v[124:127]
buffer_load_dwordx4 v5, s[16:19], s50 offen offset:3072 lds
s_waitcnt lgkmcnt(0)
v_mfma_f32_16x16x32_bf16 v[64:67], v[128:131], v[144:147], v[64:67]
ds_read_b64_tr_b16 v[160:161], v28 offset:24576
v_mfma_f32_16x16x32_bf16 v[80:83], v[128:131], v[148:151], v[80:83]
ds_read_b64_tr_b16 v[162:163], v28 offset:28672
v_mfma_f32_16x16x32_bf16 v[96:99], v[128:131], v[152:155], v[96:99]
ds_read_b64_tr_b16 v[164:165], v29 offset:24576
v_mfma_f32_16x16x32_bf16 v[112:115], v[128:131], v[156:159], v[112:115]
ds_read_b64_tr_b16 v[166:167], v29 offset:28672
s_add_u32 s43, s49, 14
s_and_b32 s43, s43, 15
s_mul_i32 s51, s43, 81920
s_add_u32 m0, s39, 49152
s_nop 0
buffer_load_dwordx4 v6, s[20:23], s51 offen offset:0 lds
v_mfma_f32_16x16x32_bf16 v[68:71], v[132:135], v[144:147], v[68:71]
ds_read_b64_tr_b16 v[168:169], v30 offset:24576
v_mfma_f32_16x16x32_bf16 v[84:87], v[132:135], v[148:151], v[84:87]
ds_read_b64_tr_b16 v[170:171], v30 offset:28672
v_mfma_f32_16x16x32_bf16 v[100:103], v[132:135], v[152:155], v[100:103]
ds_read_b64_tr_b16 v[172:173], v31 offset:24576
ds_read_b64_tr_b16 v[174:175], v31 offset:28672
v_mfma_f32_16x16x32_bf16 v[116:119], v[132:135], v[156:159], v[116:119]
ds_read_b128 v[176:179], v14 offset:33792
buffer_load_dwordx4 v7, s[20:23], s51 offen offset:1024 lds
v_mfma_f32_16x16x32_bf16 v[72:75], v[136:139], v[144:147], v[72:75]
ds_read_b128 v[180:183], v15 offset:33792
v_mfma_f32_16x16x32_bf16 v[88:91], v[136:139], v[148:151], v[88:91]
ds_read_b128 v[184:187], v16 offset:33792
v_mfma_f32_16x16x32_bf16 v[104:107], v[136:139], v[152:155], v[104:107]
ds_read_b128 v[188:191], v17 offset:33792
v_mfma_f32_16x16x32_bf16 v[120:123], v[136:139], v[156:159], v[120:123]
buffer_load_dwordx4 v8, s[20:23], s51 offen offset:2048 lds
v_mfma_f32_16x16x32_bf16 v[76:79], v[140:143], v[144:147], v[76:79]
v_mfma_f32_16x16x32_bf16 v[92:95], v[140:143], v[148:151], v[92:95]
v_mfma_f32_16x16x32_bf16 v[108:111], v[140:143], v[152:155], v[108:111]
v_mfma_f32_16x16x32_bf16 v[124:127], v[140:143], v[156:159], v[124:127]
buffer_load_dwordx4 v9, s[20:23], s51 offen offset:3072 lds
s_waitcnt lgkmcnt(0)
s_waitcnt vmcnt(12)
s_barrier
v_mfma_f32_16x16x32_bf16 v[64:67], v[160:163], v[176:179], v[64:67]
ds_read_b64_tr_b16 v[128:129], v28 offset:32768
v_mfma_f32_16x16x32_bf16 v[80:83], v[160:163], v[180:183], v[80:83]
ds_read_b64_tr_b16 v[130:131], v28 offset:36864
v_mfma_f32_16x16x32_bf16 v[96:99], v[160:163], v[184:187], v[96:99]
ds_read_b64_tr_b16 v[132:133], v29 offset:32768
v_mfma_f32_16x16x32_bf16 v[112:115], v[160:163], v[188:191], v[112:115]
ds_read_b64_tr_b16 v[134:135], v29 offset:36864
s_add_u32 s43, s49, 11
s_and_b32 s43, s43, 15
s_lshl_b32 s50, s43, 11
s_add_u32 m0, s39, 32768
s_nop 0
buffer_load_dwordx4 v4, s[16:19], s50 offen offset:0 lds
v_mfma_f32_16x16x32_bf16 v[68:71], v[164:167], v[176:179], v[68:71]
ds_read_b64_tr_b16 v[136:137], v30 offset:32768
v_mfma_f32_16x16x32_bf16 v[84:87], v[164:167], v[180:183], v[84:87]
ds_read_b64_tr_b16 v[138:139], v30 offset:36864
v_mfma_f32_16x16x32_bf16 v[100:103], v[164:167], v[184:187], v[100:103]
ds_read_b64_tr_b16 v[140:141], v31 offset:32768
ds_read_b64_tr_b16 v[142:143], v31 offset:36864
v_mfma_f32_16x16x32_bf16 v[116:119], v[164:167], v[188:191], v[116:119]
ds_read_b128 v[144:147], v14 offset:0
buffer_load_dwordx4 v4, s[16:19], s50 offen offset:1024 lds
v_mfma_f32_16x16x32_bf16 v[72:75], v[168:171], v[176:179], v[72:75]
ds_read_b128 v[148:151], v15 offset:0
v_mfma_f32_16x16x32_bf16 v[88:91], v[168:171], v[180:183], v[88:91]
ds_read_b128 v[152:155], v16 offset:0
v_mfma_f32_16x16x32_bf16 v[104:107], v[168:171], v[184:187], v[104:107]
ds_read_b128 v[156:159], v17 offset:0
v_mfma_f32_16x16x32_bf16 v[120:123], v[168:171], v[188:191], v[120:123]
buffer_load_dwordx4 v5, s[16:19], s50 offen offset:2048 lds
v_mfma_f32_16x16x32_bf16 v[76:79], v[172:175], v[176:179], v[76:79]
v_mfma_f32_16x16x32_bf16 v[92:95], v[172:175], v[180:183], v[92:95]
v_mfma_f32_16x16x32_bf16 v[108:111], v[172:175], v[184:187], v[108:111]
v_mfma_f32_16x16x32_bf16 v[124:127], v[172:175], v[188:191], v[124:127]
buffer_load_dwordx4 v5, s[16:19], s50 offen offset:3072 lds
s_waitcnt lgkmcnt(0)
v_mfma_f32_16x16x32_bf16 v[64:67], v[128:131], v[144:147], v[64:67]
ds_read_b64_tr_b16 v[160:161], v28 offset:40960
v_mfma_f32_16x16x32_bf16 v[80:83], v[128:131], v[148:151], v[80:83]
ds_read_b64_tr_b16 v[162:163], v28 offset:45056
v_mfma_f32_16x16x32_bf16 v[96:99], v[128:131], v[152:155], v[96:99]
ds_read_b64_tr_b16 v[164:165], v29 offset:40960
v_mfma_f32_16x16x32_bf16 v[112:115], v[128:131], v[156:159], v[112:115]
ds_read_b64_tr_b16 v[166:167], v29 offset:45056
s_add_u32 s43, s49, 15
s_and_b32 s43, s43, 15
s_mul_i32 s51, s43, 81920
s_add_u32 m0, s39, 65536
s_nop 0
buffer_load_dwordx4 v6, s[20:23], s51 offen offset:0 lds
v_mfma_f32_16x16x32_bf16 v[68:71], v[132:135], v[144:147], v[68:71]
ds_read_b64_tr_b16 v[168:169], v30 offset:40960
v_mfma_f32_16x16x32_bf16 v[84:87], v[132:135], v[148:151], v[84:87]
ds_read_b64_tr_b16 v[170:171], v30 offset:45056
v_mfma_f32_16x16x32_bf16 v[100:103], v[132:135], v[152:155], v[100:103]
ds_read_b64_tr_b16 v[172:173], v31 offset:40960
ds_read_b64_tr_b16 v[174:175], v31 offset:45056
v_mfma_f32_16x16x32_bf16 v[116:119], v[132:135], v[156:159], v[116:119]
ds_read_b128 v[176:179], v14 offset:1024
buffer_load_dwordx4 v7, s[20:23], s51 offen offset:1024 lds
v_mfma_f32_16x16x32_bf16 v[72:75], v[136:139], v[144:147], v[72:75]
ds_read_b128 v[180:183], v15 offset:1024
v_mfma_f32_16x16x32_bf16 v[88:91], v[136:139], v[148:151], v[88:91]
ds_read_b128 v[184:187], v16 offset:1024
v_mfma_f32_16x16x32_bf16 v[104:107], v[136:139], v[152:155], v[104:107]
ds_read_b128 v[188:191], v17 offset:1024
v_mfma_f32_16x16x32_bf16 v[120:123], v[136:139], v[156:159], v[120:123]
buffer_load_dwordx4 v8, s[20:23], s51 offen offset:2048 lds
v_mfma_f32_16x16x32_bf16 v[76:79], v[140:143], v[144:147], v[76:79]
v_mfma_f32_16x16x32_bf16 v[92:95], v[140:143], v[148:151], v[92:95]
v_mfma_f32_16x16x32_bf16 v[108:111], v[140:143], v[152:155], v[108:111]
v_mfma_f32_16x16x32_bf16 v[124:127], v[140:143], v[156:159], v[124:127]
buffer_load_dwordx4 v9, s[20:23], s51 offen offset:3072 lds
s_waitcnt lgkmcnt(0)
s_waitcnt vmcnt(12)
s_barrier
v_mfma_f32_16x16x32_bf16 v[64:67], v[160:163], v[176:179], v[64:67]
ds_read_b64_tr_b16 v[128:129], v28 offset:49152
v_mfma_f32_16x16x32_bf16 v[80:83], v[160:163], v[180:183], v[80:83]
ds_read_b64_tr_b16 v[130:131], v28 offset:53248
v_mfma_f32_16x16x32_bf16 v[96:99], v[160:163], v[184:187], v[96:99]
ds_read_b64_tr_b16 v[132:133], v29 offset:49152
v_mfma_f32_16x16x32_bf16 v[112:115], v[160:163], v[188:191], v[112:115]
ds_read_b64_tr_b16 v[134:135], v29 offset:53248
s_add_u32 s43, s49, 12
s_and_b32 s43, s43, 15
s_lshl_b32 s50, s43, 11
s_add_u32 m0, s39, 0
s_nop 0
buffer_load_dwordx4 v4, s[16:19], s50 offen offset:0 lds
v_mfma_f32_16x16x32_bf16 v[68:71], v[164:167], v[176:179], v[68:71]
ds_read_b64_tr_b16 v[136:137], v30 offset:49152
v_mfma_f32_16x16x32_bf16 v[84:87], v[164:167], v[180:183], v[84:87]
ds_read_b64_tr_b16 v[138:139], v30 offset:53248
v_mfma_f32_16x16x32_bf16 v[100:103], v[164:167], v[184:187], v[100:103]
ds_read_b64_tr_b16 v[140:141], v31 offset:49152
ds_read_b64_tr_b16 v[142:143], v31 offset:53248
v_mfma_f32_16x16x32_bf16 v[116:119], v[164:167], v[188:191], v[116:119]
ds_read_b128 v[144:147], v14 offset:16384
buffer_load_dwordx4 v4, s[16:19], s50 offen offset:1024 lds
v_mfma_f32_16x16x32_bf16 v[72:75], v[168:171], v[176:179], v[72:75]
ds_read_b128 v[148:151], v15 offset:16384
v_mfma_f32_16x16x32_bf16 v[88:91], v[168:171], v[180:183], v[88:91]
ds_read_b128 v[152:155], v16 offset:16384
v_mfma_f32_16x16x32_bf16 v[104:107], v[168:171], v[184:187], v[104:107]
ds_read_b128 v[156:159], v17 offset:16384
v_mfma_f32_16x16x32_bf16 v[120:123], v[168:171], v[188:191], v[120:123]
buffer_load_dwordx4 v5, s[16:19], s50 offen offset:2048 lds
v_mfma_f32_16x16x32_bf16 v[76:79], v[172:175], v[176:179], v[76:79]
v_mfma_f32_16x16x32_bf16 v[92:95], v[172:175], v[180:183], v[92:95]
v_mfma_f32_16x16x32_bf16 v[108:111], v[172:175], v[184:187], v[108:111]
v_mfma_f32_16x16x32_bf16 v[124:127], v[172:175], v[188:191], v[124:127]
buffer_load_dwordx4 v5, s[16:19], s50 offen offset:3072 lds
s_waitcnt lgkmcnt(0)
v_mfma_f32_16x16x32_bf16 v[64:67], v[128:131], v[144:147], v[64:67]
ds_read_b64_tr_b16 v[160:161], v28 offset:57344
v_mfma_f32_16x16x32_bf16 v[80:83], v[128:131], v[148:151], v[80:83]
ds_read_b64_tr_b16 v[162:163], v28 offset:61440
v_mfma_f32_16x16x32_bf16 v[96:99], v[128:131], v[152:155], v[96:99]
ds_read_b64_tr_b16 v[164:165], v29 offset:57344
v_mfma_f32_16x16x32_bf16 v[112:115], v[128:131], v[156:159], v[112:115]
ds_read_b64_tr_b16 v[166:167], v29 offset:61440
v_mfma_f32_16x16x32_bf16 v[68:71], v[132:135], v[144:147], v[68:71]
ds_read_b64_tr_b16 v[168:169], v30 offset:57344
v_mfma_f32_16x16x32_bf16 v[84:87], v[132:135], v[148:151], v[84:87]
ds_read_b64_tr_b16 v[170:171], v30 offset:61440
v_mfma_f32_16x16x32_bf16 v[100:103], v[132:135], v[152:155], v[100:103]
ds_read_b64_tr_b16 v[172:173], v31 offset:57344
ds_read_b64_tr_b16 v[174:175], v31 offset:61440
v_mfma_f32_16x16x32_bf16 v[116:119], v[132:135], v[156:159], v[116:119]
ds_read_b128 v[176:179], v14 offset:17408
v_mfma_f32_16x16x32_bf16 v[72:75], v[136:139], v[144:147], v[72:75]
ds_read_b128 v[180:183], v15 offset:17408
v_mfma_f32_16x16x32_bf16 v[88:91], v[136:139], v[148:151], v[88:91]
ds_read_b128 v[184:187], v16 offset:17408
v_mfma_f32_16x16x32_bf16 v[104:107], v[136:139], v[152:155], v[104:107]
ds_read_b128 v[188:191], v17 offset:17408
v_mfma_f32_16x16x32_bf16 v[120:123], v[136:139], v[156:159], v[120:123]
v_mfma_f32_16x16x32_bf16 v[76:79], v[140:143], v[144:147], v[76:79]
v_mfma_f32_16x16x32_bf16 v[92:95], v[140:143], v[148:151], v[92:95]
v_mfma_f32_16x16x32_bf16 v[108:111], v[140:143], v[152:155], v[108:111]
v_mfma_f32_16x16x32_bf16 v[124:127], v[140:143], v[156:159], v[124:127]
s_waitcnt lgkmcnt(0)
s_waitcnt vmcnt(8)
s_barrier
v_mfma_f32_16x16x32_bf16 v[64:67], v[160:163], v[176:179], v[64:67]
ds_read_b64_tr_b16 v[128:129], v32 offset:0
v_mfma_f32_16x16x32_bf16 v[80:83], v[160:163], v[180:183], v[80:83]
ds_read_b64_tr_b16 v[130:131], v32 offset:4096
v_mfma_f32_16x16x32_bf16 v[96:99], v[160:163], v[184:187], v[96:99]
ds_read_b64_tr_b16 v[132:133], v33 offset:0
v_mfma_f32_16x16x32_bf16 v[112:115], v[160:163], v[188:191], v[112:115]
ds_read_b64_tr_b16 v[134:135], v33 offset:4096
s_add_u32 s43, s49, 13
s_and_b32 s43, s43, 15
s_lshl_b32 s50, s43, 11
s_add_u32 m0, s39, 16384
s_nop 0
buffer_load_dwordx4 v4, s[16:19], s50 offen offset:0 lds
v_mfma_f32_16x16x32_bf16 v[68:71], v[164:167], v[176:179], v[68:71]
ds_read_b64_tr_b16 v[136:137], v34 offset:0
v_mfma_f32_16x16x32_bf16 v[84:87], v[164:167], v[180:183], v[84:87]
ds_read_b64_tr_b16 v[138:139], v34 offset:4096
v_mfma_f32_16x16x32_bf16 v[100:103], v[164:167], v[184:187], v[100:103]
ds_read_b64_tr_b16 v[140:141], v35 offset:0
ds_read_b64_tr_b16 v[142:143], v35 offset:4096
v_mfma_f32_16x16x32_bf16 v[116:119], v[164:167], v[188:191], v[116:119]
ds_read_b128 v[144:147], v14 offset:32768
buffer_load_dwordx4 v4, s[16:19], s50 offen offset:1024 lds
v_mfma_f32_16x16x32_bf16 v[72:75], v[168:171], v[176:179], v[72:75]
ds_read_b128 v[148:151], v15 offset:32768
v_mfma_f32_16x16x32_bf16 v[88:91], v[168:171], v[180:183], v[88:91]
ds_read_b128 v[152:155], v16 offset:32768
v_mfma_f32_16x16x32_bf16 v[104:107], v[168:171], v[184:187], v[104:107]
ds_read_b128 v[156:159], v17 offset:32768
v_mfma_f32_16x16x32_bf16 v[120:123], v[168:171], v[188:191], v[120:123]
buffer_load_dwordx4 v5, s[16:19], s50 offen offset:2048 lds
v_mfma_f32_16x16x32_bf16 v[76:79], v[172:175], v[176:179], v[76:79]
v_mfma_f32_16x16x32_bf16 v[92:95], v[172:175], v[180:183], v[92:95]
v_mfma_f32_16x16x32_bf16 v[108:111], v[172:175], v[184:187], v[108:111]
v_mfma_f32_16x16x32_bf16 v[124:127], v[172:175], v[188:191], v[124:127]
buffer_load_dwordx4 v5, s[16:19], s50 offen offset:3072 lds
s_waitcnt lgkmcnt(0)
v_mfma_f32_16x16x32_bf16 v[64:67], v[128:131], v[144:147], v[64:67]
ds_read_b64_tr_b16 v[160:161], v32 offset:8192
v_mfma_f32_16x16x32_bf16 v[80:83], v[128:131], v[148:151], v[80:83]
ds_read_b64_tr_b16 v[162:163], v32 offset:12288
v_mfma_f32_16x16x32_bf16 v[96:99], v[128:131], v[152:155], v[96:99]
ds_read_b64_tr_b16 v[164:165], v33 offset:8192
v_mfma_f32_16x16x32_bf16 v[112:115], v[128:131], v[156:159], v[112:115]
ds_read_b64_tr_b16 v[166:167], v33 offset:12288
v_mfma_f32_16x16x32_bf16 v[68:71], v[132:135], v[144:147], v[68:71]
ds_read_b64_tr_b16 v[168:169], v34 offset:8192
v_mfma_f32_16x16x32_bf16 v[84:87], v[132:135], v[148:151], v[84:87]
ds_read_b64_tr_b16 v[170:171], v34 offset:12288
v_mfma_f32_16x16x32_bf16 v[100:103], v[132:135], v[152:155], v[100:103]
ds_read_b64_tr_b16 v[172:173], v35 offset:8192
ds_read_b64_tr_b16 v[174:175], v35 offset:12288
v_mfma_f32_16x16x32_bf16 v[116:119], v[132:135], v[156:159], v[116:119]
ds_read_b128 v[176:179], v14 offset:33792
v_mfma_f32_16x16x32_bf16 v[72:75], v[136:139], v[144:147], v[72:75]
ds_read_b128 v[180:183], v15 offset:33792
v_mfma_f32_16x16x32_bf16 v[88:91], v[136:139], v[148:151], v[88:91]
ds_read_b128 v[184:187], v16 offset:33792
v_mfma_f32_16x16x32_bf16 v[104:107], v[136:139], v[152:155], v[104:107]
ds_read_b128 v[188:191], v17 offset:33792
v_mfma_f32_16x16x32_bf16 v[120:123], v[136:139], v[156:159], v[120:123]
v_mfma_f32_16x16x32_bf16 v[76:79], v[140:143], v[144:147], v[76:79]
v_mfma_f32_16x16x32_bf16 v[92:95], v[140:143], v[148:151], v[92:95]
v_mfma_f32_16x16x32_bf16 v[108:111], v[140:143], v[152:155], v[108:111]
v_mfma_f32_16x16x32_bf16 v[124:127], v[140:143], v[156:159], v[124:127]
s_waitcnt lgkmcnt(0)
s_waitcnt vmcnt(4)
s_barrier
v_mfma_f32_16x16x32_bf16 v[64:67], v[160:163], v[176:179], v[64:67]
ds_read_b64_tr_b16 v[128:129], v32 offset:16384
v_mfma_f32_16x16x32_bf16 v[80:83], v[160:163], v[180:183], v[80:83]
ds_read_b64_tr_b16 v[130:131], v32 offset:20480
v_mfma_f32_16x16x32_bf16 v[96:99], v[160:163], v[184:187], v[96:99]
ds_read_b64_tr_b16 v[132:133], v33 offset:16384
v_mfma_f32_16x16x32_bf16 v[112:115], v[160:163], v[188:191], v[112:115]
ds_read_b64_tr_b16 v[134:135], v33 offset:20480
s_add_u32 s43, s49, 14
s_and_b32 s43, s43, 15
s_lshl_b32 s50, s43, 11
s_add_u32 m0, s39, 32768
s_nop 0
buffer_load_dwordx4 v4, s[16:19], s50 offen offset:0 lds
v_mfma_f32_16x16x32_bf16 v[68:71], v[164:167], v[176:179], v[68:71]
ds_read_b64_tr_b16 v[136:137], v34 offset:16384
v_mfma_f32_16x16x32_bf16 v[84:87], v[164:167], v[180:183], v[84:87]
ds_read_b64_tr_b16 v[138:139], v34 offset:20480
v_mfma_f32_16x16x32_bf16 v[100:103], v[164:167], v[184:187], v[100:103]
ds_read_b64_tr_b16 v[140:141], v35 offset:16384
ds_read_b64_tr_b16 v[142:143], v35 offset:20480
v_mfma_f32_16x16x32_bf16 v[116:119], v[164:167], v[188:191], v[116:119]
ds_read_b128 v[144:147], v14 offset:0
buffer_load_dwordx4 v4, s[16:19], s50 offen offset:1024 lds
v_mfma_f32_16x16x32_bf16 v[72:75], v[168:171], v[176:179], v[72:75]
ds_read_b128 v[148:151], v15 offset:0
v_mfma_f32_16x16x32_bf16 v[88:91], v[168:171], v[180:183], v[88:91]
ds_read_b128 v[152:155], v16 offset:0
v_mfma_f32_16x16x32_bf16 v[104:107], v[168:171], v[184:187], v[104:107]
ds_read_b128 v[156:159], v17 offset:0
v_mfma_f32_16x16x32_bf16 v[120:123], v[168:171], v[188:191], v[120:123]
buffer_load_dwordx4 v5, s[16:19], s50 offen offset:2048 lds
v_mfma_f32_16x16x32_bf16 v[76:79], v[172:175], v[176:179], v[76:79]
v_mfma_f32_16x16x32_bf16 v[92:95], v[172:175], v[180:183], v[92:95]
v_mfma_f32_16x16x32_bf16 v[108:111], v[172:175], v[184:187], v[108:111]
v_mfma_f32_16x16x32_bf16 v[124:127], v[172:175], v[188:191], v[124:127]
buffer_load_dwordx4 v5, s[16:19], s50 offen offset:3072 lds
s_waitcnt lgkmcnt(0)
v_mfma_f32_16x16x32_bf16 v[64:67], v[128:131], v[144:147], v[64:67]
ds_read_b64_tr_b16 v[160:161], v32 offset:24576
v_mfma_f32_16x16x32_bf16 v[80:83], v[128:131], v[148:151], v[80:83]
ds_read_b64_tr_b16 v[162:163], v32 offset:28672
v_mfma_f32_16x16x32_bf16 v[96:99], v[128:131], v[152:155], v[96:99]
ds_read_b64_tr_b16 v[164:165], v33 offset:24576
v_mfma_f32_16x16x32_bf16 v[112:115], v[128:131], v[156:159], v[112:115]
ds_read_b64_tr_b16 v[166:167], v33 offset:28672
v_mfma_f32_16x16x32_bf16 v[68:71], v[132:135], v[144:147], v[68:71]
ds_read_b64_tr_b16 v[168:169], v34 offset:24576
v_mfma_f32_16x16x32_bf16 v[84:87], v[132:135], v[148:151], v[84:87]
ds_read_b64_tr_b16 v[170:171], v34 offset:28672
v_mfma_f32_16x16x32_bf16 v[100:103], v[132:135], v[152:155], v[100:103]
ds_read_b64_tr_b16 v[172:173], v35 offset:24576
ds_read_b64_tr_b16 v[174:175], v35 offset:28672
v_mfma_f32_16x16x32_bf16 v[116:119], v[132:135], v[156:159], v[116:119]
ds_read_b128 v[176:179], v14 offset:1024
v_mfma_f32_16x16x32_bf16 v[72:75], v[136:139], v[144:147], v[72:75]
ds_read_b128 v[180:183], v15 offset:1024
v_mfma_f32_16x16x32_bf16 v[88:91], v[136:139], v[148:151], v[88:91]
ds_read_b128 v[184:187], v16 offset:1024
v_mfma_f32_16x16x32_bf16 v[104:107], v[136:139], v[152:155], v[104:107]
ds_read_b128 v[188:191], v17 offset:1024
v_mfma_f32_16x16x32_bf16 v[120:123], v[136:139], v[156:159], v[120:123]
v_mfma_f32_16x16x32_bf16 v[76:79], v[140:143], v[144:147], v[76:79]
v_mfma_f32_16x16x32_bf16 v[92:95], v[140:143], v[148:151], v[92:95]
v_mfma_f32_16x16x32_bf16 v[108:111], v[140:143], v[152:155], v[108:111]
v_mfma_f32_16x16x32_bf16 v[124:127], v[140:143], v[156:159], v[124:127]
s_waitcnt lgkmcnt(0)
s_waitcnt vmcnt(4)
s_barrier
v_mfma_f32_16x16x32_bf16 v[64:67], v[160:163], v[176:179], v[64:67]
ds_read_b64_tr_b16 v[128:129], v32 offset:32768
v_mfma_f32_16x16x32_bf16 v[80:83], v[160:163], v[180:183], v[80:83]
ds_read_b64_tr_b16 v[130:131], v32 offset:36864
v_mfma_f32_16x16x32_bf16 v[96:99], v[160:163], v[184:187], v[96:99]
ds_read_b64_tr_b16 v[132:133], v33 offset:32768
v_mfma_f32_16x16x32_bf16 v[112:115], v[160:163], v[188:191], v[112:115]
ds_read_b64_tr_b16 v[134:135], v33 offset:36864
s_add_u32 s43, s49, 15
s_and_b32 s43, s43, 15
s_lshl_b32 s50, s43, 11
s_add_u32 m0, s39, 0
s_nop 0
buffer_load_dwordx4 v4, s[16:19], s50 offen offset:0 lds
v_mfma_f32_16x16x32_bf16 v[68:71], v[164:167], v[176:179], v[68:71]
ds_read_b64_tr_b16 v[136:137], v34 offset:32768
v_mfma_f32_16x16x32_bf16 v[84:87], v[164:167], v[180:183], v[84:87]
ds_read_b64_tr_b16 v[138:139], v34 offset:36864
v_mfma_f32_16x16x32_bf16 v[100:103], v[164:167], v[184:187], v[100:103]
ds_read_b64_tr_b16 v[140:141], v35 offset:32768
ds_read_b64_tr_b16 v[142:143], v35 offset:36864
v_mfma_f32_16x16x32_bf16 v[116:119], v[164:167], v[188:191], v[116:119]
ds_read_b128 v[144:147], v14 offset:16384
buffer_load_dwordx4 v4, s[16:19], s50 offen offset:1024 lds
v_mfma_f32_16x16x32_bf16 v[72:75], v[168:171], v[176:179], v[72:75]
ds_read_b128 v[148:151], v15 offset:16384
v_mfma_f32_16x16x32_bf16 v[88:91], v[168:171], v[180:183], v[88:91]
ds_read_b128 v[152:155], v16 offset:16384
v_mfma_f32_16x16x32_bf16 v[104:107], v[168:171], v[184:187], v[104:107]
ds_read_b128 v[156:159], v17 offset:16384
v_mfma_f32_16x16x32_bf16 v[120:123], v[168:171], v[188:191], v[120:123]
buffer_load_dwordx4 v5, s[16:19], s50 offen offset:2048 lds
v_mfma_f32_16x16x32_bf16 v[76:79], v[172:175], v[176:179], v[76:79]
v_mfma_f32_16x16x32_bf16 v[92:95], v[172:175], v[180:183], v[92:95]
v_mfma_f32_16x16x32_bf16 v[108:111], v[172:175], v[184:187], v[108:111]
v_mfma_f32_16x16x32_bf16 v[124:127], v[172:175], v[188:191], v[124:127]
buffer_load_dwordx4 v5, s[16:19], s50 offen offset:3072 lds
s_waitcnt lgkmcnt(0)
v_mfma_f32_16x16x32_bf16 v[64:67], v[128:131], v[144:147], v[64:67]
ds_read_b64_tr_b16 v[160:161], v32 offset:40960
v_mfma_f32_16x16x32_bf16 v[80:83], v[128:131], v[148:151], v[80:83]
ds_read_b64_tr_b16 v[162:163], v32 offset:45056
v_mfma_f32_16x16x32_bf16 v[96:99], v[128:131], v[152:155], v[96:99]
ds_read_b64_tr_b16 v[164:165], v33 offset:40960
v_mfma_f32_16x16x32_bf16 v[112:115], v[128:131], v[156:159], v[112:115]
ds_read_b64_tr_b16 v[166:167], v33 offset:45056
v_mfma_f32_16x16x32_bf16 v[68:71], v[132:135], v[144:147], v[68:71]
ds_read_b64_tr_b16 v[168:169], v34 offset:40960
v_mfma_f32_16x16x32_bf16 v[84:87], v[132:135], v[148:151], v[84:87]
ds_read_b64_tr_b16 v[170:171], v34 offset:45056
v_mfma_f32_16x16x32_bf16 v[100:103], v[132:135], v[152:155], v[100:103]
ds_read_b64_tr_b16 v[172:173], v35 offset:40960
ds_read_b64_tr_b16 v[174:175], v35 offset:45056
v_mfma_f32_16x16x32_bf16 v[116:119], v[132:135], v[156:159], v[116:119]
ds_read_b128 v[176:179], v14 offset:17408
v_mfma_f32_16x16x32_bf16 v[72:75], v[136:139], v[144:147], v[72:75]
ds_read_b128 v[180:183], v15 offset:17408
v_mfma_f32_16x16x32_bf16 v[88:91], v[136:139], v[148:151], v[88:91]
ds_read_b128 v[184:187], v16 offset:17408
v_mfma_f32_16x16x32_bf16 v[104:107], v[136:139], v[152:155], v[104:107]
ds_read_b128 v[188:191], v17 offset:17408
v_mfma_f32_16x16x32_bf16 v[120:123], v[136:139], v[156:159], v[120:123]
v_mfma_f32_16x16x32_bf16 v[76:79], v[140:143], v[144:147], v[76:79]
v_mfma_f32_16x16x32_bf16 v[92:95], v[140:143], v[148:151], v[92:95]
v_mfma_f32_16x16x32_bf16 v[108:111], v[140:143], v[152:155], v[108:111]
v_mfma_f32_16x16x32_bf16 v[124:127], v[140:143], v[156:159], v[124:127]
s_waitcnt lgkmcnt(0)
s_waitcnt vmcnt(4)
s_barrier
v_mfma_f32_16x16x32_bf16 v[64:67], v[160:163], v[176:179], v[64:67]
ds_read_b64_tr_b16 v[128:129], v28 offset:0
v_mfma_f32_16x16x32_bf16 v[80:83], v[160:163], v[180:183], v[80:83]
ds_read_b64_tr_b16 v[130:131], v28 offset:4096
v_mfma_f32_16x16x32_bf16 v[96:99], v[160:163], v[184:187], v[96:99]
ds_read_b64_tr_b16 v[132:133], v29 offset:0
v_mfma_f32_16x16x32_bf16 v[112:115], v[160:163], v[188:191], v[112:115]
ds_read_b64_tr_b16 v[134:135], v29 offset:4096
v_mfma_f32_16x16x32_bf16 v[68:71], v[164:167], v[176:179], v[68:71]
ds_read_b64_tr_b16 v[136:137], v30 offset:0
v_mfma_f32_16x16x32_bf16 v[84:87], v[164:167], v[180:183], v[84:87]
ds_read_b64_tr_b16 v[138:139], v30 offset:4096
v_mfma_f32_16x16x32_bf16 v[100:103], v[164:167], v[184:187], v[100:103]
ds_read_b64_tr_b16 v[140:141], v31 offset:0
ds_read_b64_tr_b16 v[142:143], v31 offset:4096
v_mfma_f32_16x16x32_bf16 v[116:119], v[164:167], v[188:191], v[116:119]
ds_read_b128 v[144:147], v14 offset:32768
v_mfma_f32_16x16x32_bf16 v[72:75], v[168:171], v[176:179], v[72:75]
ds_read_b128 v[148:151], v15 offset:32768
v_mfma_f32_16x16x32_bf16 v[88:91], v[168:171], v[180:183], v[88:91]
ds_read_b128 v[152:155], v16 offset:32768
v_mfma_f32_16x16x32_bf16 v[104:107], v[168:171], v[184:187], v[104:107]
ds_read_b128 v[156:159], v17 offset:32768
v_mfma_f32_16x16x32_bf16 v[120:123], v[168:171], v[188:191], v[120:123]
v_mfma_f32_16x16x32_bf16 v[76:79], v[172:175], v[176:179], v[76:79]
v_mfma_f32_16x16x32_bf16 v[92:95], v[172:175], v[180:183], v[92:95]
v_mfma_f32_16x16x32_bf16 v[108:111], v[172:175], v[184:187], v[108:111]
v_mfma_f32_16x16x32_bf16 v[124:127], v[172:175], v[188:191], v[124:127]
s_waitcnt lgkmcnt(0)
v_mfma_f32_16x16x32_bf16 v[64:67], v[128:131], v[144:147], v[64:67]
ds_read_b64_tr_b16 v[160:161], v28 offset:8192
v_mfma_f32_16x16x32_bf16 v[80:83], v[128:131], v[148:151], v[80:83]
ds_read_b64_tr_b16 v[162:163], v28 offset:12288
v_mfma_f32_16x16x32_bf16 v[96:99], v[128:131], v[152:155], v[96:99]
ds_read_b64_tr_b16 v[164:165], v29 offset:8192
v_mfma_f32_16x16x32_bf16 v[112:115], v[128:131], v[156:159], v[112:115]
ds_read_b64_tr_b16 v[166:167], v29 offset:12288
v_mfma_f32_16x16x32_bf16 v[68:71], v[132:135], v[144:147], v[68:71]
ds_read_b64_tr_b16 v[168:169], v30 offset:8192
v_mfma_f32_16x16x32_bf16 v[84:87], v[132:135], v[148:151], v[84:87]
ds_read_b64_tr_b16 v[170:171], v30 offset:12288
v_mfma_f32_16x16x32_bf16 v[100:103], v[132:135], v[152:155], v[100:103]
ds_read_b64_tr_b16 v[172:173], v31 offset:8192
ds_read_b64_tr_b16 v[174:175], v31 offset:12288
v_mfma_f32_16x16x32_bf16 v[116:119], v[132:135], v[156:159], v[116:119]
ds_read_b128 v[176:179], v14 offset:33792
v_mfma_f32_16x16x32_bf16 v[72:75], v[136:139], v[144:147], v[72:75]
ds_read_b128 v[180:183], v15 offset:33792
v_mfma_f32_16x16x32_bf16 v[88:91], v[136:139], v[148:151], v[88:91]
ds_read_b128 v[184:187], v16 offset:33792
v_mfma_f32_16x16x32_bf16 v[104:107], v[136:139], v[152:155], v[104:107]
ds_read_b128 v[188:191], v17 offset:33792
v_mfma_f32_16x16x32_bf16 v[120:123], v[136:139], v[156:159], v[120:123]
v_mfma_f32_16x16x32_bf16 v[76:79], v[140:143], v[144:147], v[76:79]
v_mfma_f32_16x16x32_bf16 v[92:95], v[140:143], v[148:151], v[92:95]
v_mfma_f32_16x16x32_bf16 v[108:111], v[140:143], v[152:155], v[108:111]
v_mfma_f32_16x16x32_bf16 v[124:127], v[140:143], v[156:159], v[124:127]
s_waitcnt lgkmcnt(0)
s_waitcnt vmcnt(0)
s_barrier
v_mfma_f32_16x16x32_bf16 v[64:67], v[160:163], v[176:179], v[64:67]
ds_read_b64_tr_b16 v[128:129], v28 offset:16384
v_mfma_f32_16x16x32_bf16 v[80:83], v[160:163], v[180:183], v[80:83]
ds_read_b64_tr_b16 v[130:131], v28 offset:20480
v_mfma_f32_16x16x32_bf16 v[96:99], v[160:163], v[184:187], v[96:99]
ds_read_b64_tr_b16 v[132:133], v29 offset:16384
v_mfma_f32_16x16x32_bf16 v[112:115], v[160:163], v[188:191], v[112:115]
ds_read_b64_tr_b16 v[134:135], v29 offset:20480
v_mfma_f32_16x16x32_bf16 v[68:71], v[164:167], v[176:179], v[68:71]
ds_read_b64_tr_b16 v[136:137], v30 offset:16384
v_mfma_f32_16x16x32_bf16 v[84:87], v[164:167], v[180:183], v[84:87]
ds_read_b64_tr_b16 v[138:139], v30 offset:20480
v_mfma_f32_16x16x32_bf16 v[100:103], v[164:167], v[184:187], v[100:103]
ds_read_b64_tr_b16 v[140:141], v31 offset:16384
ds_read_b64_tr_b16 v[142:143], v31 offset:20480
v_mfma_f32_16x16x32_bf16 v[116:119], v[164:167], v[188:191], v[116:119]
ds_read_b128 v[144:147], v14 offset:0
v_mfma_f32_16x16x32_bf16 v[72:75], v[168:171], v[176:179], v[72:75]
ds_read_b128 v[148:151], v15 offset:0
v_mfma_f32_16x16x32_bf16 v[88:91], v[168:171], v[180:183], v[88:91]
ds_read_b128 v[152:155], v16 offset:0
v_mfma_f32_16x16x32_bf16 v[104:107], v[168:171], v[184:187], v[104:107]
ds_read_b128 v[156:159], v17 offset:0
v_mfma_f32_16x16x32_bf16 v[120:123], v[168:171], v[188:191], v[120:123]
v_mfma_f32_16x16x32_bf16 v[76:79], v[172:175], v[176:179], v[76:79]
v_mfma_f32_16x16x32_bf16 v[92:95], v[172:175], v[180:183], v[92:95]
v_mfma_f32_16x16x32_bf16 v[108:111], v[172:175], v[184:187], v[108:111]
v_mfma_f32_16x16x32_bf16 v[124:127], v[172:175], v[188:191], v[124:127]
s_waitcnt lgkmcnt(0)
v_mfma_f32_16x16x32_bf16 v[64:67], v[128:131], v[144:147], v[64:67]
ds_read_b64_tr_b16 v[160:161], v28 offset:24576
v_mfma_f32_16x16x32_bf16 v[80:83], v[128:131], v[148:151], v[80:83]
ds_read_b64_tr_b16 v[162:163], v28 offset:28672
v_mfma_f32_16x16x32_bf16 v[96:99], v[128:131], v[152:155], v[96:99]
ds_read_b64_tr_b16 v[164:165], v29 offset:24576
v_mfma_f32_16x16x32_bf16 v[112:115], v[128:131], v[156:159], v[112:115]
ds_read_b64_tr_b16 v[166:167], v29 offset:28672
v_mfma_f32_16x16x32_bf16 v[68:71], v[132:135], v[144:147], v[68:71]
ds_read_b64_tr_b16 v[168:169], v30 offset:24576
v_mfma_f32_16x16x32_bf16 v[84:87], v[132:135], v[148:151], v[84:87]
ds_read_b64_tr_b16 v[170:171], v30 offset:28672
v_mfma_f32_16x16x32_bf16 v[100:103], v[132:135], v[152:155], v[100:103]
ds_read_b64_tr_b16 v[172:173], v31 offset:24576
ds_read_b64_tr_b16 v[174:175], v31 offset:28672
v_mfma_f32_16x16x32_bf16 v[116:119], v[132:135], v[156:159], v[116:119]
ds_read_b128 v[176:179], v14 offset:1024
v_mfma_f32_16x16x32_bf16 v[72:75], v[136:139], v[144:147], v[72:75]
ds_read_b128 v[180:183], v15 offset:1024
v_mfma_f32_16x16x32_bf16 v[88:91], v[136:139], v[148:151], v[88:91]
ds_read_b128 v[184:187], v16 offset:1024
v_mfma_f32_16x16x32_bf16 v[104:107], v[136:139], v[152:155], v[104:107]
ds_read_b128 v[188:191], v17 offset:1024
v_mfma_f32_16x16x32_bf16 v[120:123], v[136:139], v[156:159], v[120:123]
v_mfma_f32_16x16x32_bf16 v[76:79], v[140:143], v[144:147], v[76:79]
v_mfma_f32_16x16x32_bf16 v[92:95], v[140:143], v[148:151], v[92:95]
v_mfma_f32_16x16x32_bf16 v[108:111], v[140:143], v[152:155], v[108:111]
v_mfma_f32_16x16x32_bf16 v[124:127], v[140:143], v[156:159], v[124:127]
s_waitcnt lgkmcnt(0)
v_mfma_f32_16x16x32_bf16 v[64:67], v[160:163], v[176:179], v[64:67]
v_mfma_f32_16x16x32_bf16 v[80:83], v[160:163], v[180:183], v[80:83]
v_mfma_f32_16x16x32_bf16 v[96:99], v[160:163], v[184:187], v[96:99]
v_mfma_f32_16x16x32_bf16 v[112:115], v[160:163], v[188:191], v[112:115]
v_mfma_f32_16x16x32_bf16 v[68:71], v[164:167], v[176:179], v[68:71]
v_mfma_f32_16x16x32_bf16 v[84:87], v[164:167], v[180:183], v[84:87]
v_mfma_f32_16x16x32_bf16 v[100:103], v[164:167], v[184:187], v[100:103]
v_mfma_f32_16x16x32_bf16 v[116:119], v[164:167], v[188:191], v[116:119]
v_mfma_f32_16x16x32_bf16 v[72:75], v[168:171], v[176:179], v[72:75]
v_mfma_f32_16x16x32_bf16 v[88:91], v[168:171], v[180:183], v[88:91]
v_mfma_f32_16x16x32_bf16 v[104:107], v[168:171], v[184:187], v[104:107]
v_mfma_f32_16x16x32_bf16 v[120:123], v[168:171], v[188:191], v[120:123]
v_mfma_f32_16x16x32_bf16 v[76:79], v[172:175], v[176:179], v[76:79]
v_mfma_f32_16x16x32_bf16 v[92:95], v[172:175], v[180:183], v[92:95]
v_mfma_f32_16x16x32_bf16 v[108:111], v[172:175], v[184:187], v[108:111]
v_mfma_f32_16x16x32_bf16 v[124:127], v[172:175], v[188:191], v[124:127]
s_lshl_b32 s43, s45, 2
s_add_u32 s43, s43, s36
s_lshl_b32 s43, s43, 14
s_nop 7
s_xor_b32 s44, s45, 1
s_lshl_b32 s44, s44, 12
s_add_u32 s44, s44, s43
buffer_store_dwordx4 v[80:83], v12, s[24:27], s44 offen offset:0 sc1
buffer_store_dwordx4 v[84:87], v12, s[24:27], s44 offen offset:1024 sc1
buffer_store_dwordx4 v[88:91], v12, s[24:27], s44 offen offset:2048 sc1
buffer_store_dwordx4 v[92:95], v12, s[24:27], s44 offen offset:3072 sc1
s_xor_b32 s44, s45, 2
s_lshl_b32 s44, s44, 12
s_add_u32 s44, s44, s43
buffer_store_dwordx4 v[96:99], v12, s[24:27], s44 offen offset:0 sc1
buffer_store_dwordx4 v[100:103], v12, s[24:27], s44 offen offset:1024 sc1
buffer_store_dwordx4 v[104:107], v12, s[24:27], s44 offen offset:2048 sc1
buffer_store_dwordx4 v[108:111], v12, s[24:27], s44 offen offset:3072 sc1
s_xor_b32 s44, s45, 3
s_lshl_b32 s44, s44, 12
s_add_u32 s44, s44, s43
buffer_store_dwordx4 v[112:115], v12, s[24:27], s44 offen offset:0 sc1
buffer_store_dwordx4 v[116:119], v12, s[24:27], s44 offen offset:1024 sc1
buffer_store_dwordx4 v[120:123], v12, s[24:27], s44 offen offset:2048 sc1
buffer_store_dwordx4 v[124:127], v12, s[24:27], s44 offen offset:3072 sc1
s_waitcnt vmcnt(0)
s_barrier
s_cmp_lg_u32 s36, 0
s_cbranch_scc1 L_f_join2
s_add_u32 s42, s42, 16384
s_lshl_b32 s43, s45, 2
s_add_u32 s43, s43, s42
v_mov_b32 v40, s43
v_mov_b32 v41, s78
s_mov_b64 exec, 1
buffer_store_dword v41, v40, s[28:31], 0 offen sc1
s_mov_b64 exec, -1
v_and_b32 v40, 3, v1
v_lshlrev_b32 v40, 2, v40
v_add_u32 v40, s42, v40
s_mov_b32 s44, 0
L_f_poll2:
buffer_load_dword v42, v40, s[28:31], 0 offen sc1
s_waitcnt vmcnt(0)
v_cmp_eq_u32 vcc, s78, v42
s_nop 1
s_and_b32 s43, vcc_lo, 0xf
s_add_u32 s44, s44, 1
s_cmp_eq_u32 s43, 0xf
s_cbranch_scc1 L_f_join2
s_cmp_lt_u32 s44, 0x20000
s_cbranch_scc0 L_f_join2
s_sleep 1
s_branch L_f_poll2
L_f_join2:
s_barrier
s_xor_b32 s43, s45, 1
s_lshl_b32 s43, s43, 2
s_add_u32 s43, s43, s36
s_lshl_b32 s43, s43, 14
s_lshl_b32 s44, s45, 12
s_add_u32 s43, s43, s44
buffer_load_dwordx4 v[128:131], v12, s[24:27], s43 offen offset:0 sc1
buffer_load_dwordx4 v[132:135], v12, s[24:27], s43 offen offset:1024 sc1
buffer_load_dwordx4 v[136:139], v12, s[24:27], s43 offen offset:2048 sc1
buffer_load_dwordx4 v[140:143], v12, s[24:27], s43 offen offset:3072 sc1
s_xor_b32 s43, s45, 2
s_lshl_b32 s43, s43, 2
s_add_u32 s43, s43, s36
s_lshl_b32 s43, s43, 14
s_lshl_b32 s44, s45, 12
s_add_u32 s43, s43, s44
buffer_load_dwordx4 v[144:147], v12, s[24:27], s43 offen offset:0 sc1
buffer_load_dwordx4 v[148:151], v12, s[24:27], s43 offen offset:1024 sc1
buffer_load_dwordx4 v[152:155], v12, s[24:27], s43 offen offset:2048 sc1
buffer_load_dwordx4 v[156:159], v12, s[24:27], s43 offen offset:3072 sc1
s_xor_b32 s43, s45, 3
s_lshl_b32 s43, s43, 2
s_add_u32 s43, s43, s36
s_lshl_b32 s43, s43, 14
s_lshl_b32 s44, s45, 12
s_add_u32 s43, s43, s44
buffer_load_dwordx4 v[160:163], v12, s[24:27], s43 offen offset:0 sc1
buffer_load_dwordx4 v[164:167], v12, s[24:27], s43 offen offset:1024 sc1
buffer_load_dwordx4 v[168:171], v12, s[24:27], s43 offen offset:2048 sc1
buffer_load_dwordx4 v[172:175], v12, s[24:27], s43 offen offset:3072 sc1
s_lshl_b32 s43, s47, 7
s_lshl_b32 s44, s37, 6
s_add_u32 s43, s43, s44
s_lshl_b32 s44, s45, 4
s_add_u32 s43, s43, s44
v_add_u32 v40, s43, v2
v_mul_u32_u24 v40, 2560, v40
s_mul_i32 s43, s46, 1280
s_lshl_b32 s44, s48, 8
s_add_u32 s43, s43, s44
s_lshl_b32 s44, s38, 7
s_add_u32 s43, s43, s44
v_lshlrev_b32 v41, 3, v3
v_add3_u32 v40, v40, v41, s43
s_waitcnt vmcnt(0)
v_pk_add_f32 v[64:65], v[64:65], v[128:129]
v_pk_add_f32 v[66:67], v[66:67], v[130:131]
v_pk_add_f32 v[64:65], v[64:65], v[144:145]
v_pk_add_f32 v[66:67], v[66:67], v[146:147]
v_pk_add_f32 v[64:65], v[64:65], v[160:161]
v_pk_add_f32 v[66:67], v[66:67], v[162:163]
v_pk_add_f32 v[68:69], v[68:69], v[132:133]
v_pk_add_f32 v[70:71], v[70:71], v[134:135]
v_pk_add_f32 v[68:69], v[68:69], v[148:149]
v_pk_add_f32 v[70:71], v[70:71], v[150:151]
v_pk_add_f32 v[68:69], v[68:69], v[164:165]
v_pk_add_f32 v[70:71], v[70:71], v[166:167]
v_pk_add_f32 v[72:73], v[72:73], v[136:137]
v_pk_add_f32 v[74:75], v[74:75], v[138:139]
v_pk_add_f32 v[72:73], v[72:73], v[152:153]
v_pk_add_f32 v[74:75], v[74:75], v[154:155]
v_pk_add_f32 v[72:73], v[72:73], v[168:169]
v_pk_add_f32 v[74:75], v[74:75], v[170:171]
v_pk_add_f32 v[76:77], v[76:77], v[140:141]
v_pk_add_f32 v[78:79], v[78:79], v[142:143]
v_pk_add_f32 v[76:77], v[76:77], v[156:157]
v_pk_add_f32 v[78:79], v[78:79], v[158:159]
v_pk_add_f32 v[76:77], v[76:77], v[172:173]
v_pk_add_f32 v[78:79], v[78:79], v[174:175]
v_cvt_pk_bf16_f32 v44, v64, v65
v_cvt_pk_bf16_f32 v45, v66, v67
v_cvt_pk_bf16_f32 v46, v68, v69
v_cvt_pk_bf16_f32 v47, v70, v71
v_cvt_pk_bf16_f32 v48, v72, v73
v_cvt_pk_bf16_f32 v49, v74, v75
v_cvt_pk_bf16_f32 v50, v76, v77
v_cvt_pk_bf16_f32 v51, v78, v79
buffer_store_dwordx2 v[44:45], v40, s[32:35], 0 offen offset:0
buffer_store_dwordx2 v[46:47], v40, s[32:35], 0 offen offset:32
buffer_store_dwordx2 v[48:49], v40, s[32:35], 0 offen offset:64
buffer_store_dwordx2 v[50:51], v40, s[32:35], 0 offen offset:96
L_k1_end:
s_endpgm
.section .rodata,"a"
.p2align 6
.amdhsa_kernel concat_heads__mha_block_cached__mha_block_cached__near_ridge_kernel
  .amdhsa_next_free_vgpr 512
  .amdhsa_next_free_sgpr 102
  .amdhsa_accum_offset 256
  .amdhsa_group_segment_fixed_size 0
  .amdhsa_kernarg_size 104
  .amdhsa_user_sgpr_count 2
  .amdhsa_user_sgpr_kernarg_segment_ptr 1
  .amdhsa_system_sgpr_workgroup_id_x 1
.end_amdhsa_kernel
```
